```python
import torch

def _softmax(x, axis=-1):
    return torch.softmax(x, dim=axis)
def _gelu(x):
    return torch.nn.functional.gelu(x, approximate="tanh")
def _silu(x):
    return torch.nn.functional.silu(x)
def _sigmoid(x):
    return torch.sigmoid(x)
def _layernorm(x, axis=-1, eps=1e-5):
    m = x.mean(dim=axis, keepdim=True)
    v = x.var(dim=axis, keepdim=True, unbiased=False)
    return (x - m) / torch.sqrt(v + eps)
def _scatter_add(tgt, idx, src, axis=0):
    return tgt.clone().index_add_(axis, idx, src)
def _segment_sum(src, seg, n):
    out = torch.zeros((n,) + src.shape[1:], dtype=src.dtype)
    return out.index_add_(0, seg, src)
def _pad(x, pw):
    flat = tuple(v for pair in reversed(pw) for v in pair)
    return torch.nn.functional.pad(x, flat)

kernel_name = 'gated_mix__sliding_local_dilated__dense_activation_squared_relu__prompt'

def setup_inputs():

    _w = (lambda a: (lambda t: t.to(torch.bfloat16) if t.is_floating_point() else t)(torch.as_tensor(a)))
    def _A_setup():
        B, S, D = 1, 2048, 1024
        return {
            "x": _w((lambda *s: torch.randn(*s, dtype=torch.bfloat16) * 0.05)(B, S, D)),
            "wqkv": _w((lambda *s: torch.randn(*s, dtype=torch.bfloat16) * 0.8)(D, 3 * D)),
            "wo": _w((lambda *s: torch.randn(*s, dtype=torch.bfloat16) * 0.05)(D, D)),
        }
    _A_in = _A_setup()

    def _B_setup():
        B, S, D, F = 1, 2048, 1024, 3584
        return {
            "x": _w((lambda *s: torch.randn(*s, dtype=torch.bfloat16) * 0.05)(B, S, D)),
            "w1": _w((lambda *s: torch.randn(*s, dtype=torch.bfloat16) * 0.1)(D, F)),
            "b1": _w((lambda *s: torch.randn(*s, dtype=torch.bfloat16) * 0.2)(F)),
            "w2": _w((lambda *s: torch.randn(*s, dtype=torch.bfloat16) * 0.1)(F, D)),
            "b2": _w((lambda *s: torch.randn(*s, dtype=torch.bfloat16) * 0.4)(D)),
        }
    _B_in = _B_setup()

    return {
        "A_x": _A_in["x"],
        "A_wqkv": _A_in["wqkv"],
        "A_wo": _A_in["wo"],
        "B_x": _B_in["x"],
        "B_w1": _B_in["w1"],
        "B_b1": _B_in["b1"],
        "B_w2": _B_in["w2"],
        "B_b2": _B_in["b2"],
        "gate_w": _w((lambda *s: torch.randn(*s, dtype=torch.bfloat16) * 0.05)(1024) * 16.0),
    }

def reference(A_x, A_wqkv, A_wo, B_x, B_w1, B_b1, B_w2, B_b2, gate_w):
    def _A_ref(x, wqkv, wo):
        B, S, D = x.shape
        H = 32; Dh = D // H
        W, dil = 8, 2
        qkv = (lambda x, *d: x.permute(*d))((x @ wqkv).reshape(B, S, 3, H, Dh), 2, 0, 3, 1, 4)
        q, k, v = qkv[0], qkv[1], qkv[2]
        scale = Dh ** -0.5
        pos = torch.arange(S)
        off = torch.arange(W) * dil
        idx = pos[:, None] - off[None, :]
        mask = idx >= 0
        idx_c = torch.where(mask, idx, 0).reshape(-1)
        kg = k[:, :, idx_c, :].reshape(B, H, S, W, Dh)
        vg = v[:, :, idx_c, :].reshape(B, H, S, W, Dh)
        logits = torch.einsum("bhsd,bhswd->bhsw", q, kg) * scale
        logits = torch.where(mask[None, None, :, :], logits, -1e9)
        attn = _softmax(logits, axis=-1)
        o = torch.einsum("bhsw,bhswd->bhsd", attn, vg)
        return (lambda x, *d: x.permute(*d))(o, 0, 2, 1, 3).reshape(B, S, D) @ wo

    def _B_ref(x, w1, b1, w2, b2):
        h = torch.einsum("bsd,df->bsf", x, w1) + b1
        zero = torch.zeros_like(h)
        r = torch.where(h > zero, h, zero)
        h = r * r
        out = torch.einsum("bsf,fd->bsd", h, w2) + b2
        return out

    x = A_x
    g = _sigmoid((x * gate_w).sum(-1, keepdims=True))
    a = _A_ref(x, A_wqkv, A_wo)
    b = _B_ref(x, B_w1, B_b1, B_w2, B_b2)
    return g * a + (1 - g) * b
```

```asm
; @launch grid=(256,1,1) block=(448,1,1) lds=163840
.amdgcn_target "amdgcn-amd-amdhsa--gfx950"
.text
.globl gated_mix__sliding_local_dilated__dense_activation_squared_relu__prompt_kernel
.p2align 8
.type gated_mix__sliding_local_dilated__dense_activation_squared_relu__prompt_kernel,@function
gated_mix__sliding_local_dilated__dense_activation_squared_relu__prompt_kernel:
L_KSTART:
    s_cmp_ge_u32 s2, 256
    s_cbranch_scc1 L_END
    s_load_dwordx16 s[4:19], s[0:1], 0
    s_load_dwordx8 s[20:27], s[0:1], 64
    v_lshrrev_b32 v2, 6, v0
    v_and_b32 v1, 63, v0
    s_nop 0
    v_readfirstlane_b32 s52, v2
    s_nop 2
    s_cmp_lt_u32 s52, 4
    s_cbranch_scc1 L_COMP
    s_cmp_eq_u32 s52, 4
    s_cbranch_scc1 L_LX
    s_cmp_eq_u32 s52, 6
    s_cbranch_scc1 L_HELP
L_LW:
    s_and_b32 s62, s2, 7
    s_lshr_b32 s63, s2, 3
    s_and_b32 s53, s62, 1
    s_lshl_b32 s53, s53, 3
    s_lshr_b32 s64, s63, 2
    s_add_u32 s53, s53, s64
    s_lshr_b32 s54, s62, 1
    s_lshl_b32 s54, s54, 2
    s_and_b32 s64, s63, 3
    s_add_u32 s54, s54, s64
    s_lshr_b32 s57, s54, 3
    s_and_b32 s58, s54, 7
    s_and_b32 s55, s52, 1
    s_lshr_b32 s56, s52, 1
    s_waitcnt lgkmcnt(0)
    s_mov_b32 s28, s12
    s_mov_b32 s29, s13
    s_mov_b32 s30, 0x700000
    s_mov_b32 s31, 0x20000
    s_mov_b32 s32, s6
    s_mov_b32 s33, s7
    s_mov_b32 s34, 0x600000
    s_mov_b32 s35, 0x20000
    s_mov_b32 s36, s16
    s_mov_b32 s37, s17
    s_mov_b32 s38, 0x700000
    s_mov_b32 s39, 0x20000
    s_mov_b32 s40, s8
    s_mov_b32 s41, s9
    s_mov_b32 s42, 0x200000
    s_mov_b32 s43, 0x20000
    s_mul_i32 s63, s54, 448
    s_movk_i32 s64, 2341
    s_movk_i32 s65, 7168
    v_add_u32 v2, 0, v1
    v_mul_lo_u32 v3, v2, s64
    v_lshrrev_b32 v3, 16, v3
    v_mul_u32_u24 v22, 28, v3
    v_sub_u32 v2, v2, v22
    v_lshrrev_b32 v22, 2, v3
    v_and_b32 v22, 2, v22
    v_xor_b32 v2, v2, v22
    v_lshlrev_b32 v2, 4, v2
    v_mul_lo_u32 v3, v3, s65
    v_add_u32 v2, v2, v3
    v_add_u32 v2, s63, v2
    v_subrev_u32 v4, 0, v2
    v_add_u32 v2, 64, v1
    v_mul_lo_u32 v3, v2, s64
    v_lshrrev_b32 v3, 16, v3
    v_mul_u32_u24 v22, 28, v3
    v_sub_u32 v2, v2, v22
    v_lshrrev_b32 v22, 2, v3
    v_and_b32 v22, 2, v22
    v_xor_b32 v2, v2, v22
    v_lshlrev_b32 v2, 4, v2
    v_mul_lo_u32 v3, v3, s65
    v_add_u32 v2, v2, v3
    v_add_u32 v2, s63, v2
    v_subrev_u32 v5, 1024, v2
    v_add_u32 v2, 128, v1
    v_mul_lo_u32 v3, v2, s64
    v_lshrrev_b32 v3, 16, v3
    v_mul_u32_u24 v22, 28, v3
    v_sub_u32 v2, v2, v22
    v_lshrrev_b32 v22, 2, v3
    v_and_b32 v22, 2, v22
    v_xor_b32 v2, v2, v22
    v_lshlrev_b32 v2, 4, v2
    v_mul_lo_u32 v3, v3, s65
    v_add_u32 v2, v2, v3
    v_add_u32 v2, s63, v2
    v_subrev_u32 v6, 2048, v2
    v_add_u32 v2, 192, v1
    v_mul_lo_u32 v3, v2, s64
    v_lshrrev_b32 v3, 16, v3
    v_mul_u32_u24 v22, 28, v3
    v_sub_u32 v2, v2, v22
    v_lshrrev_b32 v22, 2, v3
    v_and_b32 v22, 2, v22
    v_xor_b32 v2, v2, v22
    v_lshlrev_b32 v2, 4, v2
    v_mul_lo_u32 v3, v3, s65
    v_add_u32 v2, v2, v3
    v_add_u32 v2, s63, v2
    v_subrev_u32 v7, 3072, v2
    v_add_u32 v2, 256, v1
    v_mul_lo_u32 v3, v2, s64
    v_lshrrev_b32 v3, 16, v3
    v_mul_u32_u24 v22, 28, v3
    v_sub_u32 v2, v2, v22
    v_lshrrev_b32 v22, 2, v3
    v_and_b32 v22, 2, v22
    v_xor_b32 v2, v2, v22
    v_lshlrev_b32 v2, 4, v2
    v_mul_lo_u32 v3, v3, s65
    v_add_u32 v2, v2, v3
    v_add_u32 v2, s63, v2
    v_subrev_u32 v8, 0, v2
    v_add_u32 v2, 320, v1
    v_mul_lo_u32 v3, v2, s64
    v_lshrrev_b32 v3, 16, v3
    v_mul_u32_u24 v22, 28, v3
    v_sub_u32 v2, v2, v22
    v_lshrrev_b32 v22, 2, v3
    v_and_b32 v22, 2, v22
    v_xor_b32 v2, v2, v22
    v_lshlrev_b32 v2, 4, v2
    v_mul_lo_u32 v3, v3, s65
    v_add_u32 v2, v2, v3
    v_add_u32 v2, s63, v2
    v_subrev_u32 v9, 1024, v2
    v_add_u32 v2, 384, v1
    v_mul_lo_u32 v3, v2, s64
    v_lshrrev_b32 v3, 16, v3
    v_mul_u32_u24 v22, 28, v3
    v_sub_u32 v2, v2, v22
    v_lshrrev_b32 v22, 2, v3
    v_and_b32 v22, 2, v22
    v_xor_b32 v2, v2, v22
    v_lshlrev_b32 v2, 4, v2
    v_mul_lo_u32 v3, v3, s65
    v_add_u32 v2, v2, v3
    v_add_u32 v2, s63, v2
    v_subrev_u32 v10, 2048, v2
    s_mov_b32 s46, 0
    s_mov_b32 s44, 0
    s_add_u32 m0, s44, 16384
    s_add_u32 s47, s46, 0
    buffer_load_dwordx4 v4, s[28:31], s47 offen offset:0 lds
    buffer_load_dwordx4 v5, s[28:31], s47 offen offset:1024 lds
    buffer_load_dwordx4 v6, s[28:31], s47 offen offset:2048 lds
    buffer_load_dwordx4 v7, s[28:31], s47 offen offset:3072 lds
    s_add_u32 m0, s44, 20480
    s_nop 0
    buffer_load_dwordx4 v8, s[28:31], s47 offen offset:0 lds
    buffer_load_dwordx4 v9, s[28:31], s47 offen offset:1024 lds
    buffer_load_dwordx4 v10, s[28:31], s47 offen offset:2048 lds
    s_add_u32 m0, s44, 23552
    s_add_u32 s47, s46, 114688
    buffer_load_dwordx4 v4, s[28:31], s47 offen offset:0 lds
    buffer_load_dwordx4 v5, s[28:31], s47 offen offset:1024 lds
    buffer_load_dwordx4 v6, s[28:31], s47 offen offset:2048 lds
    buffer_load_dwordx4 v7, s[28:31], s47 offen offset:3072 lds
    s_add_u32 m0, s44, 27648
    s_nop 0
    buffer_load_dwordx4 v8, s[28:31], s47 offen offset:0 lds
    buffer_load_dwordx4 v9, s[28:31], s47 offen offset:1024 lds
    buffer_load_dwordx4 v10, s[28:31], s47 offen offset:2048 lds
    s_add_u32 m0, s44, 30720
    s_add_u32 s47, s46, 229376
    buffer_load_dwordx4 v4, s[28:31], s47 offen offset:0 lds
    buffer_load_dwordx4 v5, s[28:31], s47 offen offset:1024 lds
    buffer_load_dwordx4 v6, s[28:31], s47 offen offset:2048 lds
    buffer_load_dwordx4 v7, s[28:31], s47 offen offset:3072 lds
    s_add_u32 m0, s44, 34816
    s_nop 0
    buffer_load_dwordx4 v8, s[28:31], s47 offen offset:0 lds
    buffer_load_dwordx4 v9, s[28:31], s47 offen offset:1024 lds
    buffer_load_dwordx4 v10, s[28:31], s47 offen offset:2048 lds
    s_add_u32 s46, s46, 458752
    s_add_u32 s44, s44, 45056
    s_cmp_eq_u32 s44, 135168
    s_cselect_b32 s44, 0, s44
    s_barrier
    s_add_u32 m0, s44, 16384
    s_add_u32 s47, s46, 0
    buffer_load_dwordx4 v4, s[28:31], s47 offen offset:0 lds
    buffer_load_dwordx4 v5, s[28:31], s47 offen offset:1024 lds
    buffer_load_dwordx4 v6, s[28:31], s47 offen offset:2048 lds
    buffer_load_dwordx4 v7, s[28:31], s47 offen offset:3072 lds
    s_add_u32 m0, s44, 20480
    s_nop 0
    buffer_load_dwordx4 v8, s[28:31], s47 offen offset:0 lds
    buffer_load_dwordx4 v9, s[28:31], s47 offen offset:1024 lds
    buffer_load_dwordx4 v10, s[28:31], s47 offen offset:2048 lds
    s_add_u32 m0, s44, 23552
    s_add_u32 s47, s46, 114688
    buffer_load_dwordx4 v4, s[28:31], s47 offen offset:0 lds
    buffer_load_dwordx4 v5, s[28:31], s47 offen offset:1024 lds
    buffer_load_dwordx4 v6, s[28:31], s47 offen offset:2048 lds
    buffer_load_dwordx4 v7, s[28:31], s47 offen offset:3072 lds
    s_add_u32 m0, s44, 27648
    s_nop 0
    buffer_load_dwordx4 v8, s[28:31], s47 offen offset:0 lds
    buffer_load_dwordx4 v9, s[28:31], s47 offen offset:1024 lds
    buffer_load_dwordx4 v10, s[28:31], s47 offen offset:2048 lds
    s_add_u32 m0, s44, 30720
    s_add_u32 s47, s46, 229376
    buffer_load_dwordx4 v4, s[28:31], s47 offen offset:0 lds
    buffer_load_dwordx4 v5, s[28:31], s47 offen offset:1024 lds
    buffer_load_dwordx4 v6, s[28:31], s47 offen offset:2048 lds
    buffer_load_dwordx4 v7, s[28:31], s47 offen offset:3072 lds
    s_add_u32 m0, s44, 34816
    s_nop 0
    buffer_load_dwordx4 v8, s[28:31], s47 offen offset:0 lds
    buffer_load_dwordx4 v9, s[28:31], s47 offen offset:1024 lds
    buffer_load_dwordx4 v10, s[28:31], s47 offen offset:2048 lds
    s_add_u32 s46, s46, 458752
    s_add_u32 s44, s44, 45056
    s_cmp_eq_u32 s44, 135168
    s_cselect_b32 s44, 0, s44
    s_lshl_b32 s63, s54, 7
    s_movk_i32 s64, 2731
    s_movk_i32 s65, 6144
    v_add_u32 v2, 0, v1
    v_mul_lo_u32 v3, v2, s64
    v_lshrrev_b32 v3, 16, v3
    v_mul_u32_u24 v22, 24, v3
    v_sub_u32 v2, v2, v22
    v_and_b32 v22, 2, v3
    v_xor_b32 v2, v2, v22
    v_lshrrev_b32 v22, 1, v3
    v_and_b32 v22, 4, v22
    v_xor_b32 v2, v2, v22
    v_lshrrev_b32 v22, 3, v2
    v_lshlrev_b32 v22, 11, v22
    v_and_b32 v2, 7, v2
    v_lshlrev_b32 v2, 4, v2
    v_add_u32 v2, v2, v22
    v_mul_lo_u32 v3, v3, s65
    v_add_u32 v2, v2, v3
    v_add_u32 v2, s63, v2
    v_subrev_u32 v11, 0, v2
    v_add_u32 v2, 64, v1
    v_mul_lo_u32 v3, v2, s64
    v_lshrrev_b32 v3, 16, v3
    v_mul_u32_u24 v22, 24, v3
    v_sub_u32 v2, v2, v22
    v_and_b32 v22, 2, v3
    v_xor_b32 v2, v2, v22
    v_lshrrev_b32 v22, 1, v3
    v_and_b32 v22, 4, v22
    v_xor_b32 v2, v2, v22
    v_lshrrev_b32 v22, 3, v2
    v_lshlrev_b32 v22, 11, v22
    v_and_b32 v2, 7, v2
    v_lshlrev_b32 v2, 4, v2
    v_add_u32 v2, v2, v22
    v_mul_lo_u32 v3, v3, s65
    v_add_u32 v2, v2, v3
    v_add_u32 v2, s63, v2
    v_subrev_u32 v12, 1024, v2
    v_add_u32 v2, 128, v1
    v_mul_lo_u32 v3, v2, s64
    v_lshrrev_b32 v3, 16, v3
    v_mul_u32_u24 v22, 24, v3
    v_sub_u32 v2, v2, v22
    v_and_b32 v22, 2, v3
    v_xor_b32 v2, v2, v22
    v_lshrrev_b32 v22, 1, v3
    v_and_b32 v22, 4, v22
    v_xor_b32 v2, v2, v22
    v_lshrrev_b32 v22, 3, v2
    v_lshlrev_b32 v22, 11, v22
    v_and_b32 v2, 7, v2
    v_lshlrev_b32 v2, 4, v2
    v_add_u32 v2, v2, v22
    v_mul_lo_u32 v3, v3, s65
    v_add_u32 v2, v2, v3
    v_add_u32 v2, s63, v2
    v_subrev_u32 v13, 2048, v2
    v_add_u32 v2, 192, v1
    v_mul_lo_u32 v3, v2, s64
    v_lshrrev_b32 v3, 16, v3
    v_mul_u32_u24 v22, 24, v3
    v_sub_u32 v2, v2, v22
    v_and_b32 v22, 2, v3
    v_xor_b32 v2, v2, v22
    v_lshrrev_b32 v22, 1, v3
    v_and_b32 v22, 4, v22
    v_xor_b32 v2, v2, v22
    v_lshrrev_b32 v22, 3, v2
    v_lshlrev_b32 v22, 11, v22
    v_and_b32 v2, 7, v2
    v_lshlrev_b32 v2, 4, v2
    v_add_u32 v2, v2, v22
    v_mul_lo_u32 v3, v3, s65
    v_add_u32 v2, v2, v3
    v_add_u32 v2, s63, v2
    v_subrev_u32 v14, 3072, v2
    v_add_u32 v2, 256, v1
    v_mul_lo_u32 v3, v2, s64
    v_lshrrev_b32 v3, 16, v3
    v_mul_u32_u24 v22, 24, v3
    v_sub_u32 v2, v2, v22
    v_and_b32 v22, 2, v3
    v_xor_b32 v2, v2, v22
    v_lshrrev_b32 v22, 1, v3
    v_and_b32 v22, 4, v22
    v_xor_b32 v2, v2, v22
    v_lshrrev_b32 v22, 3, v2
    v_lshlrev_b32 v22, 11, v22
    v_and_b32 v2, 7, v2
    v_lshlrev_b32 v2, 4, v2
    v_add_u32 v2, v2, v22
    v_mul_lo_u32 v3, v3, s65
    v_add_u32 v2, v2, v3
    v_add_u32 v2, s63, v2
    v_subrev_u32 v15, 0, v2
    v_add_u32 v2, 320, v1
    v_mul_lo_u32 v3, v2, s64
    v_lshrrev_b32 v3, 16, v3
    v_mul_u32_u24 v22, 24, v3
    v_sub_u32 v2, v2, v22
    v_and_b32 v22, 2, v3
    v_xor_b32 v2, v2, v22
    v_lshrrev_b32 v22, 1, v3
    v_and_b32 v22, 4, v22
    v_xor_b32 v2, v2, v22
    v_lshrrev_b32 v22, 3, v2
    v_lshlrev_b32 v22, 11, v22
    v_and_b32 v2, 7, v2
    v_lshlrev_b32 v2, 4, v2
    v_add_u32 v2, v2, v22
    v_mul_lo_u32 v3, v3, s65
    v_add_u32 v2, v2, v3
    v_add_u32 v2, s63, v2
    v_subrev_u32 v16, 1024, v2
    v_lshrrev_b32 v2, 4, v1
    v_and_b32 v3, 15, v1
    s_lshl_b32 s63, s58, 8
    v_add_u32 v22, 0, v2
    v_lshlrev_b32 v22, 1, v22
    v_xor_b32 v22, v22, v3
    v_lshlrev_b32 v22, 4, v22
    v_add_u32 v23, 0, v2
    v_lshlrev_b32 v23, 11, v23
    v_add_u32 v22, v22, v23
    v_add_u32 v22, s63, v22
    v_subrev_u32 v17, 0, v22
    v_add_u32 v22, 4, v2
    v_lshlrev_b32 v22, 1, v22
    v_xor_b32 v22, v22, v3
    v_lshlrev_b32 v22, 4, v22
    v_add_u32 v23, 4, v2
    v_lshlrev_b32 v23, 11, v23
    v_add_u32 v22, v22, v23
    v_add_u32 v22, s63, v22
    v_subrev_u32 v18, 1024, v22
    v_add_u32 v22, 0, v2
    v_lshlrev_b32 v22, 1, v22
    v_xor_b32 v22, v22, v3
    v_lshlrev_b32 v22, 4, v22
    v_add_u32 v23, 8, v2
    v_lshlrev_b32 v23, 11, v23
    v_add_u32 v22, v22, v23
    v_add_u32 v22, s63, v22
    v_subrev_u32 v19, 2048, v22
    v_add_u32 v22, 4, v2
    v_lshlrev_b32 v22, 1, v22
    v_xor_b32 v22, v22, v3
    v_lshlrev_b32 v22, 4, v22
    v_add_u32 v23, 12, v2
    v_lshlrev_b32 v23, 11, v23
    v_add_u32 v22, v22, v23
    v_add_u32 v22, s63, v22
    v_subrev_u32 v20, 3072, v22
    s_add_u32 m0, s44, 16384
    s_add_u32 s47, s46, 0
    buffer_load_dwordx4 v4, s[28:31], s47 offen offset:0 lds
    buffer_load_dwordx4 v5, s[28:31], s47 offen offset:1024 lds
    buffer_load_dwordx4 v6, s[28:31], s47 offen offset:2048 lds
    buffer_load_dwordx4 v7, s[28:31], s47 offen offset:3072 lds
    s_add_u32 m0, s44, 20480
    s_nop 0
    buffer_load_dwordx4 v8, s[28:31], s47 offen offset:0 lds
    buffer_load_dwordx4 v9, s[28:31], s47 offen offset:1024 lds
    buffer_load_dwordx4 v10, s[28:31], s47 offen offset:2048 lds
    s_add_u32 m0, s44, 23552
    s_add_u32 s47, s46, 114688
    buffer_load_dwordx4 v4, s[28:31], s47 offen offset:0 lds
    buffer_load_dwordx4 v5, s[28:31], s47 offen offset:1024 lds
    buffer_load_dwordx4 v6, s[28:31], s47 offen offset:2048 lds
    buffer_load_dwordx4 v7, s[28:31], s47 offen offset:3072 lds
    s_add_u32 m0, s44, 27648
    s_nop 0
    buffer_load_dwordx4 v8, s[28:31], s47 offen offset:0 lds
    buffer_load_dwordx4 v9, s[28:31], s47 offen offset:1024 lds
    buffer_load_dwordx4 v10, s[28:31], s47 offen offset:2048 lds
    s_add_u32 m0, s44, 30720
    s_add_u32 s47, s46, 229376
    buffer_load_dwordx4 v4, s[28:31], s47 offen offset:0 lds
    buffer_load_dwordx4 v5, s[28:31], s47 offen offset:1024 lds
    buffer_load_dwordx4 v6, s[28:31], s47 offen offset:2048 lds
    buffer_load_dwordx4 v7, s[28:31], s47 offen offset:3072 lds
    s_add_u32 m0, s44, 34816
    s_nop 0
    buffer_load_dwordx4 v8, s[28:31], s47 offen offset:0 lds
    buffer_load_dwordx4 v9, s[28:31], s47 offen offset:1024 lds
    buffer_load_dwordx4 v10, s[28:31], s47 offen offset:2048 lds
    s_add_u32 s46, s46, 458752
    s_add_u32 s44, s44, 45056
    s_cmp_eq_u32 s44, 135168
    s_cselect_b32 s44, 0, s44
    s_waitcnt vmcnt(42)
    s_barrier
    s_mov_b32 s61, 13
LL_1:
    s_waitcnt vmcnt(21)
    s_barrier
    s_add_u32 m0, s44, 16384
    s_add_u32 s47, s46, 0
    buffer_load_dwordx4 v4, s[28:31], s47 offen offset:0 lds
    buffer_load_dwordx4 v5, s[28:31], s47 offen offset:1024 lds
    buffer_load_dwordx4 v6, s[28:31], s47 offen offset:2048 lds
    buffer_load_dwordx4 v7, s[28:31], s47 offen offset:3072 lds
    s_add_u32 m0, s44, 20480
    s_nop 0
    buffer_load_dwordx4 v8, s[28:31], s47 offen offset:0 lds
    buffer_load_dwordx4 v9, s[28:31], s47 offen offset:1024 lds
    buffer_load_dwordx4 v10, s[28:31], s47 offen offset:2048 lds
    s_add_u32 m0, s44, 23552
    s_add_u32 s47, s46, 114688
    buffer_load_dwordx4 v4, s[28:31], s47 offen offset:0 lds
    buffer_load_dwordx4 v5, s[28:31], s47 offen offset:1024 lds
    buffer_load_dwordx4 v6, s[28:31], s47 offen offset:2048 lds
    buffer_load_dwordx4 v7, s[28:31], s47 offen offset:3072 lds
    s_add_u32 m0, s44, 27648
    s_nop 0
    buffer_load_dwordx4 v8, s[28:31], s47 offen offset:0 lds
    buffer_load_dwordx4 v9, s[28:31], s47 offen offset:1024 lds
    buffer_load_dwordx4 v10, s[28:31], s47 offen offset:2048 lds
    s_add_u32 m0, s44, 30720
    s_add_u32 s47, s46, 229376
    buffer_load_dwordx4 v4, s[28:31], s47 offen offset:0 lds
    buffer_load_dwordx4 v5, s[28:31], s47 offen offset:1024 lds
    buffer_load_dwordx4 v6, s[28:31], s47 offen offset:2048 lds
    buffer_load_dwordx4 v7, s[28:31], s47 offen offset:3072 lds
    s_add_u32 m0, s44, 34816
    s_nop 0
    buffer_load_dwordx4 v8, s[28:31], s47 offen offset:0 lds
    buffer_load_dwordx4 v9, s[28:31], s47 offen offset:1024 lds
    buffer_load_dwordx4 v10, s[28:31], s47 offen offset:2048 lds
    s_add_u32 s46, s46, 458752
    s_add_u32 s44, s44, 45056
    s_cmp_eq_u32 s44, 135168
    s_cselect_b32 s44, 0, s44
    s_sub_u32 s61, s61, 1
    s_cmp_lg_u32 s61, 0
    s_cbranch_scc1 LL_1
    s_mov_b32 s46, 0
    s_waitcnt vmcnt(21)
    s_barrier
    s_add_u32 m0, s44, 18432
    s_add_u32 s47, s46, 0
    buffer_load_dwordx4 v11, s[32:35], s47 offen offset:0 lds
    buffer_load_dwordx4 v12, s[32:35], s47 offen offset:1024 lds
    buffer_load_dwordx4 v13, s[32:35], s47 offen offset:2048 lds
    buffer_load_dwordx4 v14, s[32:35], s47 offen offset:3072 lds
    s_add_u32 m0, s44, 22528
    s_add_u32 s47, s46, 0
    buffer_load_dwordx4 v15, s[32:35], s47 offen offset:0 lds
    buffer_load_dwordx4 v16, s[32:35], s47 offen offset:1024 lds
    s_add_u32 m0, s44, 24576
    s_add_u32 s47, s46, 98304
    buffer_load_dwordx4 v11, s[32:35], s47 offen offset:0 lds
    buffer_load_dwordx4 v12, s[32:35], s47 offen offset:1024 lds
    buffer_load_dwordx4 v13, s[32:35], s47 offen offset:2048 lds
    buffer_load_dwordx4 v14, s[32:35], s47 offen offset:3072 lds
    s_add_u32 m0, s44, 28672
    s_add_u32 s47, s46, 98304
    buffer_load_dwordx4 v15, s[32:35], s47 offen offset:0 lds
    buffer_load_dwordx4 v16, s[32:35], s47 offen offset:1024 lds
    s_add_u32 m0, s44, 30720
    s_add_u32 s47, s46, 196608
    buffer_load_dwordx4 v11, s[32:35], s47 offen offset:0 lds
    buffer_load_dwordx4 v12, s[32:35], s47 offen offset:1024 lds
    buffer_load_dwordx4 v13, s[32:35], s47 offen offset:2048 lds
    buffer_load_dwordx4 v14, s[32:35], s47 offen offset:3072 lds
    s_add_u32 m0, s44, 34816
    s_add_u32 s47, s46, 196608
    buffer_load_dwordx4 v15, s[32:35], s47 offen offset:0 lds
    buffer_load_dwordx4 v16, s[32:35], s47 offen offset:1024 lds
    s_add_u32 m0, s44, 40960
    s_add_u32 s47, s46, 294912
    buffer_load_dwordx4 v15, s[32:35], s47 offen offset:0 lds
    buffer_load_dwordx4 v16, s[32:35], s47 offen offset:1024 lds
    s_add_u32 s46, s46, 393216
    s_add_u32 s44, s44, 45056
    s_cmp_eq_u32 s44, 135168
    s_cselect_b32 s44, 0, s44
    s_mov_b32 s61, 15
LL_3:
    s_waitcnt vmcnt(20)
    s_barrier
    s_add_u32 m0, s44, 18432
    s_add_u32 s47, s46, 0
    buffer_load_dwordx4 v11, s[32:35], s47 offen offset:0 lds
    buffer_load_dwordx4 v12, s[32:35], s47 offen offset:1024 lds
    buffer_load_dwordx4 v13, s[32:35], s47 offen offset:2048 lds
    buffer_load_dwordx4 v14, s[32:35], s47 offen offset:3072 lds
    s_add_u32 m0, s44, 22528
    s_add_u32 s47, s46, 0
    buffer_load_dwordx4 v15, s[32:35], s47 offen offset:0 lds
    buffer_load_dwordx4 v16, s[32:35], s47 offen offset:1024 lds
    s_add_u32 m0, s44, 24576
    s_add_u32 s47, s46, 98304
    buffer_load_dwordx4 v11, s[32:35], s47 offen offset:0 lds
    buffer_load_dwordx4 v12, s[32:35], s47 offen offset:1024 lds
    buffer_load_dwordx4 v13, s[32:35], s47 offen offset:2048 lds
    buffer_load_dwordx4 v14, s[32:35], s47 offen offset:3072 lds
    s_add_u32 m0, s44, 28672
    s_add_u32 s47, s46, 98304
    buffer_load_dwordx4 v15, s[32:35], s47 offen offset:0 lds
    buffer_load_dwordx4 v16, s[32:35], s47 offen offset:1024 lds
    s_add_u32 m0, s44, 30720
    s_add_u32 s47, s46, 196608
    buffer_load_dwordx4 v11, s[32:35], s47 offen offset:0 lds
    buffer_load_dwordx4 v12, s[32:35], s47 offen offset:1024 lds
    buffer_load_dwordx4 v13, s[32:35], s47 offen offset:2048 lds
    buffer_load_dwordx4 v14, s[32:35], s47 offen offset:3072 lds
    s_add_u32 m0, s44, 34816
    s_add_u32 s47, s46, 196608
    buffer_load_dwordx4 v15, s[32:35], s47 offen offset:0 lds
    buffer_load_dwordx4 v16, s[32:35], s47 offen offset:1024 lds
    s_add_u32 m0, s44, 40960
    s_add_u32 s47, s46, 294912
    buffer_load_dwordx4 v15, s[32:35], s47 offen offset:0 lds
    buffer_load_dwordx4 v16, s[32:35], s47 offen offset:1024 lds
    s_add_u32 s46, s46, 393216
    s_add_u32 s44, s44, 45056
    s_cmp_eq_u32 s44, 135168
    s_cselect_b32 s44, 0, s44
    s_sub_u32 s61, s61, 1
    s_cmp_lg_u32 s61, 0
    s_cbranch_scc1 LL_3
    s_cmp_eq_u32 s57, 0
    s_cbranch_scc0 LB_4
    s_mov_b32 s44, 98304
    s_mov_b32 s46, 0
    s_waitcnt vmcnt(20)
    s_barrier
    s_add_u32 m0, s44, 16384
    s_add_u32 s47, s46, 0
    buffer_load_dwordx4 v17, s[36:39], s47 offen offset:0 lds
    buffer_load_dwordx4 v18, s[36:39], s47 offen offset:1024 lds
    buffer_load_dwordx4 v19, s[36:39], s47 offen offset:2048 lds
    buffer_load_dwordx4 v20, s[36:39], s47 offen offset:3072 lds
    s_add_u32 m0, s44, 20480
    s_add_u32 s47, s46, 32768
    buffer_load_dwordx4 v17, s[36:39], s47 offen offset:0 lds
    buffer_load_dwordx4 v18, s[36:39], s47 offen offset:1024 lds
    buffer_load_dwordx4 v19, s[36:39], s47 offen offset:2048 lds
    buffer_load_dwordx4 v20, s[36:39], s47 offen offset:3072 lds
    s_add_u32 m0, s44, 24576
    s_add_u32 s47, s46, 65536
    buffer_load_dwordx4 v17, s[36:39], s47 offen offset:0 lds
    buffer_load_dwordx4 v18, s[36:39], s47 offen offset:1024 lds
    buffer_load_dwordx4 v19, s[36:39], s47 offen offset:2048 lds
    buffer_load_dwordx4 v20, s[36:39], s47 offen offset:3072 lds
    s_waitcnt vmcnt(59)
    s_add_u32 m0, s44, 28672
    s_add_u32 s47, s46, 98304
    buffer_load_dwordx4 v17, s[36:39], s47 offen offset:0 lds
    buffer_load_dwordx4 v18, s[36:39], s47 offen offset:1024 lds
    buffer_load_dwordx4 v19, s[36:39], s47 offen offset:2048 lds
    buffer_load_dwordx4 v20, s[36:39], s47 offen offset:3072 lds
    s_add_u32 s46, s46, 131072
    s_add_u32 s44, s44, 32768
    s_cmp_eq_u32 s44, 163840
    s_cselect_b32 s44, 0, s44
    s_waitcnt vmcnt(16)
    s_barrier
    s_add_u32 m0, s44, 16384
    s_add_u32 s47, s46, 0
    buffer_load_dwordx4 v17, s[36:39], s47 offen offset:0 lds
    buffer_load_dwordx4 v18, s[36:39], s47 offen offset:1024 lds
    buffer_load_dwordx4 v19, s[36:39], s47 offen offset:2048 lds
    buffer_load_dwordx4 v20, s[36:39], s47 offen offset:3072 lds
    s_add_u32 m0, s44, 20480
    s_add_u32 s47, s46, 32768
    buffer_load_dwordx4 v17, s[36:39], s47 offen offset:0 lds
    buffer_load_dwordx4 v18, s[36:39], s47 offen offset:1024 lds
    buffer_load_dwordx4 v19, s[36:39], s47 offen offset:2048 lds
    buffer_load_dwordx4 v20, s[36:39], s47 offen offset:3072 lds
    s_add_u32 m0, s44, 24576
    s_add_u32 s47, s46, 65536
    buffer_load_dwordx4 v17, s[36:39], s47 offen offset:0 lds
    buffer_load_dwordx4 v18, s[36:39], s47 offen offset:1024 lds
    buffer_load_dwordx4 v19, s[36:39], s47 offen offset:2048 lds
    buffer_load_dwordx4 v20, s[36:39], s47 offen offset:3072 lds
    s_waitcnt vmcnt(59)
    s_add_u32 m0, s44, 28672
    s_add_u32 s47, s46, 98304
    buffer_load_dwordx4 v17, s[36:39], s47 offen offset:0 lds
    buffer_load_dwordx4 v18, s[36:39], s47 offen offset:1024 lds
    buffer_load_dwordx4 v19, s[36:39], s47 offen offset:2048 lds
    buffer_load_dwordx4 v20, s[36:39], s47 offen offset:3072 lds
    s_add_u32 s46, s46, 131072
    s_add_u32 s44, s44, 32768
    s_cmp_eq_u32 s44, 163840
    s_cselect_b32 s44, 0, s44
    s_add_u32 m0, s44, 16384
    s_add_u32 s47, s46, 0
    buffer_load_dwordx4 v17, s[36:39], s47 offen offset:0 lds
    buffer_load_dwordx4 v18, s[36:39], s47 offen offset:1024 lds
    buffer_load_dwordx4 v19, s[36:39], s47 offen offset:2048 lds
    buffer_load_dwordx4 v20, s[36:39], s47 offen offset:3072 lds
    s_add_u32 m0, s44, 20480
    s_add_u32 s47, s46, 32768
    buffer_load_dwordx4 v17, s[36:39], s47 offen offset:0 lds
    buffer_load_dwordx4 v18, s[36:39], s47 offen offset:1024 lds
    buffer_load_dwordx4 v19, s[36:39], s47 offen offset:2048 lds
    buffer_load_dwordx4 v20, s[36:39], s47 offen offset:3072 lds
    s_add_u32 m0, s44, 24576
    s_add_u32 s47, s46, 65536
    buffer_load_dwordx4 v17, s[36:39], s47 offen offset:0 lds
    buffer_load_dwordx4 v18, s[36:39], s47 offen offset:1024 lds
    buffer_load_dwordx4 v19, s[36:39], s47 offen offset:2048 lds
    buffer_load_dwordx4 v20, s[36:39], s47 offen offset:3072 lds
    s_waitcnt vmcnt(59)
    s_add_u32 m0, s44, 28672
    s_add_u32 s47, s46, 98304
    buffer_load_dwordx4 v17, s[36:39], s47 offen offset:0 lds
    buffer_load_dwordx4 v18, s[36:39], s47 offen offset:1024 lds
    buffer_load_dwordx4 v19, s[36:39], s47 offen offset:2048 lds
    buffer_load_dwordx4 v20, s[36:39], s47 offen offset:3072 lds
    s_add_u32 s46, s46, 131072
    s_add_u32 s44, s44, 32768
    s_cmp_eq_u32 s44, 163840
    s_cselect_b32 s44, 0, s44
    s_waitcnt vmcnt(32)
    s_barrier
    s_add_u32 m0, s44, 16384
    s_add_u32 s47, s46, 0
    buffer_load_dwordx4 v17, s[36:39], s47 offen offset:0 lds
    buffer_load_dwordx4 v18, s[36:39], s47 offen offset:1024 lds
    buffer_load_dwordx4 v19, s[36:39], s47 offen offset:2048 lds
    buffer_load_dwordx4 v20, s[36:39], s47 offen offset:3072 lds
    s_add_u32 m0, s44, 20480
    s_add_u32 s47, s46, 32768
    buffer_load_dwordx4 v17, s[36:39], s47 offen offset:0 lds
    buffer_load_dwordx4 v18, s[36:39], s47 offen offset:1024 lds
    buffer_load_dwordx4 v19, s[36:39], s47 offen offset:2048 lds
    buffer_load_dwordx4 v20, s[36:39], s47 offen offset:3072 lds
    s_add_u32 m0, s44, 24576
    s_add_u32 s47, s46, 65536
    buffer_load_dwordx4 v17, s[36:39], s47 offen offset:0 lds
    buffer_load_dwordx4 v18, s[36:39], s47 offen offset:1024 lds
    buffer_load_dwordx4 v19, s[36:39], s47 offen offset:2048 lds
    buffer_load_dwordx4 v20, s[36:39], s47 offen offset:3072 lds
    s_waitcnt vmcnt(59)
    s_add_u32 m0, s44, 28672
    s_add_u32 s47, s46, 98304
    buffer_load_dwordx4 v17, s[36:39], s47 offen offset:0 lds
    buffer_load_dwordx4 v18, s[36:39], s47 offen offset:1024 lds
    buffer_load_dwordx4 v19, s[36:39], s47 offen offset:2048 lds
    buffer_load_dwordx4 v20, s[36:39], s47 offen offset:3072 lds
    s_add_u32 s46, s46, 131072
    s_add_u32 s44, s44, 32768
    s_cmp_eq_u32 s44, 163840
    s_cselect_b32 s44, 0, s44
    s_add_u32 m0, s44, 16384
    s_add_u32 s47, s46, 0
    buffer_load_dwordx4 v17, s[36:39], s47 offen offset:0 lds
    buffer_load_dwordx4 v18, s[36:39], s47 offen offset:1024 lds
    buffer_load_dwordx4 v19, s[36:39], s47 offen offset:2048 lds
    buffer_load_dwordx4 v20, s[36:39], s47 offen offset:3072 lds
    s_add_u32 m0, s44, 20480
    s_add_u32 s47, s46, 32768
    buffer_load_dwordx4 v17, s[36:39], s47 offen offset:0 lds
    buffer_load_dwordx4 v18, s[36:39], s47 offen offset:1024 lds
    buffer_load_dwordx4 v19, s[36:39], s47 offen offset:2048 lds
    buffer_load_dwordx4 v20, s[36:39], s47 offen offset:3072 lds
    s_add_u32 m0, s44, 24576
    s_add_u32 s47, s46, 65536
    buffer_load_dwordx4 v17, s[36:39], s47 offen offset:0 lds
    buffer_load_dwordx4 v18, s[36:39], s47 offen offset:1024 lds
    buffer_load_dwordx4 v19, s[36:39], s47 offen offset:2048 lds
    buffer_load_dwordx4 v20, s[36:39], s47 offen offset:3072 lds
    s_waitcnt vmcnt(59)
    s_add_u32 m0, s44, 28672
    s_add_u32 s47, s46, 98304
    buffer_load_dwordx4 v17, s[36:39], s47 offen offset:0 lds
    buffer_load_dwordx4 v18, s[36:39], s47 offen offset:1024 lds
    buffer_load_dwordx4 v19, s[36:39], s47 offen offset:2048 lds
    buffer_load_dwordx4 v20, s[36:39], s47 offen offset:3072 lds
    s_add_u32 s46, s46, 131072
    s_add_u32 s44, s44, 32768
    s_cmp_eq_u32 s44, 163840
    s_cselect_b32 s44, 0, s44
    s_mov_b32 s61, 15
LL_9:
    s_waitcnt vmcnt(48)
    s_barrier
    s_add_u32 m0, s44, 16384
    s_add_u32 s47, s46, 0
    buffer_load_dwordx4 v17, s[36:39], s47 offen offset:0 lds
    buffer_load_dwordx4 v18, s[36:39], s47 offen offset:1024 lds
    buffer_load_dwordx4 v19, s[36:39], s47 offen offset:2048 lds
    buffer_load_dwordx4 v20, s[36:39], s47 offen offset:3072 lds
    s_add_u32 m0, s44, 20480
    s_add_u32 s47, s46, 32768
    buffer_load_dwordx4 v17, s[36:39], s47 offen offset:0 lds
    buffer_load_dwordx4 v18, s[36:39], s47 offen offset:1024 lds
    buffer_load_dwordx4 v19, s[36:39], s47 offen offset:2048 lds
    buffer_load_dwordx4 v20, s[36:39], s47 offen offset:3072 lds
    s_add_u32 m0, s44, 24576
    s_add_u32 s47, s46, 65536
    buffer_load_dwordx4 v17, s[36:39], s47 offen offset:0 lds
    buffer_load_dwordx4 v18, s[36:39], s47 offen offset:1024 lds
    buffer_load_dwordx4 v19, s[36:39], s47 offen offset:2048 lds
    buffer_load_dwordx4 v20, s[36:39], s47 offen offset:3072 lds
    s_waitcnt vmcnt(59)
    s_add_u32 m0, s44, 28672
    s_add_u32 s47, s46, 98304
    buffer_load_dwordx4 v17, s[36:39], s47 offen offset:0 lds
    buffer_load_dwordx4 v18, s[36:39], s47 offen offset:1024 lds
    buffer_load_dwordx4 v19, s[36:39], s47 offen offset:2048 lds
    buffer_load_dwordx4 v20, s[36:39], s47 offen offset:3072 lds
    s_add_u32 s46, s46, 131072
    s_add_u32 s44, s44, 32768
    s_cmp_eq_u32 s44, 163840
    s_cselect_b32 s44, 0, s44
    s_sub_u32 s61, s61, 1
    s_cmp_lg_u32 s61, 0
    s_cbranch_scc1 LL_9
    s_mov_b32 s46, 0
    s_mov_b32 s61, 16
LL_10:
    s_waitcnt vmcnt(48)
    s_barrier
    s_add_u32 m0, s44, 16384
    s_add_u32 s47, s46, 0
    buffer_load_dwordx4 v17, s[40:43], s47 offen offset:0 lds
    buffer_load_dwordx4 v18, s[40:43], s47 offen offset:1024 lds
    buffer_load_dwordx4 v19, s[40:43], s47 offen offset:2048 lds
    buffer_load_dwordx4 v20, s[40:43], s47 offen offset:3072 lds
    s_add_u32 m0, s44, 20480
    s_add_u32 s47, s46, 32768
    buffer_load_dwordx4 v17, s[40:43], s47 offen offset:0 lds
    buffer_load_dwordx4 v18, s[40:43], s47 offen offset:1024 lds
    buffer_load_dwordx4 v19, s[40:43], s47 offen offset:2048 lds
    buffer_load_dwordx4 v20, s[40:43], s47 offen offset:3072 lds
    s_add_u32 m0, s44, 24576
    s_add_u32 s47, s46, 65536
    buffer_load_dwordx4 v17, s[40:43], s47 offen offset:0 lds
    buffer_load_dwordx4 v18, s[40:43], s47 offen offset:1024 lds
    buffer_load_dwordx4 v19, s[40:43], s47 offen offset:2048 lds
    buffer_load_dwordx4 v20, s[40:43], s47 offen offset:3072 lds
    s_waitcnt vmcnt(59)
    s_add_u32 m0, s44, 28672
    s_add_u32 s47, s46, 98304
    buffer_load_dwordx4 v17, s[40:43], s47 offen offset:0 lds
    buffer_load_dwordx4 v18, s[40:43], s47 offen offset:1024 lds
    buffer_load_dwordx4 v19, s[40:43], s47 offen offset:2048 lds
    buffer_load_dwordx4 v20, s[40:43], s47 offen offset:3072 lds
    s_add_u32 s46, s46, 131072
    s_add_u32 s44, s44, 32768
    s_cmp_eq_u32 s44, 163840
    s_cselect_b32 s44, 0, s44
    s_sub_u32 s61, s61, 1
    s_cmp_lg_u32 s61, 0
    s_cbranch_scc1 LL_10
    s_waitcnt vmcnt(48)
    s_barrier
    s_waitcnt vmcnt(32)
    s_barrier
    s_waitcnt vmcnt(16)
    s_barrier
    s_waitcnt vmcnt(0)
    s_barrier
    s_branch LE_5
LB_4:
    s_mov_b32 s44, 98304
    s_mov_b32 s46, 2621440
    s_waitcnt vmcnt(20)
    s_barrier
    s_add_u32 m0, s44, 16384
    s_add_u32 s47, s46, 0
    buffer_load_dwordx4 v17, s[36:39], s47 offen offset:0 lds
    buffer_load_dwordx4 v18, s[36:39], s47 offen offset:1024 lds
    buffer_load_dwordx4 v19, s[36:39], s47 offen offset:2048 lds
    buffer_load_dwordx4 v20, s[36:39], s47 offen offset:3072 lds
    s_add_u32 m0, s44, 20480
    s_add_u32 s47, s46, 32768
    buffer_load_dwordx4 v17, s[36:39], s47 offen offset:0 lds
    buffer_load_dwordx4 v18, s[36:39], s47 offen offset:1024 lds
    buffer_load_dwordx4 v19, s[36:39], s47 offen offset:2048 lds
    buffer_load_dwordx4 v20, s[36:39], s47 offen offset:3072 lds
    s_add_u32 m0, s44, 24576
    s_add_u32 s47, s46, 65536
    buffer_load_dwordx4 v17, s[36:39], s47 offen offset:0 lds
    buffer_load_dwordx4 v18, s[36:39], s47 offen offset:1024 lds
    buffer_load_dwordx4 v19, s[36:39], s47 offen offset:2048 lds
    buffer_load_dwordx4 v20, s[36:39], s47 offen offset:3072 lds
    s_waitcnt vmcnt(59)
    s_add_u32 m0, s44, 28672
    s_add_u32 s47, s46, 98304
    buffer_load_dwordx4 v17, s[36:39], s47 offen offset:0 lds
    buffer_load_dwordx4 v18, s[36:39], s47 offen offset:1024 lds
    buffer_load_dwordx4 v19, s[36:39], s47 offen offset:2048 lds
    buffer_load_dwordx4 v20, s[36:39], s47 offen offset:3072 lds
    s_add_u32 s46, s46, 131072
    s_add_u32 s44, s44, 32768
    s_cmp_eq_u32 s44, 163840
    s_cselect_b32 s44, 0, s44
    s_waitcnt vmcnt(16)
    s_barrier
    s_add_u32 m0, s44, 16384
    s_add_u32 s47, s46, 0
    buffer_load_dwordx4 v17, s[36:39], s47 offen offset:0 lds
    buffer_load_dwordx4 v18, s[36:39], s47 offen offset:1024 lds
    buffer_load_dwordx4 v19, s[36:39], s47 offen offset:2048 lds
    buffer_load_dwordx4 v20, s[36:39], s47 offen offset:3072 lds
    s_add_u32 m0, s44, 20480
    s_add_u32 s47, s46, 32768
    buffer_load_dwordx4 v17, s[36:39], s47 offen offset:0 lds
    buffer_load_dwordx4 v18, s[36:39], s47 offen offset:1024 lds
    buffer_load_dwordx4 v19, s[36:39], s47 offen offset:2048 lds
    buffer_load_dwordx4 v20, s[36:39], s47 offen offset:3072 lds
    s_add_u32 m0, s44, 24576
    s_add_u32 s47, s46, 65536
    buffer_load_dwordx4 v17, s[36:39], s47 offen offset:0 lds
    buffer_load_dwordx4 v18, s[36:39], s47 offen offset:1024 lds
    buffer_load_dwordx4 v19, s[36:39], s47 offen offset:2048 lds
    buffer_load_dwordx4 v20, s[36:39], s47 offen offset:3072 lds
    s_waitcnt vmcnt(59)
    s_add_u32 m0, s44, 28672
    s_add_u32 s47, s46, 98304
    buffer_load_dwordx4 v17, s[36:39], s47 offen offset:0 lds
    buffer_load_dwordx4 v18, s[36:39], s47 offen offset:1024 lds
    buffer_load_dwordx4 v19, s[36:39], s47 offen offset:2048 lds
    buffer_load_dwordx4 v20, s[36:39], s47 offen offset:3072 lds
    s_add_u32 s46, s46, 131072
    s_add_u32 s44, s44, 32768
    s_cmp_eq_u32 s44, 163840
    s_cselect_b32 s44, 0, s44
    s_add_u32 m0, s44, 16384
    s_add_u32 s47, s46, 0
    buffer_load_dwordx4 v17, s[36:39], s47 offen offset:0 lds
    buffer_load_dwordx4 v18, s[36:39], s47 offen offset:1024 lds
    buffer_load_dwordx4 v19, s[36:39], s47 offen offset:2048 lds
    buffer_load_dwordx4 v20, s[36:39], s47 offen offset:3072 lds
    s_add_u32 m0, s44, 20480
    s_add_u32 s47, s46, 32768
    buffer_load_dwordx4 v17, s[36:39], s47 offen offset:0 lds
    buffer_load_dwordx4 v18, s[36:39], s47 offen offset:1024 lds
    buffer_load_dwordx4 v19, s[36:39], s47 offen offset:2048 lds
    buffer_load_dwordx4 v20, s[36:39], s47 offen offset:3072 lds
    s_add_u32 m0, s44, 24576
    s_add_u32 s47, s46, 65536
    buffer_load_dwordx4 v17, s[36:39], s47 offen offset:0 lds
    buffer_load_dwordx4 v18, s[36:39], s47 offen offset:1024 lds
    buffer_load_dwordx4 v19, s[36:39], s47 offen offset:2048 lds
    buffer_load_dwordx4 v20, s[36:39], s47 offen offset:3072 lds
    s_waitcnt vmcnt(59)
    s_add_u32 m0, s44, 28672
    s_add_u32 s47, s46, 98304
    buffer_load_dwordx4 v17, s[36:39], s47 offen offset:0 lds
    buffer_load_dwordx4 v18, s[36:39], s47 offen offset:1024 lds
    buffer_load_dwordx4 v19, s[36:39], s47 offen offset:2048 lds
    buffer_load_dwordx4 v20, s[36:39], s47 offen offset:3072 lds
    s_add_u32 s46, s46, 131072
    s_add_u32 s44, s44, 32768
    s_cmp_eq_u32 s44, 163840
    s_cselect_b32 s44, 0, s44
    s_waitcnt vmcnt(32)
    s_barrier
    s_add_u32 m0, s44, 16384
    s_add_u32 s47, s46, 0
    buffer_load_dwordx4 v17, s[36:39], s47 offen offset:0 lds
    buffer_load_dwordx4 v18, s[36:39], s47 offen offset:1024 lds
    buffer_load_dwordx4 v19, s[36:39], s47 offen offset:2048 lds
    buffer_load_dwordx4 v20, s[36:39], s47 offen offset:3072 lds
    s_add_u32 m0, s44, 20480
    s_add_u32 s47, s46, 32768
    buffer_load_dwordx4 v17, s[36:39], s47 offen offset:0 lds
    buffer_load_dwordx4 v18, s[36:39], s47 offen offset:1024 lds
    buffer_load_dwordx4 v19, s[36:39], s47 offen offset:2048 lds
    buffer_load_dwordx4 v20, s[36:39], s47 offen offset:3072 lds
    s_add_u32 m0, s44, 24576
    s_add_u32 s47, s46, 65536
    buffer_load_dwordx4 v17, s[36:39], s47 offen offset:0 lds
    buffer_load_dwordx4 v18, s[36:39], s47 offen offset:1024 lds
    buffer_load_dwordx4 v19, s[36:39], s47 offen offset:2048 lds
    buffer_load_dwordx4 v20, s[36:39], s47 offen offset:3072 lds
    s_waitcnt vmcnt(59)
    s_add_u32 m0, s44, 28672
    s_add_u32 s47, s46, 98304
    buffer_load_dwordx4 v17, s[36:39], s47 offen offset:0 lds
    buffer_load_dwordx4 v18, s[36:39], s47 offen offset:1024 lds
    buffer_load_dwordx4 v19, s[36:39], s47 offen offset:2048 lds
    buffer_load_dwordx4 v20, s[36:39], s47 offen offset:3072 lds
    s_add_u32 s46, s46, 131072
    s_add_u32 s44, s44, 32768
    s_cmp_eq_u32 s44, 163840
    s_cselect_b32 s44, 0, s44
    s_add_u32 m0, s44, 16384
    s_add_u32 s47, s46, 0
    buffer_load_dwordx4 v17, s[36:39], s47 offen offset:0 lds
    buffer_load_dwordx4 v18, s[36:39], s47 offen offset:1024 lds
    buffer_load_dwordx4 v19, s[36:39], s47 offen offset:2048 lds
    buffer_load_dwordx4 v20, s[36:39], s47 offen offset:3072 lds
    s_add_u32 m0, s44, 20480
    s_add_u32 s47, s46, 32768
    buffer_load_dwordx4 v17, s[36:39], s47 offen offset:0 lds
    buffer_load_dwordx4 v18, s[36:39], s47 offen offset:1024 lds
    buffer_load_dwordx4 v19, s[36:39], s47 offen offset:2048 lds
    buffer_load_dwordx4 v20, s[36:39], s47 offen offset:3072 lds
    s_add_u32 m0, s44, 24576
    s_add_u32 s47, s46, 65536
    buffer_load_dwordx4 v17, s[36:39], s47 offen offset:0 lds
    buffer_load_dwordx4 v18, s[36:39], s47 offen offset:1024 lds
    buffer_load_dwordx4 v19, s[36:39], s47 offen offset:2048 lds
    buffer_load_dwordx4 v20, s[36:39], s47 offen offset:3072 lds
    s_waitcnt vmcnt(59)
    s_add_u32 m0, s44, 28672
    s_add_u32 s47, s46, 98304
    buffer_load_dwordx4 v17, s[36:39], s47 offen offset:0 lds
    buffer_load_dwordx4 v18, s[36:39], s47 offen offset:1024 lds
    buffer_load_dwordx4 v19, s[36:39], s47 offen offset:2048 lds
    buffer_load_dwordx4 v20, s[36:39], s47 offen offset:3072 lds
    s_add_u32 s46, s46, 131072
    s_add_u32 s44, s44, 32768
    s_cmp_eq_u32 s44, 163840
    s_cselect_b32 s44, 0, s44
    s_mov_b32 s61, 31
LL_18:
    s_waitcnt vmcnt(48)
    s_barrier
    s_add_u32 m0, s44, 16384
    s_add_u32 s47, s46, 0
    buffer_load_dwordx4 v17, s[36:39], s47 offen offset:0 lds
    buffer_load_dwordx4 v18, s[36:39], s47 offen offset:1024 lds
    buffer_load_dwordx4 v19, s[36:39], s47 offen offset:2048 lds
    buffer_load_dwordx4 v20, s[36:39], s47 offen offset:3072 lds
    s_add_u32 m0, s44, 20480
    s_add_u32 s47, s46, 32768
    buffer_load_dwordx4 v17, s[36:39], s47 offen offset:0 lds
    buffer_load_dwordx4 v18, s[36:39], s47 offen offset:1024 lds
    buffer_load_dwordx4 v19, s[36:39], s47 offen offset:2048 lds
    buffer_load_dwordx4 v20, s[36:39], s47 offen offset:3072 lds
    s_add_u32 m0, s44, 24576
    s_add_u32 s47, s46, 65536
    buffer_load_dwordx4 v17, s[36:39], s47 offen offset:0 lds
    buffer_load_dwordx4 v18, s[36:39], s47 offen offset:1024 lds
    buffer_load_dwordx4 v19, s[36:39], s47 offen offset:2048 lds
    buffer_load_dwordx4 v20, s[36:39], s47 offen offset:3072 lds
    s_waitcnt vmcnt(59)
    s_add_u32 m0, s44, 28672
    s_add_u32 s47, s46, 98304
    buffer_load_dwordx4 v17, s[36:39], s47 offen offset:0 lds
    buffer_load_dwordx4 v18, s[36:39], s47 offen offset:1024 lds
    buffer_load_dwordx4 v19, s[36:39], s47 offen offset:2048 lds
    buffer_load_dwordx4 v20, s[36:39], s47 offen offset:3072 lds
    s_add_u32 s46, s46, 131072
    s_add_u32 s44, s44, 32768
    s_cmp_eq_u32 s44, 163840
    s_cselect_b32 s44, 0, s44
    s_sub_u32 s61, s61, 1
    s_cmp_lg_u32 s61, 0
    s_cbranch_scc1 LL_18
    s_waitcnt vmcnt(48)
    s_barrier
    s_waitcnt vmcnt(32)
    s_barrier
    s_waitcnt vmcnt(16)
    s_barrier
    s_waitcnt vmcnt(0)
    s_barrier
LE_5:
    s_endpgm
L_LX:
    s_and_b32 s62, s2, 7
    s_lshr_b32 s63, s2, 3
    s_and_b32 s53, s62, 1
    s_lshl_b32 s53, s53, 3
    s_lshr_b32 s64, s63, 2
    s_add_u32 s53, s53, s64
    s_lshr_b32 s54, s62, 1
    s_lshl_b32 s54, s54, 2
    s_and_b32 s64, s63, 3
    s_add_u32 s54, s54, s64
    s_lshr_b32 s57, s54, 3
    s_and_b32 s58, s54, 7
    s_and_b32 s55, s52, 1
    s_lshr_b32 s56, s52, 1
    s_waitcnt lgkmcnt(0)
    s_mov_b32 s28, s4
    s_mov_b32 s29, s5
    s_mov_b32 s30, 0x400000
    s_mov_b32 s31, 0x20000
    s_mov_b32 s32, s26
    s_mov_b32 s33, s27
    s_mov_b32 s34, 0x10000000
    s_mov_b32 s35, 0x20000
    s_mov_b32 s36, s12
    s_mov_b32 s37, s13
    s_mov_b32 s38, 0x700000
    s_mov_b32 s39, 0x20000
    s_mov_b32 s40, s6
    s_mov_b32 s41, s7
    s_mov_b32 s42, 0x600000
    s_mov_b32 s43, 0x20000
    v_lshrrev_b32 v30, 3, v1
    v_and_b32 v31, 7, v1
    v_xor_b32 v31, v31, v30
    v_lshlrev_b32 v31, 4, v31
    v_lshlrev_b32 v4, 11, v30
    v_add_u32 v4, v4, v31
    v_add_u32 v5, 15360, v4
    v_add_u32 v6, 30720, v4
    v_add_u32 v7, 46080, v4
    s_lshl_b32 s48, s53, 18
    s_mov_b32 s45, s48
    s_mov_b32 s46, 0
    s_mul_i32 s63, s54, 448
    s_movk_i32 s64, 2341
    s_movk_i32 s65, 7168
    v_add_u32 v2, 0, v1
    v_mul_lo_u32 v3, v2, s64
    v_lshrrev_b32 v3, 16, v3
    v_mul_u32_u24 v32, 28, v3
    v_sub_u32 v2, v2, v32
    v_lshrrev_b32 v32, 2, v3
    v_and_b32 v32, 2, v32
    v_xor_b32 v2, v2, v32
    v_lshlrev_b32 v2, 4, v2
    v_mul_lo_u32 v3, v3, s65
    v_add_u32 v2, v2, v3
    v_add_u32 v2, s63, v2
    v_subrev_u32 v14, 0, v2
    v_add_u32 v2, 64, v1
    v_mul_lo_u32 v3, v2, s64
    v_lshrrev_b32 v3, 16, v3
    v_mul_u32_u24 v32, 28, v3
    v_sub_u32 v2, v2, v32
    v_lshrrev_b32 v32, 2, v3
    v_and_b32 v32, 2, v32
    v_xor_b32 v2, v2, v32
    v_lshlrev_b32 v2, 4, v2
    v_mul_lo_u32 v3, v3, s65
    v_add_u32 v2, v2, v3
    v_add_u32 v2, s63, v2
    v_subrev_u32 v15, 1024, v2
    v_add_u32 v2, 128, v1
    v_mul_lo_u32 v3, v2, s64
    v_lshrrev_b32 v3, 16, v3
    v_mul_u32_u24 v32, 28, v3
    v_sub_u32 v2, v2, v32
    v_lshrrev_b32 v32, 2, v3
    v_and_b32 v32, 2, v32
    v_xor_b32 v2, v2, v32
    v_lshlrev_b32 v2, 4, v2
    v_mul_lo_u32 v3, v3, s65
    v_add_u32 v2, v2, v3
    v_add_u32 v2, s63, v2
    v_subrev_u32 v16, 2048, v2
    v_add_u32 v2, 192, v1
    v_mul_lo_u32 v3, v2, s64
    v_lshrrev_b32 v3, 16, v3
    v_mul_u32_u24 v32, 28, v3
    v_sub_u32 v2, v2, v32
    v_lshrrev_b32 v32, 2, v3
    v_and_b32 v32, 2, v32
    v_xor_b32 v2, v2, v32
    v_lshlrev_b32 v2, 4, v2
    v_mul_lo_u32 v3, v3, s65
    v_add_u32 v2, v2, v3
    v_add_u32 v2, s63, v2
    v_subrev_u32 v17, 3072, v2
    v_add_u32 v2, 256, v1
    v_mul_lo_u32 v3, v2, s64
    v_lshrrev_b32 v3, 16, v3
    v_mul_u32_u24 v32, 28, v3
    v_sub_u32 v2, v2, v32
    v_lshrrev_b32 v32, 2, v3
    v_and_b32 v32, 2, v32
    v_xor_b32 v2, v2, v32
    v_lshlrev_b32 v2, 4, v2
    v_mul_lo_u32 v3, v3, s65
    v_add_u32 v2, v2, v3
    v_add_u32 v2, s63, v2
    v_subrev_u32 v18, 0, v2
    v_add_u32 v2, 320, v1
    v_mul_lo_u32 v3, v2, s64
    v_lshrrev_b32 v3, 16, v3
    v_mul_u32_u24 v32, 28, v3
    v_sub_u32 v2, v2, v32
    v_lshrrev_b32 v32, 2, v3
    v_and_b32 v32, 2, v32
    v_xor_b32 v2, v2, v32
    v_lshlrev_b32 v2, 4, v2
    v_mul_lo_u32 v3, v3, s65
    v_add_u32 v2, v2, v3
    v_add_u32 v2, s63, v2
    v_subrev_u32 v19, 1024, v2
    v_add_u32 v2, 384, v1
    v_mul_lo_u32 v3, v2, s64
    v_lshrrev_b32 v3, 16, v3
    v_mul_u32_u24 v32, 28, v3
    v_sub_u32 v2, v2, v32
    v_lshrrev_b32 v32, 2, v3
    v_and_b32 v32, 2, v32
    v_xor_b32 v2, v2, v32
    v_lshlrev_b32 v2, 4, v2
    v_mul_lo_u32 v3, v3, s65
    v_add_u32 v2, v2, v3
    v_add_u32 v2, s63, v2
    v_subrev_u32 v20, 2048, v2
    s_mov_b32 s44, 0
    s_add_u32 m0, s44, 0
    s_add_u32 s47, s45, 0
    buffer_load_dwordx4 v4, s[28:31], s47 offen offset:0 lds
    buffer_load_dwordx4 v5, s[28:31], s47 offen offset:1024 lds
    buffer_load_dwordx4 v6, s[28:31], s47 offen offset:2048 lds
    buffer_load_dwordx4 v7, s[28:31], s47 offen offset:3072 lds
    s_add_u32 m0, s44, 4096
    s_add_u32 s47, s45, 65536
    buffer_load_dwordx4 v4, s[28:31], s47 offen offset:0 lds
    buffer_load_dwordx4 v5, s[28:31], s47 offen offset:1024 lds
    buffer_load_dwordx4 v6, s[28:31], s47 offen offset:2048 lds
    buffer_load_dwordx4 v7, s[28:31], s47 offen offset:3072 lds
    s_add_u32 m0, s44, 8192
    s_add_u32 s47, s45, 131072
    buffer_load_dwordx4 v4, s[28:31], s47 offen offset:0 lds
    buffer_load_dwordx4 v5, s[28:31], s47 offen offset:1024 lds
    buffer_load_dwordx4 v6, s[28:31], s47 offen offset:2048 lds
    buffer_load_dwordx4 v7, s[28:31], s47 offen offset:3072 lds
    s_add_u32 m0, s44, 12288
    s_add_u32 s47, s45, 196608
    buffer_load_dwordx4 v4, s[28:31], s47 offen offset:0 lds
    buffer_load_dwordx4 v5, s[28:31], s47 offen offset:1024 lds
    buffer_load_dwordx4 v6, s[28:31], s47 offen offset:2048 lds
    buffer_load_dwordx4 v7, s[28:31], s47 offen offset:3072 lds
    s_add_u32 m0, s44, 37888
    s_add_u32 s47, s46, 344064
    buffer_load_dwordx4 v14, s[36:39], s47 offen offset:0 lds
    buffer_load_dwordx4 v15, s[36:39], s47 offen offset:1024 lds
    buffer_load_dwordx4 v16, s[36:39], s47 offen offset:2048 lds
    buffer_load_dwordx4 v17, s[36:39], s47 offen offset:3072 lds
    s_add_u32 m0, s44, 41984
    s_nop 0
    buffer_load_dwordx4 v18, s[36:39], s47 offen offset:0 lds
    buffer_load_dwordx4 v19, s[36:39], s47 offen offset:1024 lds
    buffer_load_dwordx4 v20, s[36:39], s47 offen offset:2048 lds
    s_add_u32 s45, s45, 128
    s_add_u32 s46, s46, 458752
    s_add_u32 s44, s44, 45056
    s_cmp_eq_u32 s44, 135168
    s_cselect_b32 s44, 0, s44
    s_barrier
    s_add_u32 m0, s44, 0
    s_add_u32 s47, s45, 0
    buffer_load_dwordx4 v4, s[28:31], s47 offen offset:0 lds
    buffer_load_dwordx4 v5, s[28:31], s47 offen offset:1024 lds
    buffer_load_dwordx4 v6, s[28:31], s47 offen offset:2048 lds
    buffer_load_dwordx4 v7, s[28:31], s47 offen offset:3072 lds
    s_add_u32 m0, s44, 4096
    s_add_u32 s47, s45, 65536
    buffer_load_dwordx4 v4, s[28:31], s47 offen offset:0 lds
    buffer_load_dwordx4 v5, s[28:31], s47 offen offset:1024 lds
    buffer_load_dwordx4 v6, s[28:31], s47 offen offset:2048 lds
    buffer_load_dwordx4 v7, s[28:31], s47 offen offset:3072 lds
    s_add_u32 m0, s44, 8192
    s_add_u32 s47, s45, 131072
    buffer_load_dwordx4 v4, s[28:31], s47 offen offset:0 lds
    buffer_load_dwordx4 v5, s[28:31], s47 offen offset:1024 lds
    buffer_load_dwordx4 v6, s[28:31], s47 offen offset:2048 lds
    buffer_load_dwordx4 v7, s[28:31], s47 offen offset:3072 lds
    s_add_u32 m0, s44, 12288
    s_add_u32 s47, s45, 196608
    buffer_load_dwordx4 v4, s[28:31], s47 offen offset:0 lds
    buffer_load_dwordx4 v5, s[28:31], s47 offen offset:1024 lds
    buffer_load_dwordx4 v6, s[28:31], s47 offen offset:2048 lds
    buffer_load_dwordx4 v7, s[28:31], s47 offen offset:3072 lds
    s_add_u32 m0, s44, 37888
    s_add_u32 s47, s46, 344064
    buffer_load_dwordx4 v14, s[36:39], s47 offen offset:0 lds
    buffer_load_dwordx4 v15, s[36:39], s47 offen offset:1024 lds
    buffer_load_dwordx4 v16, s[36:39], s47 offen offset:2048 lds
    buffer_load_dwordx4 v17, s[36:39], s47 offen offset:3072 lds
    s_add_u32 m0, s44, 41984
    s_nop 0
    buffer_load_dwordx4 v18, s[36:39], s47 offen offset:0 lds
    buffer_load_dwordx4 v19, s[36:39], s47 offen offset:1024 lds
    buffer_load_dwordx4 v20, s[36:39], s47 offen offset:2048 lds
    s_add_u32 s45, s45, 128
    s_add_u32 s46, s46, 458752
    s_add_u32 s44, s44, 45056
    s_cmp_eq_u32 s44, 135168
    s_cselect_b32 s44, 0, s44
    s_lshl_b32 s62, s53, 7
    s_sub_u32 s62, s62, 16
    v_add_u32 v13, s62, v30
    v_max_i32 v13, 0, v13
    v_lshlrev_b32 v13, 11, v13
    v_add_u32 v13, v13, v31
    v_subrev_u32 v8, 0, v13
    v_add_u32 v13, s62, v30
    v_add_u32 v13, 8, v13
    v_max_i32 v13, 1, v13
    v_lshlrev_b32 v13, 11, v13
    v_add_u32 v13, v13, v31
    v_subrev_u32 v9, 1024, v13
    v_add_u32 v13, s62, v30
    v_add_u32 v13, 16, v13
    v_max_i32 v13, 0, v13
    v_lshlrev_b32 v13, 11, v13
    v_add_u32 v13, v13, v31
    v_subrev_u32 v10, 0, v13
    v_add_u32 v13, s62, v30
    v_add_u32 v13, 24, v13
    v_max_i32 v13, 1, v13
    v_lshlrev_b32 v13, 11, v13
    v_add_u32 v13, v13, v31
    v_subrev_u32 v11, 1024, v13
    v_lshlrev_b32 v12, 4, v1
    s_lshl_b32 s63, s54, 7
    s_movk_i32 s64, 2731
    s_movk_i32 s65, 6144
    v_add_u32 v2, 0, v1
    v_mul_lo_u32 v3, v2, s64
    v_lshrrev_b32 v3, 16, v3
    v_mul_u32_u24 v32, 24, v3
    v_sub_u32 v2, v2, v32
    v_and_b32 v32, 2, v3
    v_xor_b32 v2, v2, v32
    v_lshrrev_b32 v32, 1, v3
    v_and_b32 v32, 4, v32
    v_xor_b32 v2, v2, v32
    v_lshrrev_b32 v32, 3, v2
    v_lshlrev_b32 v32, 11, v32
    v_and_b32 v2, 7, v2
    v_lshlrev_b32 v2, 4, v2
    v_add_u32 v2, v2, v32
    v_mul_lo_u32 v3, v3, s65
    v_add_u32 v2, v2, v3
    v_add_u32 v2, s63, v2
    v_subrev_u32 v21, 0, v2
    v_add_u32 v2, 64, v1
    v_mul_lo_u32 v3, v2, s64
    v_lshrrev_b32 v3, 16, v3
    v_mul_u32_u24 v32, 24, v3
    v_sub_u32 v2, v2, v32
    v_and_b32 v32, 2, v3
    v_xor_b32 v2, v2, v32
    v_lshrrev_b32 v32, 1, v3
    v_and_b32 v32, 4, v32
    v_xor_b32 v2, v2, v32
    v_lshrrev_b32 v32, 3, v2
    v_lshlrev_b32 v32, 11, v32
    v_and_b32 v2, 7, v2
    v_lshlrev_b32 v2, 4, v2
    v_add_u32 v2, v2, v32
    v_mul_lo_u32 v3, v3, s65
    v_add_u32 v2, v2, v3
    v_add_u32 v2, s63, v2
    v_subrev_u32 v22, 1024, v2
    v_add_u32 v2, 128, v1
    v_mul_lo_u32 v3, v2, s64
    v_lshrrev_b32 v3, 16, v3
    v_mul_u32_u24 v32, 24, v3
    v_sub_u32 v2, v2, v32
    v_and_b32 v32, 2, v3
    v_xor_b32 v2, v2, v32
    v_lshrrev_b32 v32, 1, v3
    v_and_b32 v32, 4, v32
    v_xor_b32 v2, v2, v32
    v_lshrrev_b32 v32, 3, v2
    v_lshlrev_b32 v32, 11, v32
    v_and_b32 v2, 7, v2
    v_lshlrev_b32 v2, 4, v2
    v_add_u32 v2, v2, v32
    v_mul_lo_u32 v3, v3, s65
    v_add_u32 v2, v2, v3
    v_add_u32 v2, s63, v2
    v_subrev_u32 v23, 2048, v2
    v_add_u32 v2, 192, v1
    v_mul_lo_u32 v3, v2, s64
    v_lshrrev_b32 v3, 16, v3
    v_mul_u32_u24 v32, 24, v3
    v_sub_u32 v2, v2, v32
    v_and_b32 v32, 2, v3
    v_xor_b32 v2, v2, v32
    v_lshrrev_b32 v32, 1, v3
    v_and_b32 v32, 4, v32
    v_xor_b32 v2, v2, v32
    v_lshrrev_b32 v32, 3, v2
    v_lshlrev_b32 v32, 11, v32
    v_and_b32 v2, 7, v2
    v_lshlrev_b32 v2, 4, v2
    v_add_u32 v2, v2, v32
    v_mul_lo_u32 v3, v3, s65
    v_add_u32 v2, v2, v3
    v_add_u32 v2, s63, v2
    v_subrev_u32 v24, 3072, v2
    s_waitcnt vmcnt(40)
    s_add_u32 m0, s44, 0
    s_add_u32 s47, s45, 0
    buffer_load_dwordx4 v4, s[28:31], s47 offen offset:0 lds
    buffer_load_dwordx4 v5, s[28:31], s47 offen offset:1024 lds
    buffer_load_dwordx4 v6, s[28:31], s47 offen offset:2048 lds
    buffer_load_dwordx4 v7, s[28:31], s47 offen offset:3072 lds
    s_add_u32 m0, s44, 4096
    s_add_u32 s47, s45, 65536
    buffer_load_dwordx4 v4, s[28:31], s47 offen offset:0 lds
    buffer_load_dwordx4 v5, s[28:31], s47 offen offset:1024 lds
    buffer_load_dwordx4 v6, s[28:31], s47 offen offset:2048 lds
    buffer_load_dwordx4 v7, s[28:31], s47 offen offset:3072 lds
    s_add_u32 m0, s44, 8192
    s_add_u32 s47, s45, 131072
    buffer_load_dwordx4 v4, s[28:31], s47 offen offset:0 lds
    buffer_load_dwordx4 v5, s[28:31], s47 offen offset:1024 lds
    buffer_load_dwordx4 v6, s[28:31], s47 offen offset:2048 lds
    buffer_load_dwordx4 v7, s[28:31], s47 offen offset:3072 lds
    s_add_u32 m0, s44, 12288
    s_add_u32 s47, s45, 196608
    buffer_load_dwordx4 v4, s[28:31], s47 offen offset:0 lds
    buffer_load_dwordx4 v5, s[28:31], s47 offen offset:1024 lds
    buffer_load_dwordx4 v6, s[28:31], s47 offen offset:2048 lds
    buffer_load_dwordx4 v7, s[28:31], s47 offen offset:3072 lds
    s_add_u32 m0, s44, 37888
    s_add_u32 s47, s46, 344064
    buffer_load_dwordx4 v14, s[36:39], s47 offen offset:0 lds
    buffer_load_dwordx4 v15, s[36:39], s47 offen offset:1024 lds
    buffer_load_dwordx4 v16, s[36:39], s47 offen offset:2048 lds
    buffer_load_dwordx4 v17, s[36:39], s47 offen offset:3072 lds
    s_add_u32 m0, s44, 41984
    s_nop 0
    buffer_load_dwordx4 v18, s[36:39], s47 offen offset:0 lds
    buffer_load_dwordx4 v19, s[36:39], s47 offen offset:1024 lds
    buffer_load_dwordx4 v20, s[36:39], s47 offen offset:2048 lds
    s_add_u32 s45, s45, 128
    s_add_u32 s46, s46, 458752
    s_add_u32 s44, s44, 45056
    s_cmp_eq_u32 s44, 135168
    s_cselect_b32 s44, 0, s44
    s_waitcnt vmcnt(46)
    s_barrier
    s_mov_b32 s61, 13
LL_23:
    s_waitcnt vmcnt(23)
    s_barrier
    s_add_u32 m0, s44, 0
    s_add_u32 s47, s45, 0
    buffer_load_dwordx4 v4, s[28:31], s47 offen offset:0 lds
    buffer_load_dwordx4 v5, s[28:31], s47 offen offset:1024 lds
    buffer_load_dwordx4 v6, s[28:31], s47 offen offset:2048 lds
    buffer_load_dwordx4 v7, s[28:31], s47 offen offset:3072 lds
    s_add_u32 m0, s44, 4096
    s_add_u32 s47, s45, 65536
    buffer_load_dwordx4 v4, s[28:31], s47 offen offset:0 lds
    buffer_load_dwordx4 v5, s[28:31], s47 offen offset:1024 lds
    buffer_load_dwordx4 v6, s[28:31], s47 offen offset:2048 lds
    buffer_load_dwordx4 v7, s[28:31], s47 offen offset:3072 lds
    s_add_u32 m0, s44, 8192
    s_add_u32 s47, s45, 131072
    buffer_load_dwordx4 v4, s[28:31], s47 offen offset:0 lds
    buffer_load_dwordx4 v5, s[28:31], s47 offen offset:1024 lds
    buffer_load_dwordx4 v6, s[28:31], s47 offen offset:2048 lds
    buffer_load_dwordx4 v7, s[28:31], s47 offen offset:3072 lds
    s_add_u32 m0, s44, 12288
    s_add_u32 s47, s45, 196608
    buffer_load_dwordx4 v4, s[28:31], s47 offen offset:0 lds
    buffer_load_dwordx4 v5, s[28:31], s47 offen offset:1024 lds
    buffer_load_dwordx4 v6, s[28:31], s47 offen offset:2048 lds
    buffer_load_dwordx4 v7, s[28:31], s47 offen offset:3072 lds
    s_add_u32 m0, s44, 37888
    s_add_u32 s47, s46, 344064
    buffer_load_dwordx4 v14, s[36:39], s47 offen offset:0 lds
    buffer_load_dwordx4 v15, s[36:39], s47 offen offset:1024 lds
    buffer_load_dwordx4 v16, s[36:39], s47 offen offset:2048 lds
    buffer_load_dwordx4 v17, s[36:39], s47 offen offset:3072 lds
    s_add_u32 m0, s44, 41984
    s_nop 0
    buffer_load_dwordx4 v18, s[36:39], s47 offen offset:0 lds
    buffer_load_dwordx4 v19, s[36:39], s47 offen offset:1024 lds
    buffer_load_dwordx4 v20, s[36:39], s47 offen offset:2048 lds
    s_add_u32 s45, s45, 128
    s_add_u32 s46, s46, 458752
    s_add_u32 s44, s44, 45056
    s_cmp_eq_u32 s44, 135168
    s_cselect_b32 s44, 0, s44
    s_sub_u32 s61, s61, 1
    s_cmp_lg_u32 s61, 0
    s_cbranch_scc1 LL_23
    s_mov_b32 s45, 0
    s_mov_b32 s46, 0
    s_waitcnt vmcnt(23)
    s_barrier
    s_mov_b32 m0, s44
    s_sub_u32 s49, s48, 32768
    buffer_load_dwordx4 v8, s[28:31], s45 offen offset:0 lds
    buffer_load_dwordx4 v9, s[28:31], s45 offen offset:1024 lds
    s_add_u32 m0, s44, 2048
    s_add_u32 s49, s49, s45
    buffer_load_dwordx4 v10, s[28:31], s45 offen offset:0 lds
    buffer_load_dwordx4 v11, s[28:31], s45 offen offset:1024 lds
    s_add_u32 m0, s44, 4096
    s_add_u32 s47, s49, 65536
    buffer_load_dwordx4 v4, s[28:31], s47 offen offset:0 lds
    buffer_load_dwordx4 v5, s[28:31], s47 offen offset:1024 lds
    buffer_load_dwordx4 v6, s[28:31], s47 offen offset:2048 lds
    buffer_load_dwordx4 v7, s[28:31], s47 offen offset:3072 lds
    s_add_u32 m0, s44, 8192
    s_add_u32 s47, s49, 131072
    buffer_load_dwordx4 v4, s[28:31], s47 offen offset:0 lds
    buffer_load_dwordx4 v5, s[28:31], s47 offen offset:1024 lds
    buffer_load_dwordx4 v6, s[28:31], s47 offen offset:2048 lds
    buffer_load_dwordx4 v7, s[28:31], s47 offen offset:3072 lds
    s_add_u32 m0, s44, 12288
    s_add_u32 s47, s49, 196608
    buffer_load_dwordx4 v4, s[28:31], s47 offen offset:0 lds
    buffer_load_dwordx4 v5, s[28:31], s47 offen offset:1024 lds
    buffer_load_dwordx4 v6, s[28:31], s47 offen offset:2048 lds
    buffer_load_dwordx4 v7, s[28:31], s47 offen offset:3072 lds
    s_add_u32 m0, s44, 16384
    s_add_u32 s47, s49, 262144
    buffer_load_dwordx4 v4, s[28:31], s47 offen offset:0 lds
    buffer_load_dwordx4 v5, s[28:31], s47 offen offset:1024 lds
    s_add_u32 m0, s44, 36864
    s_add_u32 s47, s46, 294912
    buffer_load_dwordx4 v21, s[40:43], s47 offen offset:0 lds
    buffer_load_dwordx4 v22, s[40:43], s47 offen offset:1024 lds
    buffer_load_dwordx4 v23, s[40:43], s47 offen offset:2048 lds
    buffer_load_dwordx4 v24, s[40:43], s47 offen offset:3072 lds
    s_add_u32 s45, s45, 128
    s_add_u32 s46, s46, 393216
    s_add_u32 s44, s44, 45056
    s_cmp_eq_u32 s44, 135168
    s_cselect_b32 s44, 0, s44
    s_mov_b32 s61, 15
LL_25:
    s_waitcnt vmcnt(22)
    s_barrier
    s_mov_b32 m0, s44
    s_sub_u32 s49, s48, 32768
    buffer_load_dwordx4 v8, s[28:31], s45 offen offset:0 lds
    buffer_load_dwordx4 v9, s[28:31], s45 offen offset:1024 lds
    s_add_u32 m0, s44, 2048
    s_add_u32 s49, s49, s45
    buffer_load_dwordx4 v10, s[28:31], s45 offen offset:0 lds
    buffer_load_dwordx4 v11, s[28:31], s45 offen offset:1024 lds
    s_add_u32 m0, s44, 4096
    s_add_u32 s47, s49, 65536
    buffer_load_dwordx4 v4, s[28:31], s47 offen offset:0 lds
    buffer_load_dwordx4 v5, s[28:31], s47 offen offset:1024 lds
    buffer_load_dwordx4 v6, s[28:31], s47 offen offset:2048 lds
    buffer_load_dwordx4 v7, s[28:31], s47 offen offset:3072 lds
    s_add_u32 m0, s44, 8192
    s_add_u32 s47, s49, 131072
    buffer_load_dwordx4 v4, s[28:31], s47 offen offset:0 lds
    buffer_load_dwordx4 v5, s[28:31], s47 offen offset:1024 lds
    buffer_load_dwordx4 v6, s[28:31], s47 offen offset:2048 lds
    buffer_load_dwordx4 v7, s[28:31], s47 offen offset:3072 lds
    s_add_u32 m0, s44, 12288
    s_add_u32 s47, s49, 196608
    buffer_load_dwordx4 v4, s[28:31], s47 offen offset:0 lds
    buffer_load_dwordx4 v5, s[28:31], s47 offen offset:1024 lds
    buffer_load_dwordx4 v6, s[28:31], s47 offen offset:2048 lds
    buffer_load_dwordx4 v7, s[28:31], s47 offen offset:3072 lds
    s_add_u32 m0, s44, 16384
    s_add_u32 s47, s49, 262144
    buffer_load_dwordx4 v4, s[28:31], s47 offen offset:0 lds
    buffer_load_dwordx4 v5, s[28:31], s47 offen offset:1024 lds
    s_add_u32 m0, s44, 36864
    s_add_u32 s47, s46, 294912
    buffer_load_dwordx4 v21, s[40:43], s47 offen offset:0 lds
    buffer_load_dwordx4 v22, s[40:43], s47 offen offset:1024 lds
    buffer_load_dwordx4 v23, s[40:43], s47 offen offset:2048 lds
    buffer_load_dwordx4 v24, s[40:43], s47 offen offset:3072 lds
    s_add_u32 s45, s45, 128
    s_add_u32 s46, s46, 393216
    s_add_u32 s44, s44, 45056
    s_cmp_eq_u32 s44, 135168
    s_cselect_b32 s44, 0, s44
    s_sub_u32 s61, s61, 1
    s_cmp_lg_u32 s61, 0
    s_cbranch_scc1 LL_25
    s_cmp_eq_u32 s57, 0
    s_cbranch_scc0 LB_26
    s_mov_b32 s44, 98304
    s_mul_i32 s45, s53, 917504
    s_waitcnt vmcnt(22)
    s_barrier
    s_add_u32 m0, s44, 0
    s_add_u32 s47, s45, 0
    buffer_load_dwordx4 v12, s[32:35], s47 offen offset:0 lds
    buffer_load_dwordx4 v12, s[32:35], s47 offen offset:1024 lds
    buffer_load_dwordx4 v12, s[32:35], s47 offen offset:2048 lds
    buffer_load_dwordx4 v12, s[32:35], s47 offen offset:3072 lds
    s_add_u32 m0, s44, 4096
    s_add_u32 s47, s45, 4096
    buffer_load_dwordx4 v12, s[32:35], s47 offen offset:0 lds
    buffer_load_dwordx4 v12, s[32:35], s47 offen offset:1024 lds
    buffer_load_dwordx4 v12, s[32:35], s47 offen offset:2048 lds
    buffer_load_dwordx4 v12, s[32:35], s47 offen offset:3072 lds
    s_add_u32 m0, s44, 8192
    s_add_u32 s47, s45, 8192
    buffer_load_dwordx4 v12, s[32:35], s47 offen offset:0 lds
    buffer_load_dwordx4 v12, s[32:35], s47 offen offset:1024 lds
    buffer_load_dwordx4 v12, s[32:35], s47 offen offset:2048 lds
    buffer_load_dwordx4 v12, s[32:35], s47 offen offset:3072 lds
    s_waitcnt vmcnt(59)
    s_add_u32 m0, s44, 12288
    s_add_u32 s47, s45, 12288
    buffer_load_dwordx4 v12, s[32:35], s47 offen offset:0 lds
    buffer_load_dwordx4 v12, s[32:35], s47 offen offset:1024 lds
    buffer_load_dwordx4 v12, s[32:35], s47 offen offset:2048 lds
    buffer_load_dwordx4 v12, s[32:35], s47 offen offset:3072 lds
    s_add_u32 s45, s45, 16384
    s_add_u32 s44, s44, 32768
    s_cmp_eq_u32 s44, 163840
    s_cselect_b32 s44, 0, s44
    s_waitcnt vmcnt(16)
    s_barrier
    s_add_u32 m0, s44, 0
    s_add_u32 s47, s45, 0
    buffer_load_dwordx4 v12, s[32:35], s47 offen offset:0 lds
    buffer_load_dwordx4 v12, s[32:35], s47 offen offset:1024 lds
    buffer_load_dwordx4 v12, s[32:35], s47 offen offset:2048 lds
    buffer_load_dwordx4 v12, s[32:35], s47 offen offset:3072 lds
    s_add_u32 m0, s44, 4096
    s_add_u32 s47, s45, 4096
    buffer_load_dwordx4 v12, s[32:35], s47 offen offset:0 lds
    buffer_load_dwordx4 v12, s[32:35], s47 offen offset:1024 lds
    buffer_load_dwordx4 v12, s[32:35], s47 offen offset:2048 lds
    buffer_load_dwordx4 v12, s[32:35], s47 offen offset:3072 lds
    s_add_u32 m0, s44, 8192
    s_add_u32 s47, s45, 8192
    buffer_load_dwordx4 v12, s[32:35], s47 offen offset:0 lds
    buffer_load_dwordx4 v12, s[32:35], s47 offen offset:1024 lds
    buffer_load_dwordx4 v12, s[32:35], s47 offen offset:2048 lds
    buffer_load_dwordx4 v12, s[32:35], s47 offen offset:3072 lds
    s_waitcnt vmcnt(59)
    s_add_u32 m0, s44, 12288
    s_add_u32 s47, s45, 12288
    buffer_load_dwordx4 v12, s[32:35], s47 offen offset:0 lds
    buffer_load_dwordx4 v12, s[32:35], s47 offen offset:1024 lds
    buffer_load_dwordx4 v12, s[32:35], s47 offen offset:2048 lds
    buffer_load_dwordx4 v12, s[32:35], s47 offen offset:3072 lds
    s_add_u32 s45, s45, 16384
    s_add_u32 s44, s44, 32768
    s_cmp_eq_u32 s44, 163840
    s_cselect_b32 s44, 0, s44
    s_add_u32 m0, s44, 0
    s_add_u32 s47, s45, 0
    buffer_load_dwordx4 v12, s[32:35], s47 offen offset:0 lds
    buffer_load_dwordx4 v12, s[32:35], s47 offen offset:1024 lds
    buffer_load_dwordx4 v12, s[32:35], s47 offen offset:2048 lds
    buffer_load_dwordx4 v12, s[32:35], s47 offen offset:3072 lds
    s_add_u32 m0, s44, 4096
    s_add_u32 s47, s45, 4096
    buffer_load_dwordx4 v12, s[32:35], s47 offen offset:0 lds
    buffer_load_dwordx4 v12, s[32:35], s47 offen offset:1024 lds
    buffer_load_dwordx4 v12, s[32:35], s47 offen offset:2048 lds
    buffer_load_dwordx4 v12, s[32:35], s47 offen offset:3072 lds
    s_add_u32 m0, s44, 8192
    s_add_u32 s47, s45, 8192
    buffer_load_dwordx4 v12, s[32:35], s47 offen offset:0 lds
    buffer_load_dwordx4 v12, s[32:35], s47 offen offset:1024 lds
    buffer_load_dwordx4 v12, s[32:35], s47 offen offset:2048 lds
    buffer_load_dwordx4 v12, s[32:35], s47 offen offset:3072 lds
    s_waitcnt vmcnt(59)
    s_add_u32 m0, s44, 12288
    s_add_u32 s47, s45, 12288
    buffer_load_dwordx4 v12, s[32:35], s47 offen offset:0 lds
    buffer_load_dwordx4 v12, s[32:35], s47 offen offset:1024 lds
    buffer_load_dwordx4 v12, s[32:35], s47 offen offset:2048 lds
    buffer_load_dwordx4 v12, s[32:35], s47 offen offset:3072 lds
    s_add_u32 s45, s45, 16384
    s_add_u32 s44, s44, 32768
    s_cmp_eq_u32 s44, 163840
    s_cselect_b32 s44, 0, s44
    s_waitcnt vmcnt(32)
    s_barrier
    s_add_u32 m0, s44, 0
    s_add_u32 s47, s45, 0
    buffer_load_dwordx4 v12, s[32:35], s47 offen offset:0 lds
    buffer_load_dwordx4 v12, s[32:35], s47 offen offset:1024 lds
    buffer_load_dwordx4 v12, s[32:35], s47 offen offset:2048 lds
    buffer_load_dwordx4 v12, s[32:35], s47 offen offset:3072 lds
    s_add_u32 m0, s44, 4096
    s_add_u32 s47, s45, 4096
    buffer_load_dwordx4 v12, s[32:35], s47 offen offset:0 lds
    buffer_load_dwordx4 v12, s[32:35], s47 offen offset:1024 lds
    buffer_load_dwordx4 v12, s[32:35], s47 offen offset:2048 lds
    buffer_load_dwordx4 v12, s[32:35], s47 offen offset:3072 lds
    s_add_u32 m0, s44, 8192
    s_add_u32 s47, s45, 8192
    buffer_load_dwordx4 v12, s[32:35], s47 offen offset:0 lds
    buffer_load_dwordx4 v12, s[32:35], s47 offen offset:1024 lds
    buffer_load_dwordx4 v12, s[32:35], s47 offen offset:2048 lds
    buffer_load_dwordx4 v12, s[32:35], s47 offen offset:3072 lds
    s_waitcnt vmcnt(59)
    s_add_u32 m0, s44, 12288
    s_add_u32 s47, s45, 12288
    buffer_load_dwordx4 v12, s[32:35], s47 offen offset:0 lds
    buffer_load_dwordx4 v12, s[32:35], s47 offen offset:1024 lds
    buffer_load_dwordx4 v12, s[32:35], s47 offen offset:2048 lds
    buffer_load_dwordx4 v12, s[32:35], s47 offen offset:3072 lds
    s_add_u32 s45, s45, 16384
    s_add_u32 s44, s44, 32768
    s_cmp_eq_u32 s44, 163840
    s_cselect_b32 s44, 0, s44
    s_add_u32 m0, s44, 0
    s_add_u32 s47, s45, 0
    buffer_load_dwordx4 v12, s[32:35], s47 offen offset:0 lds
    buffer_load_dwordx4 v12, s[32:35], s47 offen offset:1024 lds
    buffer_load_dwordx4 v12, s[32:35], s47 offen offset:2048 lds
    buffer_load_dwordx4 v12, s[32:35], s47 offen offset:3072 lds
    s_add_u32 m0, s44, 4096
    s_add_u32 s47, s45, 4096
    buffer_load_dwordx4 v12, s[32:35], s47 offen offset:0 lds
    buffer_load_dwordx4 v12, s[32:35], s47 offen offset:1024 lds
    buffer_load_dwordx4 v12, s[32:35], s47 offen offset:2048 lds
    buffer_load_dwordx4 v12, s[32:35], s47 offen offset:3072 lds
    s_add_u32 m0, s44, 8192
    s_add_u32 s47, s45, 8192
    buffer_load_dwordx4 v12, s[32:35], s47 offen offset:0 lds
    buffer_load_dwordx4 v12, s[32:35], s47 offen offset:1024 lds
    buffer_load_dwordx4 v12, s[32:35], s47 offen offset:2048 lds
    buffer_load_dwordx4 v12, s[32:35], s47 offen offset:3072 lds
    s_waitcnt vmcnt(59)
    s_add_u32 m0, s44, 12288
    s_add_u32 s47, s45, 12288
    buffer_load_dwordx4 v12, s[32:35], s47 offen offset:0 lds
    buffer_load_dwordx4 v12, s[32:35], s47 offen offset:1024 lds
    buffer_load_dwordx4 v12, s[32:35], s47 offen offset:2048 lds
    buffer_load_dwordx4 v12, s[32:35], s47 offen offset:3072 lds
    s_add_u32 s45, s45, 16384
    s_add_u32 s44, s44, 32768
    s_cmp_eq_u32 s44, 163840
    s_cselect_b32 s44, 0, s44
    s_mov_b32 s61, 15
LL_31:
    s_waitcnt vmcnt(48)
    s_barrier
    s_add_u32 m0, s44, 0
    s_add_u32 s47, s45, 0
    buffer_load_dwordx4 v12, s[32:35], s47 offen offset:0 lds
    buffer_load_dwordx4 v12, s[32:35], s47 offen offset:1024 lds
    buffer_load_dwordx4 v12, s[32:35], s47 offen offset:2048 lds
    buffer_load_dwordx4 v12, s[32:35], s47 offen offset:3072 lds
    s_add_u32 m0, s44, 4096
    s_add_u32 s47, s45, 4096
    buffer_load_dwordx4 v12, s[32:35], s47 offen offset:0 lds
    buffer_load_dwordx4 v12, s[32:35], s47 offen offset:1024 lds
    buffer_load_dwordx4 v12, s[32:35], s47 offen offset:2048 lds
    buffer_load_dwordx4 v12, s[32:35], s47 offen offset:3072 lds
    s_add_u32 m0, s44, 8192
    s_add_u32 s47, s45, 8192
    buffer_load_dwordx4 v12, s[32:35], s47 offen offset:0 lds
    buffer_load_dwordx4 v12, s[32:35], s47 offen offset:1024 lds
    buffer_load_dwordx4 v12, s[32:35], s47 offen offset:2048 lds
    buffer_load_dwordx4 v12, s[32:35], s47 offen offset:3072 lds
    s_waitcnt vmcnt(59)
    s_add_u32 m0, s44, 12288
    s_add_u32 s47, s45, 12288
    buffer_load_dwordx4 v12, s[32:35], s47 offen offset:0 lds
    buffer_load_dwordx4 v12, s[32:35], s47 offen offset:1024 lds
    buffer_load_dwordx4 v12, s[32:35], s47 offen offset:2048 lds
    buffer_load_dwordx4 v12, s[32:35], s47 offen offset:3072 lds
    s_add_u32 s45, s45, 16384
    s_add_u32 s44, s44, 32768
    s_cmp_eq_u32 s44, 163840
    s_cselect_b32 s44, 0, s44
    s_sub_u32 s61, s61, 1
    s_cmp_lg_u32 s61, 0
    s_cbranch_scc1 LL_31
    s_lshl_b32 s45, s53, 18
    s_add_u32 s45, s45, 0xe00000
    s_mov_b32 s61, 16
LL_32:
    s_waitcnt vmcnt(48)
    s_barrier
    s_add_u32 m0, s44, 0
    s_add_u32 s47, s45, 0
    buffer_load_dwordx4 v12, s[32:35], s47 offen offset:0 lds
    buffer_load_dwordx4 v12, s[32:35], s47 offen offset:1024 lds
    buffer_load_dwordx4 v12, s[32:35], s47 offen offset:2048 lds
    buffer_load_dwordx4 v12, s[32:35], s47 offen offset:3072 lds
    s_add_u32 m0, s44, 4096
    s_add_u32 s47, s45, 4096
    buffer_load_dwordx4 v12, s[32:35], s47 offen offset:0 lds
    buffer_load_dwordx4 v12, s[32:35], s47 offen offset:1024 lds
    buffer_load_dwordx4 v12, s[32:35], s47 offen offset:2048 lds
    buffer_load_dwordx4 v12, s[32:35], s47 offen offset:3072 lds
    s_add_u32 m0, s44, 8192
    s_add_u32 s47, s45, 8192
    buffer_load_dwordx4 v12, s[32:35], s47 offen offset:0 lds
    buffer_load_dwordx4 v12, s[32:35], s47 offen offset:1024 lds
    buffer_load_dwordx4 v12, s[32:35], s47 offen offset:2048 lds
    buffer_load_dwordx4 v12, s[32:35], s47 offen offset:3072 lds
    s_waitcnt vmcnt(59)
    s_add_u32 m0, s44, 12288
    s_add_u32 s47, s45, 12288
    buffer_load_dwordx4 v12, s[32:35], s47 offen offset:0 lds
    buffer_load_dwordx4 v12, s[32:35], s47 offen offset:1024 lds
    buffer_load_dwordx4 v12, s[32:35], s47 offen offset:2048 lds
    buffer_load_dwordx4 v12, s[32:35], s47 offen offset:3072 lds
    s_add_u32 s45, s45, 16384
    s_add_u32 s44, s44, 32768
    s_cmp_eq_u32 s44, 163840
    s_cselect_b32 s44, 0, s44
    s_sub_u32 s61, s61, 1
    s_cmp_lg_u32 s61, 0
    s_cbranch_scc1 LL_32
    s_waitcnt vmcnt(48)
    s_barrier
    s_waitcnt vmcnt(32)
    s_barrier
    s_waitcnt vmcnt(16)
    s_barrier
    s_waitcnt vmcnt(0)
    s_barrier
    s_branch LE_27
LB_26:
    s_mov_b32 s44, 98304
    s_mul_i32 s45, s53, 917504
    s_add_u32 s45, s45, 327680
    s_waitcnt vmcnt(22)
    s_barrier
    s_add_u32 m0, s44, 0
    s_add_u32 s47, s45, 0
    buffer_load_dwordx4 v12, s[32:35], s47 offen offset:0 lds
    buffer_load_dwordx4 v12, s[32:35], s47 offen offset:1024 lds
    buffer_load_dwordx4 v12, s[32:35], s47 offen offset:2048 lds
    buffer_load_dwordx4 v12, s[32:35], s47 offen offset:3072 lds
    s_add_u32 m0, s44, 4096
    s_add_u32 s47, s45, 4096
    buffer_load_dwordx4 v12, s[32:35], s47 offen offset:0 lds
    buffer_load_dwordx4 v12, s[32:35], s47 offen offset:1024 lds
    buffer_load_dwordx4 v12, s[32:35], s47 offen offset:2048 lds
    buffer_load_dwordx4 v12, s[32:35], s47 offen offset:3072 lds
    s_add_u32 m0, s44, 8192
    s_add_u32 s47, s45, 8192
    buffer_load_dwordx4 v12, s[32:35], s47 offen offset:0 lds
    buffer_load_dwordx4 v12, s[32:35], s47 offen offset:1024 lds
    buffer_load_dwordx4 v12, s[32:35], s47 offen offset:2048 lds
    buffer_load_dwordx4 v12, s[32:35], s47 offen offset:3072 lds
    s_waitcnt vmcnt(59)
    s_add_u32 m0, s44, 12288
    s_add_u32 s47, s45, 12288
    buffer_load_dwordx4 v12, s[32:35], s47 offen offset:0 lds
    buffer_load_dwordx4 v12, s[32:35], s47 offen offset:1024 lds
    buffer_load_dwordx4 v12, s[32:35], s47 offen offset:2048 lds
    buffer_load_dwordx4 v12, s[32:35], s47 offen offset:3072 lds
    s_add_u32 s45, s45, 16384
    s_add_u32 s44, s44, 32768
    s_cmp_eq_u32 s44, 163840
    s_cselect_b32 s44, 0, s44
    s_waitcnt vmcnt(16)
    s_barrier
    s_add_u32 m0, s44, 0
    s_add_u32 s47, s45, 0
    buffer_load_dwordx4 v12, s[32:35], s47 offen offset:0 lds
    buffer_load_dwordx4 v12, s[32:35], s47 offen offset:1024 lds
    buffer_load_dwordx4 v12, s[32:35], s47 offen offset:2048 lds
    buffer_load_dwordx4 v12, s[32:35], s47 offen offset:3072 lds
    s_add_u32 m0, s44, 4096
    s_add_u32 s47, s45, 4096
    buffer_load_dwordx4 v12, s[32:35], s47 offen offset:0 lds
    buffer_load_dwordx4 v12, s[32:35], s47 offen offset:1024 lds
    buffer_load_dwordx4 v12, s[32:35], s47 offen offset:2048 lds
    buffer_load_dwordx4 v12, s[32:35], s47 offen offset:3072 lds
    s_add_u32 m0, s44, 8192
    s_add_u32 s47, s45, 8192
    buffer_load_dwordx4 v12, s[32:35], s47 offen offset:0 lds
    buffer_load_dwordx4 v12, s[32:35], s47 offen offset:1024 lds
    buffer_load_dwordx4 v12, s[32:35], s47 offen offset:2048 lds
    buffer_load_dwordx4 v12, s[32:35], s47 offen offset:3072 lds
    s_waitcnt vmcnt(59)
    s_add_u32 m0, s44, 12288
    s_add_u32 s47, s45, 12288
    buffer_load_dwordx4 v12, s[32:35], s47 offen offset:0 lds
    buffer_load_dwordx4 v12, s[32:35], s47 offen offset:1024 lds
    buffer_load_dwordx4 v12, s[32:35], s47 offen offset:2048 lds
    buffer_load_dwordx4 v12, s[32:35], s47 offen offset:3072 lds
    s_add_u32 s45, s45, 16384
    s_add_u32 s44, s44, 32768
    s_cmp_eq_u32 s44, 163840
    s_cselect_b32 s44, 0, s44
    s_add_u32 m0, s44, 0
    s_add_u32 s47, s45, 0
    buffer_load_dwordx4 v12, s[32:35], s47 offen offset:0 lds
    buffer_load_dwordx4 v12, s[32:35], s47 offen offset:1024 lds
    buffer_load_dwordx4 v12, s[32:35], s47 offen offset:2048 lds
    buffer_load_dwordx4 v12, s[32:35], s47 offen offset:3072 lds
    s_add_u32 m0, s44, 4096
    s_add_u32 s47, s45, 4096
    buffer_load_dwordx4 v12, s[32:35], s47 offen offset:0 lds
    buffer_load_dwordx4 v12, s[32:35], s47 offen offset:1024 lds
    buffer_load_dwordx4 v12, s[32:35], s47 offen offset:2048 lds
    buffer_load_dwordx4 v12, s[32:35], s47 offen offset:3072 lds
    s_add_u32 m0, s44, 8192
    s_add_u32 s47, s45, 8192
    buffer_load_dwordx4 v12, s[32:35], s47 offen offset:0 lds
    buffer_load_dwordx4 v12, s[32:35], s47 offen offset:1024 lds
    buffer_load_dwordx4 v12, s[32:35], s47 offen offset:2048 lds
    buffer_load_dwordx4 v12, s[32:35], s47 offen offset:3072 lds
    s_waitcnt vmcnt(59)
    s_add_u32 m0, s44, 12288
    s_add_u32 s47, s45, 12288
    buffer_load_dwordx4 v12, s[32:35], s47 offen offset:0 lds
    buffer_load_dwordx4 v12, s[32:35], s47 offen offset:1024 lds
    buffer_load_dwordx4 v12, s[32:35], s47 offen offset:2048 lds
    buffer_load_dwordx4 v12, s[32:35], s47 offen offset:3072 lds
    s_add_u32 s45, s45, 16384
    s_add_u32 s44, s44, 32768
    s_cmp_eq_u32 s44, 163840
    s_cselect_b32 s44, 0, s44
    s_waitcnt vmcnt(32)
    s_barrier
    s_add_u32 m0, s44, 0
    s_add_u32 s47, s45, 0
    buffer_load_dwordx4 v12, s[32:35], s47 offen offset:0 lds
    buffer_load_dwordx4 v12, s[32:35], s47 offen offset:1024 lds
    buffer_load_dwordx4 v12, s[32:35], s47 offen offset:2048 lds
    buffer_load_dwordx4 v12, s[32:35], s47 offen offset:3072 lds
    s_add_u32 m0, s44, 4096
    s_add_u32 s47, s45, 4096
    buffer_load_dwordx4 v12, s[32:35], s47 offen offset:0 lds
    buffer_load_dwordx4 v12, s[32:35], s47 offen offset:1024 lds
    buffer_load_dwordx4 v12, s[32:35], s47 offen offset:2048 lds
    buffer_load_dwordx4 v12, s[32:35], s47 offen offset:3072 lds
    s_add_u32 m0, s44, 8192
    s_add_u32 s47, s45, 8192
    buffer_load_dwordx4 v12, s[32:35], s47 offen offset:0 lds
    buffer_load_dwordx4 v12, s[32:35], s47 offen offset:1024 lds
    buffer_load_dwordx4 v12, s[32:35], s47 offen offset:2048 lds
    buffer_load_dwordx4 v12, s[32:35], s47 offen offset:3072 lds
    s_waitcnt vmcnt(59)
    s_add_u32 m0, s44, 12288
    s_add_u32 s47, s45, 12288
    buffer_load_dwordx4 v12, s[32:35], s47 offen offset:0 lds
    buffer_load_dwordx4 v12, s[32:35], s47 offen offset:1024 lds
    buffer_load_dwordx4 v12, s[32:35], s47 offen offset:2048 lds
    buffer_load_dwordx4 v12, s[32:35], s47 offen offset:3072 lds
    s_add_u32 s45, s45, 16384
    s_add_u32 s44, s44, 32768
    s_cmp_eq_u32 s44, 163840
    s_cselect_b32 s44, 0, s44
    s_add_u32 m0, s44, 0
    s_add_u32 s47, s45, 0
    buffer_load_dwordx4 v12, s[32:35], s47 offen offset:0 lds
    buffer_load_dwordx4 v12, s[32:35], s47 offen offset:1024 lds
    buffer_load_dwordx4 v12, s[32:35], s47 offen offset:2048 lds
    buffer_load_dwordx4 v12, s[32:35], s47 offen offset:3072 lds
    s_add_u32 m0, s44, 4096
    s_add_u32 s47, s45, 4096
    buffer_load_dwordx4 v12, s[32:35], s47 offen offset:0 lds
    buffer_load_dwordx4 v12, s[32:35], s47 offen offset:1024 lds
    buffer_load_dwordx4 v12, s[32:35], s47 offen offset:2048 lds
    buffer_load_dwordx4 v12, s[32:35], s47 offen offset:3072 lds
    s_add_u32 m0, s44, 8192
    s_add_u32 s47, s45, 8192
    buffer_load_dwordx4 v12, s[32:35], s47 offen offset:0 lds
    buffer_load_dwordx4 v12, s[32:35], s47 offen offset:1024 lds
    buffer_load_dwordx4 v12, s[32:35], s47 offen offset:2048 lds
    buffer_load_dwordx4 v12, s[32:35], s47 offen offset:3072 lds
    s_waitcnt vmcnt(59)
    s_add_u32 m0, s44, 12288
    s_add_u32 s47, s45, 12288
    buffer_load_dwordx4 v12, s[32:35], s47 offen offset:0 lds
    buffer_load_dwordx4 v12, s[32:35], s47 offen offset:1024 lds
    buffer_load_dwordx4 v12, s[32:35], s47 offen offset:2048 lds
    buffer_load_dwordx4 v12, s[32:35], s47 offen offset:3072 lds
    s_add_u32 s45, s45, 16384
    s_add_u32 s44, s44, 32768
    s_cmp_eq_u32 s44, 163840
    s_cselect_b32 s44, 0, s44
    s_mov_b32 s61, 31
LL_40:
    s_waitcnt vmcnt(48)
    s_barrier
    s_add_u32 m0, s44, 0
    s_add_u32 s47, s45, 0
    buffer_load_dwordx4 v12, s[32:35], s47 offen offset:0 lds
    buffer_load_dwordx4 v12, s[32:35], s47 offen offset:1024 lds
    buffer_load_dwordx4 v12, s[32:35], s47 offen offset:2048 lds
    buffer_load_dwordx4 v12, s[32:35], s47 offen offset:3072 lds
    s_add_u32 m0, s44, 4096
    s_add_u32 s47, s45, 4096
    buffer_load_dwordx4 v12, s[32:35], s47 offen offset:0 lds
    buffer_load_dwordx4 v12, s[32:35], s47 offen offset:1024 lds
    buffer_load_dwordx4 v12, s[32:35], s47 offen offset:2048 lds
    buffer_load_dwordx4 v12, s[32:35], s47 offen offset:3072 lds
    s_add_u32 m0, s44, 8192
    s_add_u32 s47, s45, 8192
    buffer_load_dwordx4 v12, s[32:35], s47 offen offset:0 lds
    buffer_load_dwordx4 v12, s[32:35], s47 offen offset:1024 lds
    buffer_load_dwordx4 v12, s[32:35], s47 offen offset:2048 lds
    buffer_load_dwordx4 v12, s[32:35], s47 offen offset:3072 lds
    s_waitcnt vmcnt(59)
    s_add_u32 m0, s44, 12288
    s_add_u32 s47, s45, 12288
    buffer_load_dwordx4 v12, s[32:35], s47 offen offset:0 lds
    buffer_load_dwordx4 v12, s[32:35], s47 offen offset:1024 lds
    buffer_load_dwordx4 v12, s[32:35], s47 offen offset:2048 lds
    buffer_load_dwordx4 v12, s[32:35], s47 offen offset:3072 lds
    s_add_u32 s45, s45, 16384
    s_add_u32 s44, s44, 32768
    s_cmp_eq_u32 s44, 163840
    s_cselect_b32 s44, 0, s44
    s_sub_u32 s61, s61, 1
    s_cmp_lg_u32 s61, 0
    s_cbranch_scc1 LL_40
    s_waitcnt vmcnt(48)
    s_barrier
    s_waitcnt vmcnt(32)
    s_barrier
    s_waitcnt vmcnt(16)
    s_barrier
    s_waitcnt vmcnt(0)
    s_barrier
LE_27:
    s_endpgm
L_HELP:
    s_and_b32 s62, s2, 7
    s_lshr_b32 s63, s2, 3
    s_and_b32 s53, s62, 1
    s_lshl_b32 s53, s53, 3
    s_lshr_b32 s64, s63, 2
    s_add_u32 s53, s53, s64
    s_lshr_b32 s54, s62, 1
    s_lshl_b32 s54, s54, 2
    s_and_b32 s64, s63, 3
    s_add_u32 s54, s54, s64
    s_lshr_b32 s57, s54, 3
    s_and_b32 s58, s54, 7
    s_and_b32 s55, s52, 1
    s_lshr_b32 s56, s52, 1
    s_waitcnt lgkmcnt(0)
    s_mov_b32 s28, s4
    s_mov_b32 s29, s5
    s_mov_b32 s30, 0x400000
    s_mov_b32 s31, 0x20000
    s_mov_b32 s32, s20
    s_mov_b32 s33, s21
    s_mov_b32 s34, 0x800
    s_mov_b32 s35, 0x20000
    s_mov_b32 s36, s26
    s_mov_b32 s37, s27
    s_mov_b32 s38, 0x10000000
    s_mov_b32 s39, 0x20000
    s_mov_b32 s40, s24
    s_mov_b32 s41, s25
    s_mov_b32 s42, 0x100
    s_mov_b32 s43, 0x20000
    v_lshlrev_b32 v20, 7, v1
    v_mov_b32 v2, 0x7f000000
    v_cmp_gt_u32 vcc, 56, v1
    s_nop 1
    v_cndmask_b32 v21, v2, v20, vcc
    v_lshrrev_b32 v2, 3, v1
    v_lshlrev_b32 v22, 11, v2
    v_and_b32 v3, 7, v1
    v_lshlrev_b32 v4, 7, v3
    v_add_u32 v22, v22, v4
    v_mov_b32 v26, 0x7f000000
    v_cmp_gt_u32 vcc, 14, v1
    s_nop 1
    v_cndmask_b32 v24, v26, v20, vcc
    v_lshrrev_b32 v25, 2, v1
    v_lshlrev_b32 v25, 11, v25
    v_and_b32 v27, 3, v1
    v_lshlrev_b32 v27, 7, v27
    v_add_u32 v25, v25, v27
    v_cmp_gt_u32 vcc, 32, v1
    s_nop 1
    v_cndmask_b32 v25, v26, v25, vcc
    s_lshl_b32 s62, s53, 7
    s_lshl_b32 s63, s54, 3
    s_add_u32 s62, s62, s63
    v_add_u32 v5, s62, v2
    v_lshlrev_b32 v6, 11, v5
    v_lshlrev_b32 v7, 4, v3
    v_add_u32 v6, v6, v7
    s_barrier
    s_getpc_b64 s[44:45]
L_CPH_45:
    s_sub_u32 s44, s44, L_CPH_45-L_KSTART
    s_subb_u32 s45, s45, 0
    s_mov_b32 s46, L_KEND-L_KSTART
    s_mov_b32 s47, 0x20000
    s_lshr_b32 s62, s2, 3
    s_and_b32 s62, s62, 7
    s_lshl_b32 s62, s62, 13
    buffer_load_dword v199, v20, s[44:47], s62 offen
    s_mov_b32 s44, s12
    s_mov_b32 s45, s13
    s_mov_b32 s46, 0x700000
    s_mov_b32 s47, 0x20000
    s_mul_i32 s62, s2, 7168
    s_add_u32 s62, s62, 1376256
    buffer_load_dword v200, v21, s[44:47], s62 offen
    s_lshl_b32 s62, s2, 14
    s_add_u32 s62, s62, 384
    buffer_load_dword v201, v25, s[28:31], s62 offen
    s_lshl_b32 s62, s53, 3
    s_add_u32 s62, s62, s58
    s_lshl_b32 s62, s62, 7
    s_add_u32 s50, s62, 0x1b00000
    v_mov_b32 v8, 0
    v_mov_b32 v9, 0
    s_cmp_eq_u32 s57, 1
    s_cbranch_scc0 HC_46
    s_mov_b64 exec, 1
    buffer_store_dword v8, v9, s[36:39], s50 offen sc1
    s_mov_b64 exec, -1
HC_46:
    s_barrier
    buffer_load_dwordx4 v[64:67], v6, s[28:31], 0 offen offset:0
    buffer_load_dwordx4 v[128:131], v7, s[32:35], 0 offen offset:0
    buffer_load_dwordx4 v[68:71], v6, s[28:31], 0 offen offset:128
    buffer_load_dwordx4 v[132:135], v7, s[32:35], 0 offen offset:128
    buffer_load_dwordx4 v[72:75], v6, s[28:31], 0 offen offset:256
    buffer_load_dwordx4 v[136:139], v7, s[32:35], 0 offen offset:256
    buffer_load_dwordx4 v[76:79], v6, s[28:31], 0 offen offset:384
    buffer_load_dwordx4 v[140:143], v7, s[32:35], 0 offen offset:384
    buffer_load_dwordx4 v[80:83], v6, s[28:31], 0 offen offset:512
    buffer_load_dwordx4 v[144:147], v7, s[32:35], 0 offen offset:512
    buffer_load_dwordx4 v[84:87], v6, s[28:31], 0 offen offset:640
    buffer_load_dwordx4 v[148:151], v7, s[32:35], 0 offen offset:640
    buffer_load_dwordx4 v[88:91], v6, s[28:31], 0 offen offset:768
    buffer_load_dwordx4 v[152:155], v7, s[32:35], 0 offen offset:768
    buffer_load_dwordx4 v[92:95], v6, s[28:31], 0 offen offset:896
    buffer_load_dwordx4 v[156:159], v7, s[32:35], 0 offen offset:896
    buffer_load_dwordx4 v[96:99], v6, s[28:31], 0 offen offset:1024
    buffer_load_dwordx4 v[160:163], v7, s[32:35], 0 offen offset:1024
    buffer_load_dwordx4 v[100:103], v6, s[28:31], 0 offen offset:1152
    buffer_load_dwordx4 v[164:167], v7, s[32:35], 0 offen offset:1152
    buffer_load_dwordx4 v[104:107], v6, s[28:31], 0 offen offset:1280
    buffer_load_dwordx4 v[168:171], v7, s[32:35], 0 offen offset:1280
    buffer_load_dwordx4 v[108:111], v6, s[28:31], 0 offen offset:1408
    buffer_load_dwordx4 v[172:175], v7, s[32:35], 0 offen offset:1408
    buffer_load_dwordx4 v[112:115], v6, s[28:31], 0 offen offset:1536
    buffer_load_dwordx4 v[176:179], v7, s[32:35], 0 offen offset:1536
    buffer_load_dwordx4 v[116:119], v6, s[28:31], 0 offen offset:1664
    buffer_load_dwordx4 v[180:183], v7, s[32:35], 0 offen offset:1664
    buffer_load_dwordx4 v[120:123], v6, s[28:31], 0 offen offset:1792
    buffer_load_dwordx4 v[184:187], v7, s[32:35], 0 offen offset:1792
    buffer_load_dwordx4 v[124:127], v6, s[28:31], 0 offen offset:1920
    buffer_load_dwordx4 v[188:191], v7, s[32:35], 0 offen offset:1920
    s_mov_b32 s44, s12
    s_mov_b32 s45, s13
    s_mov_b32 s46, 0x700000
    s_mov_b32 s47, 0x20000
    s_mul_i32 s62, s2, 7168
    s_add_u32 s62, s62, 3211264
    buffer_load_dword v202, v21, s[44:47], s62 offen
    s_barrier
    s_mov_b32 s44, s12
    s_mov_b32 s45, s13
    s_mov_b32 s46, 0x700000
    s_mov_b32 s47, 0x20000
    s_mul_i32 s62, s2, 7168
    s_add_u32 s62, s62, 5046272
    buffer_load_dword v203, v21, s[44:47], s62 offen
    s_barrier
    s_mov_b32 s44, s12
    s_mov_b32 s45, s13
    s_mov_b32 s46, 0x700000
    s_mov_b32 s47, 0x20000
    s_mul_i32 s62, s2, 1792
    s_add_u32 s62, s62, 6881280
    buffer_load_dword v204, v24, s[44:47], s62 offen
    s_barrier
    s_mov_b32 s44, s6
    s_mov_b32 s45, s7
    s_mov_b32 s46, 0x600000
    s_mov_b32 s47, 0x20000
    s_mul_i32 s62, s2, 8192
    s_add_u32 s62, s62, 0
    buffer_load_dword v205, v20, s[44:47], s62 offen
    s_barrier
    s_waitcnt vmcnt(4)
    v_mov_b32 v10, 0
    v_mov_b32 v11, 0
    v_mov_b32 v12, 0
    v_mov_b32 v13, 0
    v_dot2_f32_bf16 v10, v64, v128, v10
    v_dot2_f32_bf16 v11, v65, v129, v11
    v_dot2_f32_bf16 v12, v66, v130, v12
    v_dot2_f32_bf16 v13, v67, v131, v13
    v_dot2_f32_bf16 v10, v68, v132, v10
    v_dot2_f32_bf16 v11, v69, v133, v11
    v_dot2_f32_bf16 v12, v70, v134, v12
    v_dot2_f32_bf16 v13, v71, v135, v13
    v_dot2_f32_bf16 v10, v72, v136, v10
    v_dot2_f32_bf16 v11, v73, v137, v11
    v_dot2_f32_bf16 v12, v74, v138, v12
    v_dot2_f32_bf16 v13, v75, v139, v13
    v_dot2_f32_bf16 v10, v76, v140, v10
    v_dot2_f32_bf16 v11, v77, v141, v11
    v_dot2_f32_bf16 v12, v78, v142, v12
    v_dot2_f32_bf16 v13, v79, v143, v13
    s_barrier
    s_mov_b32 s44, s6
    s_mov_b32 s45, s7
    s_mov_b32 s46, 0x600000
    s_mov_b32 s47, 0x20000
    s_mul_i32 s62, s2, 8192
    s_add_u32 s62, s62, 2097152
    buffer_load_dword v206, v20, s[44:47], s62 offen
    v_dot2_f32_bf16 v10, v80, v144, v10
    v_dot2_f32_bf16 v11, v81, v145, v11
    v_dot2_f32_bf16 v12, v82, v146, v12
    v_dot2_f32_bf16 v13, v83, v147, v13
    v_dot2_f32_bf16 v10, v84, v148, v10
    v_dot2_f32_bf16 v11, v85, v149, v11
    v_dot2_f32_bf16 v12, v86, v150, v12
    v_dot2_f32_bf16 v13, v87, v151, v13
    v_dot2_f32_bf16 v10, v88, v152, v10
    v_dot2_f32_bf16 v11, v89, v153, v11
    v_dot2_f32_bf16 v12, v90, v154, v12
    v_dot2_f32_bf16 v13, v91, v155, v13
    v_dot2_f32_bf16 v10, v92, v156, v10
    v_dot2_f32_bf16 v11, v93, v157, v11
    v_dot2_f32_bf16 v12, v94, v158, v12
    v_dot2_f32_bf16 v13, v95, v159, v13
    s_barrier
    v_dot2_f32_bf16 v10, v96, v160, v10
    v_dot2_f32_bf16 v11, v97, v161, v11
    v_dot2_f32_bf16 v12, v98, v162, v12
    v_dot2_f32_bf16 v13, v99, v163, v13
    v_dot2_f32_bf16 v10, v100, v164, v10
    v_dot2_f32_bf16 v11, v101, v165, v11
    v_dot2_f32_bf16 v12, v102, v166, v12
    v_dot2_f32_bf16 v13, v103, v167, v13
    v_dot2_f32_bf16 v10, v104, v168, v10
    v_dot2_f32_bf16 v11, v105, v169, v11
    v_dot2_f32_bf16 v12, v106, v170, v12
    v_dot2_f32_bf16 v13, v107, v171, v13
    v_dot2_f32_bf16 v10, v108, v172, v10
    v_dot2_f32_bf16 v11, v109, v173, v11
    v_dot2_f32_bf16 v12, v110, v174, v12
    v_dot2_f32_bf16 v13, v111, v175, v13
    s_barrier
    s_mov_b32 s44, s6
    s_mov_b32 s45, s7
    s_mov_b32 s46, 0x600000
    s_mov_b32 s47, 0x20000
    s_mul_i32 s62, s2, 8192
    s_add_u32 s62, s62, 4194304
    buffer_load_dword v207, v20, s[44:47], s62 offen
    v_dot2_f32_bf16 v10, v112, v176, v10
    v_dot2_f32_bf16 v11, v113, v177, v11
    v_dot2_f32_bf16 v12, v114, v178, v12
    v_dot2_f32_bf16 v13, v115, v179, v13
    v_dot2_f32_bf16 v10, v116, v180, v10
    v_dot2_f32_bf16 v11, v117, v181, v11
    v_dot2_f32_bf16 v12, v118, v182, v12
    v_dot2_f32_bf16 v13, v119, v183, v13
    v_dot2_f32_bf16 v10, v120, v184, v10
    v_dot2_f32_bf16 v11, v121, v185, v11
    v_dot2_f32_bf16 v12, v122, v186, v12
    v_dot2_f32_bf16 v13, v123, v187, v13
    v_dot2_f32_bf16 v10, v124, v188, v10
    v_dot2_f32_bf16 v11, v125, v189, v11
    v_dot2_f32_bf16 v12, v126, v190, v12
    v_dot2_f32_bf16 v13, v127, v191, v13
    s_barrier
    s_barrier
    s_mov_b32 s44, s16
    s_mov_b32 s45, s17
    s_mov_b32 s46, 0x700000
    s_mov_b32 s47, 0x20000
    s_mul_i32 s62, s2, 7168
    s_add_u32 s62, s62, 0
    buffer_load_dword v208, v21, s[44:47], s62 offen
    s_nop 1
    v_add_f32 v10, v10, v11
    v_add_f32 v12, v12, v13
    s_nop 0
    v_add_f32 v10, v10, v12
    s_nop 1
    v_add_f32_dpp v10, v10, v10 quad_perm:[1,0,3,2] row_mask:0xf bank_mask:0xf
    s_nop 1
    v_add_f32_dpp v10, v10, v10 quad_perm:[2,3,0,1] row_mask:0xf bank_mask:0xf
    s_nop 1
    v_add_f32_dpp v10, v10, v10 row_half_mirror row_mask:0xf bank_mask:0xf
    s_nop 1
    v_cvt_pk_bf16_f32 v10, v10, v10
    v_lshlrev_b32 v10, 16, v10
    v_mul_f32 v10, 0xbfb8aa3b, v10
    v_exp_f32 v10, v10
    s_nop 0
    v_add_f32 v10, 1.0, v10
    v_rcp_f32 v10, v10
    s_nop 0
    v_cvt_pk_bf16_f32 v10, v10, v10
    v_lshlrev_b32 v10, 16, v10
    v_lshlrev_b32 v11, 2, v5
    v_cmp_eq_u32 vcc, 0, v3
    s_mov_b32 s62, 0x1200000
    s_and_saveexec_b64 s[64:65], vcc
    buffer_store_dword v10, v11, s[36:39], s62 offen sc1
    s_mov_b64 exec, s[64:65]
    s_barrier
    s_barrier
    s_mov_b32 s44, s16
    s_mov_b32 s45, s17
    s_mov_b32 s46, 0x700000
    s_mov_b32 s47, 0x20000
    s_mul_i32 s62, s2, 7168
    s_add_u32 s62, s62, 1835008
    buffer_load_dword v209, v21, s[44:47], s62 offen
    s_barrier
    s_barrier
    s_mov_b32 s44, s16
    s_mov_b32 s45, s17
    s_mov_b32 s46, 0x700000
    s_mov_b32 s47, 0x20000
    s_mul_i32 s62, s2, 7168
    s_add_u32 s62, s62, 3670016
    buffer_load_dword v210, v21, s[44:47], s62 offen
    s_barrier
    s_barrier
    s_mov_b32 s44, s16
    s_mov_b32 s45, s17
    s_mov_b32 s46, 0x700000
    s_mov_b32 s47, 0x20000
    s_mul_i32 s62, s2, 7168
    s_add_u32 s62, s62, 5505024
    buffer_load_dword v211, v21, s[44:47], s62 offen
    s_barrier
    s_mov_b32 s44, s8
    s_mov_b32 s45, s9
    s_mov_b32 s46, 0x200000
    s_mov_b32 s47, 0x20000
    s_mul_i32 s62, s2, 8192
    s_add_u32 s62, s62, 0
    buffer_load_dword v212, v20, s[44:47], s62 offen
    s_mov_b32 s61, 3
HB_47:
    s_barrier
    s_sub_u32 s61, s61, 1
    s_cmp_lg_u32 s61, 0
    s_cbranch_scc1 HB_47
    s_waitcnt vmcnt(0)
    s_barrier
    s_and_b32 s62, s53, 7
    s_lshr_b32 s63, s53, 3
    s_lshl_b32 s63, s63, 5
    s_add_u32 s62, s62, s63
    s_add_u32 s62, s62, 0
    s_lshl_b32 s62, s62, 2
    v_mov_b32 v8, 1
    v_mov_b32 v9, s62
    s_mov_b64 exec, 1
    buffer_atomic_add v8, v9, s[40:43], 0 offen sc1
    s_mov_b64 exec, -1
    s_barrier
    v_mov_b32 v28, -1
    v_mov_b32 v29, -1
    v_mov_b32 v30, -1
    v_mov_b32 v31, -1
    v_lshlrev_b32 v32, 4, v1
    s_cmp_eq_u32 s57, 1
    s_cbranch_scc0 CL_48
    s_lshl_b32 s62, s53, 3
    s_add_u32 s62, s62, s58
    s_lshl_b32 s62, s62, 15
    s_add_u32 s62, s62, 0x1300000
    buffer_store_dwordx4 v[28:31], v32, s[36:39], s62 offen offset:0 sc1
    buffer_store_dwordx4 v[28:31], v32, s[36:39], s62 offen offset:1024 sc1
    buffer_store_dwordx4 v[28:31], v32, s[36:39], s62 offen offset:2048 sc1
    buffer_store_dwordx4 v[28:31], v32, s[36:39], s62 offen offset:3072 sc1
CL_48:
    s_barrier
    s_cmp_eq_u32 s57, 1
    s_cbranch_scc0 CL_49
    s_lshl_b32 s62, s53, 3
    s_add_u32 s62, s62, s58
    s_lshl_b32 s62, s62, 15
    s_add_u32 s62, s62, 0x1301000
    buffer_store_dwordx4 v[28:31], v32, s[36:39], s62 offen offset:0 sc1
    buffer_store_dwordx4 v[28:31], v32, s[36:39], s62 offen offset:1024 sc1
    buffer_store_dwordx4 v[28:31], v32, s[36:39], s62 offen offset:2048 sc1
    buffer_store_dwordx4 v[28:31], v32, s[36:39], s62 offen offset:3072 sc1
CL_49:
    s_barrier
    s_cmp_eq_u32 s57, 1
    s_cbranch_scc0 CL_50
    s_lshl_b32 s62, s53, 3
    s_add_u32 s62, s62, s58
    s_lshl_b32 s62, s62, 15
    s_add_u32 s62, s62, 0x1302000
    buffer_store_dwordx4 v[28:31], v32, s[36:39], s62 offen offset:0 sc1
    buffer_store_dwordx4 v[28:31], v32, s[36:39], s62 offen offset:1024 sc1
    buffer_store_dwordx4 v[28:31], v32, s[36:39], s62 offen offset:2048 sc1
    buffer_store_dwordx4 v[28:31], v32, s[36:39], s62 offen offset:3072 sc1
CL_50:
    s_barrier
    s_cmp_eq_u32 s57, 1
    s_cbranch_scc0 CL_51
    s_lshl_b32 s62, s53, 3
    s_add_u32 s62, s62, s58
    s_lshl_b32 s62, s62, 15
    s_add_u32 s62, s62, 0x1303000
    buffer_store_dwordx4 v[28:31], v32, s[36:39], s62 offen offset:0 sc1
    buffer_store_dwordx4 v[28:31], v32, s[36:39], s62 offen offset:1024 sc1
    buffer_store_dwordx4 v[28:31], v32, s[36:39], s62 offen offset:2048 sc1
    buffer_store_dwordx4 v[28:31], v32, s[36:39], s62 offen offset:3072 sc1
CL_51:
    s_barrier
    s_cmp_eq_u32 s57, 1
    s_cbranch_scc0 CL_52
    s_lshl_b32 s62, s53, 3
    s_add_u32 s62, s62, s58
    s_lshl_b32 s62, s62, 15
    s_add_u32 s62, s62, 0x1304000
    buffer_store_dwordx4 v[28:31], v32, s[36:39], s62 offen offset:0 sc1
    buffer_store_dwordx4 v[28:31], v32, s[36:39], s62 offen offset:1024 sc1
    buffer_store_dwordx4 v[28:31], v32, s[36:39], s62 offen offset:2048 sc1
    buffer_store_dwordx4 v[28:31], v32, s[36:39], s62 offen offset:3072 sc1
CL_52:
    s_barrier
    s_cmp_eq_u32 s57, 1
    s_cbranch_scc0 CL_53
    s_lshl_b32 s62, s53, 3
    s_add_u32 s62, s62, s58
    s_lshl_b32 s62, s62, 15
    s_add_u32 s62, s62, 0x1305000
    buffer_store_dwordx4 v[28:31], v32, s[36:39], s62 offen offset:0 sc1
    buffer_store_dwordx4 v[28:31], v32, s[36:39], s62 offen offset:1024 sc1
    buffer_store_dwordx4 v[28:31], v32, s[36:39], s62 offen offset:2048 sc1
    buffer_store_dwordx4 v[28:31], v32, s[36:39], s62 offen offset:3072 sc1
CL_53:
    s_barrier
    s_cmp_eq_u32 s57, 1
    s_cbranch_scc0 CL_54
    s_lshl_b32 s62, s53, 3
    s_add_u32 s62, s62, s58
    s_lshl_b32 s62, s62, 15
    s_add_u32 s62, s62, 0x1306000
    buffer_store_dwordx4 v[28:31], v32, s[36:39], s62 offen offset:0 sc1
    buffer_store_dwordx4 v[28:31], v32, s[36:39], s62 offen offset:1024 sc1
    buffer_store_dwordx4 v[28:31], v32, s[36:39], s62 offen offset:2048 sc1
    buffer_store_dwordx4 v[28:31], v32, s[36:39], s62 offen offset:3072 sc1
CL_54:
    s_and_b32 s62, s53, 7
    s_lshr_b32 s63, s53, 3
    s_lshl_b32 s63, s63, 5
    s_add_u32 s62, s62, s63
    s_add_u32 s62, s62, 0
    s_lshl_b32 s62, s62, 2
    v_mov_b32 v9, s62
    s_mov_b32 s63, 0x40000
PL_55:
    buffer_load_dword v8, v9, s[40:43], 0 offen sc1
    s_waitcnt vmcnt(0)
    v_readfirstlane_b32 s64, v8
    s_sub_u32 s63, s63, 1
    s_cmp_eq_u32 s64, 16
    s_cbranch_scc1 PD_56
    s_cmp_eq_u32 s63, 0
    s_cbranch_scc1 PD_56
    s_branch PL_55
PD_56:
    s_barrier
    s_cmp_eq_u32 s57, 1
    s_cbranch_scc0 CL_57
    s_lshl_b32 s62, s53, 3
    s_add_u32 s62, s62, s58
    s_lshl_b32 s62, s62, 15
    s_add_u32 s62, s62, 0x1307000
    buffer_store_dwordx4 v[28:31], v32, s[36:39], s62 offen offset:0 sc1
    buffer_store_dwordx4 v[28:31], v32, s[36:39], s62 offen offset:1024 sc1
    buffer_store_dwordx4 v[28:31], v32, s[36:39], s62 offen offset:2048 sc1
    buffer_store_dwordx4 v[28:31], v32, s[36:39], s62 offen offset:3072 sc1
CL_57:
    v_lshlrev_b32 v11, 3, v1
    s_lshl_b32 s62, s53, 9
    s_add_u32 s62, s62, 0x1200000
    buffer_load_dwordx2 v[14:15], v11, s[36:39], s62 offen sc1
    s_barrier
    s_waitcnt vmcnt(0)
    v_add_u32 v11, 88064, v11
    ds_write_b64 v11, v[14:15]
    s_waitcnt lgkmcnt(0)
    s_barrier
    s_mov_b32 s61, 5
HB_58:
    s_barrier
    s_sub_u32 s61, s61, 1
    s_cmp_lg_u32 s61, 0
    s_cbranch_scc1 HB_58
    s_waitcnt vmcnt(0)
    s_barrier
    s_and_b32 s62, s53, 7
    s_lshr_b32 s63, s53, 3
    s_lshl_b32 s63, s63, 5
    s_add_u32 s62, s62, s63
    s_add_u32 s62, s62, 16
    s_lshl_b32 s62, s62, 2
    v_mov_b32 v8, 1
    v_mov_b32 v9, s62
    s_mov_b64 exec, 1
    buffer_atomic_add v8, v9, s[40:43], 0 offen sc1
    s_mov_b64 exec, -1
    s_cmp_eq_u32 s57, 0
    s_cbranch_scc0 HLB_59
    s_mov_b32 s61, 11
HB_61:
    s_barrier
    s_sub_u32 s61, s61, 1
    s_cmp_lg_u32 s61, 0
    s_cbranch_scc1 HB_61
    s_and_b32 s62, s53, 7
    s_lshr_b32 s63, s53, 3
    s_lshl_b32 s63, s63, 5
    s_add_u32 s62, s62, s63
    s_add_u32 s62, s62, 16
    s_lshl_b32 s62, s62, 2
    v_mov_b32 v9, s62
    s_mov_b32 s63, 0x40000
PL_62:
    buffer_load_dword v8, v9, s[40:43], 0 offen sc1
    s_waitcnt vmcnt(0)
    v_readfirstlane_b32 s64, v8
    s_sub_u32 s63, s63, 1
    s_cmp_eq_u32 s64, 16
    s_cbranch_scc1 PD_63
    s_cmp_eq_u32 s63, 0
    s_cbranch_scc1 PD_63
    s_branch PL_62
PD_63:
    s_barrier
    s_mov_b32 s61, 19
HB_64:
    s_barrier
    s_sub_u32 s61, s61, 1
    s_cmp_lg_u32 s61, 0
    s_cbranch_scc1 HB_64
    s_branch HLE_60
HLB_59:
    s_mov_b32 s61, 31
HB_65:
    s_barrier
    s_sub_u32 s61, s61, 1
    s_cmp_lg_u32 s61, 0
    s_cbranch_scc1 HB_65
HLE_60:
    s_endpgm
L_COMP:
    s_and_b32 s62, s2, 7
    s_lshr_b32 s63, s2, 3
    s_and_b32 s53, s62, 1
    s_lshl_b32 s53, s53, 3
    s_lshr_b32 s64, s63, 2
    s_add_u32 s53, s53, s64
    s_lshr_b32 s54, s62, 1
    s_lshl_b32 s54, s54, 2
    s_and_b32 s64, s63, 3
    s_add_u32 s54, s54, s64
    s_lshr_b32 s57, s54, 3
    s_and_b32 s58, s54, 7
    s_and_b32 s55, s52, 1
    s_lshr_b32 s56, s52, 1
    s_waitcnt lgkmcnt(0)
    s_mov_b32 s28, s26
    s_mov_b32 s29, s27
    s_mov_b32 s30, 0x10000000
    s_mov_b32 s31, 0x20000
    s_mov_b32 s32, s22
    s_mov_b32 s33, s23
    s_mov_b32 s34, 0x400000
    s_mov_b32 s35, 0x20000
    s_mov_b32 s36, s14
    s_mov_b32 s37, s15
    s_mov_b32 s38, 0x1c00
    s_mov_b32 s39, 0x20000
    s_mov_b32 s40, s18
    s_mov_b32 s41, s19
    s_mov_b32 s42, 0x800
    s_mov_b32 s43, 0x20000
    v_lshrrev_b32 v3, 4, v1
    v_lshlrev_b32 v3, 3, v3
    s_mul_i32 s62, s54, 448
    s_mul_i32 s63, s56, 224
    s_add_u32 s62, s62, s63
    v_add_u32 v3, s62, v3
    buffer_load_dwordx2 v[100:101], v3, s[36:39], 0 offen offset:0
    buffer_load_dwordx2 v[102:103], v3, s[36:39], 0 offen offset:32
    buffer_load_dwordx2 v[104:105], v3, s[36:39], 0 offen offset:64
    buffer_load_dwordx2 v[106:107], v3, s[36:39], 0 offen offset:96
    buffer_load_dwordx2 v[108:109], v3, s[36:39], 0 offen offset:128
    buffer_load_dwordx2 v[110:111], v3, s[36:39], 0 offen offset:160
    buffer_load_dwordx2 v[112:113], v3, s[36:39], 0 offen offset:192
    s_barrier
    v_and_b32 v2, 15, v1
    v_lshrrev_b32 v3, 4, v1
    v_and_b32 v4, 7, v2
    v_xor_b32 v4, v4, v3
    v_lshlrev_b32 v4, 4, v4
    v_lshlrev_b32 v5, 7, v2
    v_add_u32 v4, v4, v5
    s_lshl_b32 s62, s55, 13
    v_add_u32 v6, s62, v4
    v_xor_b32 v7, 64, v6
    v_lshlrev_b32 v4, 3, v3
    v_lshrrev_b32 v5, 2, v2
    v_add_u32 v4, v4, v5
    v_mul_u32_u24 v4, 448, v4
    v_and_b32 v5, 3, v2
    v_lshlrev_b32 v5, 3, v5
    v_add_u32 v4, v4, v5
    s_mul_i32 s62, s56, 224
    s_add_u32 s62, s62, 16384
    v_add_u32 v4, s62, v4
    v_and_b32 v5, 1, v3
    v_lshlrev_b32 v5, 5, v5
    v_add_u32 v2, v4, v5
    v_sub_u32 v3, v4, v5
    s_cmp_eq_u32 s56, 0
    s_cselect_b64 vcc, -1, 0
    v_cndmask_b32 v8, v3, v2, vcc
    v_cndmask_b32 v9, v2, v3, vcc
    v_add_u32 v10, 45056, v6
    v_add_u32 v11, 45056, v7
    v_add_u32 v12, 45056, v8
    v_add_u32 v13, 45056, v9
    v_add_u32 v14, 90112, v6
    v_add_u32 v15, 90112, v7
    v_add_u32 v16, 90112, v8
    v_add_u32 v17, 90112, v9
    s_waitcnt vmcnt(0)
    v_lshlrev_b32 v28, 16, v100
    v_and_b32 v29, 0xffff0000, v100
    v_lshlrev_b32 v30, 16, v101
    v_and_b32 v31, 0xffff0000, v101
    v_lshlrev_b32 v32, 16, v102
    v_and_b32 v33, 0xffff0000, v102
    v_lshlrev_b32 v34, 16, v103
    v_and_b32 v35, 0xffff0000, v103
    v_lshlrev_b32 v36, 16, v104
    v_and_b32 v37, 0xffff0000, v104
    v_lshlrev_b32 v38, 16, v105
    v_and_b32 v39, 0xffff0000, v105
    v_lshlrev_b32 v40, 16, v106
    v_and_b32 v41, 0xffff0000, v106
    v_lshlrev_b32 v42, 16, v107
    v_and_b32 v43, 0xffff0000, v107
    v_lshlrev_b32 v44, 16, v108
    v_and_b32 v45, 0xffff0000, v108
    v_lshlrev_b32 v46, 16, v109
    v_and_b32 v47, 0xffff0000, v109
    v_lshlrev_b32 v48, 16, v110
    v_and_b32 v49, 0xffff0000, v110
    v_lshlrev_b32 v50, 16, v111
    v_and_b32 v51, 0xffff0000, v111
    v_lshlrev_b32 v52, 16, v112
    v_and_b32 v53, 0xffff0000, v112
    v_lshlrev_b32 v54, 16, v113
    v_and_b32 v55, 0xffff0000, v113
    s_barrier
    ds_read_b128 v[56:59], v6 offset:0
    ds_read_b64_tr_b16 v[72:73], v8 offset:0
    ds_read_b64_tr_b16 v[74:75], v8 offset:1792
    ds_read_b128 v[60:63], v6 offset:2048
    ds_read_b128 v[64:67], v6 offset:4096
    ds_read_b128 v[68:71], v6 offset:6144
    ds_read_b64_tr_b16 v[76:77], v9 offset:32
    ds_read_b64_tr_b16 v[78:79], v9 offset:1824
    ds_read_b64_tr_b16 v[80:81], v8 offset:64
    ds_read_b64_tr_b16 v[82:83], v8 offset:1856
    ds_read_b64_tr_b16 v[84:85], v9 offset:96
    ds_read_b64_tr_b16 v[86:87], v9 offset:1888
    ds_read_b64_tr_b16 v[88:89], v8 offset:128
    ds_read_b64_tr_b16 v[90:91], v8 offset:1920
    ds_read_b64_tr_b16 v[92:93], v9 offset:160
    ds_read_b64_tr_b16 v[94:95], v9 offset:1952
    ds_read_b64_tr_b16 v[96:97], v8 offset:192
    ds_read_b64_tr_b16 v[98:99], v8 offset:1984
    s_waitcnt lgkmcnt(0)
    v_mfma_f32_16x16x32_bf16 v[144:147], v[72:75], v[56:59], v[28:31]
    ds_read_b128 v[100:103], v7 offset:0
    v_mfma_f32_16x16x32_bf16 v[148:151], v[72:75], v[60:63], v[28:31]
    ds_read_b64_tr_b16 v[116:117], v8 offset:14336
    v_mfma_f32_16x16x32_bf16 v[152:155], v[72:75], v[64:67], v[28:31]
    ds_read_b64_tr_b16 v[118:119], v8 offset:16128
    v_mfma_f32_16x16x32_bf16 v[156:159], v[72:75], v[68:71], v[28:31]
    ds_read_b128 v[104:107], v7 offset:2048
    v_mfma_f32_16x16x32_bf16 v[160:163], v[76:79], v[56:59], v[32:35]
    ds_read_b128 v[108:111], v7 offset:4096
    v_mfma_f32_16x16x32_bf16 v[164:167], v[76:79], v[60:63], v[32:35]
    ds_read_b128 v[112:115], v7 offset:6144
    v_mfma_f32_16x16x32_bf16 v[168:171], v[76:79], v[64:67], v[32:35]
    ds_read_b64_tr_b16 v[120:121], v9 offset:14368
    v_mfma_f32_16x16x32_bf16 v[172:175], v[76:79], v[68:71], v[32:35]
    ds_read_b64_tr_b16 v[122:123], v9 offset:16160
    v_mfma_f32_16x16x32_bf16 v[176:179], v[80:83], v[56:59], v[36:39]
    ds_read_b64_tr_b16 v[124:125], v8 offset:14400
    v_mfma_f32_16x16x32_bf16 v[180:183], v[80:83], v[60:63], v[36:39]
    ds_read_b64_tr_b16 v[126:127], v8 offset:16192
    v_mfma_f32_16x16x32_bf16 v[184:187], v[80:83], v[64:67], v[36:39]
    ds_read_b64_tr_b16 v[128:129], v9 offset:14432
    v_mfma_f32_16x16x32_bf16 v[188:191], v[80:83], v[68:71], v[36:39]
    ds_read_b64_tr_b16 v[130:131], v9 offset:16224
    v_mfma_f32_16x16x32_bf16 v[192:195], v[84:87], v[56:59], v[40:43]
    ds_read_b64_tr_b16 v[132:133], v8 offset:14464
    v_mfma_f32_16x16x32_bf16 v[196:199], v[84:87], v[60:63], v[40:43]
    ds_read_b64_tr_b16 v[134:135], v8 offset:16256
    v_mfma_f32_16x16x32_bf16 v[200:203], v[84:87], v[64:67], v[40:43]
    ds_read_b64_tr_b16 v[136:137], v9 offset:14496
    v_mfma_f32_16x16x32_bf16 v[204:207], v[84:87], v[68:71], v[40:43]
    ds_read_b64_tr_b16 v[138:139], v9 offset:16288
    v_mfma_f32_16x16x32_bf16 v[208:211], v[88:91], v[56:59], v[44:47]
    ds_read_b64_tr_b16 v[140:141], v8 offset:14528
    v_mfma_f32_16x16x32_bf16 v[212:215], v[88:91], v[60:63], v[44:47]
    ds_read_b64_tr_b16 v[142:143], v8 offset:16320
    v_mfma_f32_16x16x32_bf16 v[216:219], v[88:91], v[64:67], v[44:47]
    v_mfma_f32_16x16x32_bf16 v[220:223], v[88:91], v[68:71], v[44:47]
    v_mfma_f32_16x16x32_bf16 v[224:227], v[92:95], v[56:59], v[48:51]
    v_mfma_f32_16x16x32_bf16 v[228:231], v[92:95], v[60:63], v[48:51]
    v_mfma_f32_16x16x32_bf16 v[232:235], v[92:95], v[64:67], v[48:51]
    v_mfma_f32_16x16x32_bf16 v[236:239], v[92:95], v[68:71], v[48:51]
    v_mfma_f32_16x16x32_bf16 v[240:243], v[96:99], v[56:59], v[52:55]
    v_mfma_f32_16x16x32_bf16 v[244:247], v[96:99], v[60:63], v[52:55]
    v_mfma_f32_16x16x32_bf16 v[248:251], v[96:99], v[64:67], v[52:55]
    v_mfma_f32_16x16x32_bf16 v[252:255], v[96:99], v[68:71], v[52:55]
    s_waitcnt lgkmcnt(0)
    v_mfma_f32_16x16x32_bf16 v[144:147], v[116:119], v[100:103], v[144:147]
    s_barrier
    v_mfma_f32_16x16x32_bf16 v[148:151], v[116:119], v[104:107], v[148:151]
    ds_read_b128 v[56:59], v10 offset:0
    v_mfma_f32_16x16x32_bf16 v[152:155], v[116:119], v[108:111], v[152:155]
    ds_read_b64_tr_b16 v[72:73], v12 offset:0
    v_mfma_f32_16x16x32_bf16 v[156:159], v[116:119], v[112:115], v[156:159]
    ds_read_b64_tr_b16 v[74:75], v12 offset:1792
    v_mfma_f32_16x16x32_bf16 v[160:163], v[120:123], v[100:103], v[160:163]
    ds_read_b128 v[60:63], v10 offset:2048
    v_mfma_f32_16x16x32_bf16 v[164:167], v[120:123], v[104:107], v[164:167]
    ds_read_b128 v[64:67], v10 offset:4096
    v_mfma_f32_16x16x32_bf16 v[168:171], v[120:123], v[108:111], v[168:171]
    ds_read_b128 v[68:71], v10 offset:6144
    v_mfma_f32_16x16x32_bf16 v[172:175], v[120:123], v[112:115], v[172:175]
    ds_read_b64_tr_b16 v[76:77], v13 offset:32
    v_mfma_f32_16x16x32_bf16 v[176:179], v[124:127], v[100:103], v[176:179]
    ds_read_b64_tr_b16 v[78:79], v13 offset:1824
    v_mfma_f32_16x16x32_bf16 v[180:183], v[124:127], v[104:107], v[180:183]
    ds_read_b64_tr_b16 v[80:81], v12 offset:64
    v_mfma_f32_16x16x32_bf16 v[184:187], v[124:127], v[108:111], v[184:187]
    ds_read_b64_tr_b16 v[82:83], v12 offset:1856
    v_mfma_f32_16x16x32_bf16 v[188:191], v[124:127], v[112:115], v[188:191]
    ds_read_b64_tr_b16 v[84:85], v13 offset:96
    v_mfma_f32_16x16x32_bf16 v[192:195], v[128:131], v[100:103], v[192:195]
    ds_read_b64_tr_b16 v[86:87], v13 offset:1888
    v_mfma_f32_16x16x32_bf16 v[196:199], v[128:131], v[104:107], v[196:199]
    ds_read_b64_tr_b16 v[88:89], v12 offset:128
    v_mfma_f32_16x16x32_bf16 v[200:203], v[128:131], v[108:111], v[200:203]
    ds_read_b64_tr_b16 v[90:91], v12 offset:1920
    v_mfma_f32_16x16x32_bf16 v[204:207], v[128:131], v[112:115], v[204:207]
    ds_read_b64_tr_b16 v[92:93], v13 offset:160
    v_mfma_f32_16x16x32_bf16 v[208:211], v[132:135], v[100:103], v[208:211]
    ds_read_b64_tr_b16 v[94:95], v13 offset:1952
    v_mfma_f32_16x16x32_bf16 v[212:215], v[132:135], v[104:107], v[212:215]
    ds_read_b64_tr_b16 v[96:97], v12 offset:192
    v_mfma_f32_16x16x32_bf16 v[216:219], v[132:135], v[108:111], v[216:219]
    ds_read_b64_tr_b16 v[98:99], v12 offset:1984
    v_mfma_f32_16x16x32_bf16 v[220:223], v[132:135], v[112:115], v[220:223]
    v_mfma_f32_16x16x32_bf16 v[224:227], v[136:139], v[100:103], v[224:227]
    v_mfma_f32_16x16x32_bf16 v[228:231], v[136:139], v[104:107], v[228:231]
    v_mfma_f32_16x16x32_bf16 v[232:235], v[136:139], v[108:111], v[232:235]
    v_mfma_f32_16x16x32_bf16 v[236:239], v[136:139], v[112:115], v[236:239]
    v_mfma_f32_16x16x32_bf16 v[240:243], v[140:143], v[100:103], v[240:243]
    v_mfma_f32_16x16x32_bf16 v[244:247], v[140:143], v[104:107], v[244:247]
    v_mfma_f32_16x16x32_bf16 v[248:251], v[140:143], v[108:111], v[248:251]
    v_mfma_f32_16x16x32_bf16 v[252:255], v[140:143], v[112:115], v[252:255]
    v_lshrrev_b32 v3, 4, v1
    v_lshlrev_b32 v3, 3, v3
    s_lshl_b32 s62, s58, 8
    s_lshl_b32 s63, s56, 7
    s_add_u32 s62, s62, s63
    v_add_u32 v3, s62, v3
    buffer_load_dwordx2 v[48:49], v3, s[40:43], 0 offen offset:0
    buffer_load_dwordx2 v[50:51], v3, s[40:43], 0 offen offset:32
    buffer_load_dwordx2 v[52:53], v3, s[40:43], 0 offen offset:64
    buffer_load_dwordx2 v[54:55], v3, s[40:43], 0 offen offset:96
    s_mov_b32 s61, 4
LP_66:
    s_waitcnt lgkmcnt(0)
    v_mfma_f32_16x16x32_bf16 v[144:147], v[72:75], v[56:59], v[144:147]
    ds_read_b128 v[100:103], v11 offset:0
    v_mfma_f32_16x16x32_bf16 v[148:151], v[72:75], v[60:63], v[148:151]
    ds_read_b64_tr_b16 v[116:117], v12 offset:14336
    v_mfma_f32_16x16x32_bf16 v[152:155], v[72:75], v[64:67], v[152:155]
    ds_read_b64_tr_b16 v[118:119], v12 offset:16128
    v_mfma_f32_16x16x32_bf16 v[156:159], v[72:75], v[68:71], v[156:159]
    ds_read_b128 v[104:107], v11 offset:2048
    v_mfma_f32_16x16x32_bf16 v[160:163], v[76:79], v[56:59], v[160:163]
    ds_read_b128 v[108:111], v11 offset:4096
    v_mfma_f32_16x16x32_bf16 v[164:167], v[76:79], v[60:63], v[164:167]
    ds_read_b128 v[112:115], v11 offset:6144
    v_mfma_f32_16x16x32_bf16 v[168:171], v[76:79], v[64:67], v[168:171]
    ds_read_b64_tr_b16 v[120:121], v13 offset:14368
    v_mfma_f32_16x16x32_bf16 v[172:175], v[76:79], v[68:71], v[172:175]
    ds_read_b64_tr_b16 v[122:123], v13 offset:16160
    v_mfma_f32_16x16x32_bf16 v[176:179], v[80:83], v[56:59], v[176:179]
    ds_read_b64_tr_b16 v[124:125], v12 offset:14400
    v_mfma_f32_16x16x32_bf16 v[180:183], v[80:83], v[60:63], v[180:183]
    ds_read_b64_tr_b16 v[126:127], v12 offset:16192
    v_mfma_f32_16x16x32_bf16 v[184:187], v[80:83], v[64:67], v[184:187]
    ds_read_b64_tr_b16 v[128:129], v13 offset:14432
    v_mfma_f32_16x16x32_bf16 v[188:191], v[80:83], v[68:71], v[188:191]
    ds_read_b64_tr_b16 v[130:131], v13 offset:16224
    v_mfma_f32_16x16x32_bf16 v[192:195], v[84:87], v[56:59], v[192:195]
    ds_read_b64_tr_b16 v[132:133], v12 offset:14464
    v_mfma_f32_16x16x32_bf16 v[196:199], v[84:87], v[60:63], v[196:199]
    ds_read_b64_tr_b16 v[134:135], v12 offset:16256
    v_mfma_f32_16x16x32_bf16 v[200:203], v[84:87], v[64:67], v[200:203]
    ds_read_b64_tr_b16 v[136:137], v13 offset:14496
    v_mfma_f32_16x16x32_bf16 v[204:207], v[84:87], v[68:71], v[204:207]
    ds_read_b64_tr_b16 v[138:139], v13 offset:16288
    v_mfma_f32_16x16x32_bf16 v[208:211], v[88:91], v[56:59], v[208:211]
    ds_read_b64_tr_b16 v[140:141], v12 offset:14528
    v_mfma_f32_16x16x32_bf16 v[212:215], v[88:91], v[60:63], v[212:215]
    ds_read_b64_tr_b16 v[142:143], v12 offset:16320
    v_mfma_f32_16x16x32_bf16 v[216:219], v[88:91], v[64:67], v[216:219]
    v_mfma_f32_16x16x32_bf16 v[220:223], v[88:91], v[68:71], v[220:223]
    v_mfma_f32_16x16x32_bf16 v[224:227], v[92:95], v[56:59], v[224:227]
    v_mfma_f32_16x16x32_bf16 v[228:231], v[92:95], v[60:63], v[228:231]
    v_mfma_f32_16x16x32_bf16 v[232:235], v[92:95], v[64:67], v[232:235]
    v_mfma_f32_16x16x32_bf16 v[236:239], v[92:95], v[68:71], v[236:239]
    v_mfma_f32_16x16x32_bf16 v[240:243], v[96:99], v[56:59], v[240:243]
    v_mfma_f32_16x16x32_bf16 v[244:247], v[96:99], v[60:63], v[244:247]
    v_mfma_f32_16x16x32_bf16 v[248:251], v[96:99], v[64:67], v[248:251]
    v_mfma_f32_16x16x32_bf16 v[252:255], v[96:99], v[68:71], v[252:255]
    s_waitcnt lgkmcnt(0)
    v_mfma_f32_16x16x32_bf16 v[144:147], v[116:119], v[100:103], v[144:147]
    s_barrier
    v_mfma_f32_16x16x32_bf16 v[148:151], v[116:119], v[104:107], v[148:151]
    ds_read_b128 v[56:59], v14 offset:0
    v_mfma_f32_16x16x32_bf16 v[152:155], v[116:119], v[108:111], v[152:155]
    ds_read_b64_tr_b16 v[72:73], v16 offset:0
    v_mfma_f32_16x16x32_bf16 v[156:159], v[116:119], v[112:115], v[156:159]
    ds_read_b64_tr_b16 v[74:75], v16 offset:1792
    v_mfma_f32_16x16x32_bf16 v[160:163], v[120:123], v[100:103], v[160:163]
    ds_read_b128 v[60:63], v14 offset:2048
    v_mfma_f32_16x16x32_bf16 v[164:167], v[120:123], v[104:107], v[164:167]
    ds_read_b128 v[64:67], v14 offset:4096
    v_mfma_f32_16x16x32_bf16 v[168:171], v[120:123], v[108:111], v[168:171]
    ds_read_b128 v[68:71], v14 offset:6144
    v_mfma_f32_16x16x32_bf16 v[172:175], v[120:123], v[112:115], v[172:175]
    ds_read_b64_tr_b16 v[76:77], v17 offset:32
    v_mfma_f32_16x16x32_bf16 v[176:179], v[124:127], v[100:103], v[176:179]
    ds_read_b64_tr_b16 v[78:79], v17 offset:1824
    v_mfma_f32_16x16x32_bf16 v[180:183], v[124:127], v[104:107], v[180:183]
    ds_read_b64_tr_b16 v[80:81], v16 offset:64
    v_mfma_f32_16x16x32_bf16 v[184:187], v[124:127], v[108:111], v[184:187]
    ds_read_b64_tr_b16 v[82:83], v16 offset:1856
    v_mfma_f32_16x16x32_bf16 v[188:191], v[124:127], v[112:115], v[188:191]
    ds_read_b64_tr_b16 v[84:85], v17 offset:96
    v_mfma_f32_16x16x32_bf16 v[192:195], v[128:131], v[100:103], v[192:195]
    ds_read_b64_tr_b16 v[86:87], v17 offset:1888
    v_mfma_f32_16x16x32_bf16 v[196:199], v[128:131], v[104:107], v[196:199]
    ds_read_b64_tr_b16 v[88:89], v16 offset:128
    v_mfma_f32_16x16x32_bf16 v[200:203], v[128:131], v[108:111], v[200:203]
    ds_read_b64_tr_b16 v[90:91], v16 offset:1920
    v_mfma_f32_16x16x32_bf16 v[204:207], v[128:131], v[112:115], v[204:207]
    ds_read_b64_tr_b16 v[92:93], v17 offset:160
    v_mfma_f32_16x16x32_bf16 v[208:211], v[132:135], v[100:103], v[208:211]
    ds_read_b64_tr_b16 v[94:95], v17 offset:1952
    v_mfma_f32_16x16x32_bf16 v[212:215], v[132:135], v[104:107], v[212:215]
    ds_read_b64_tr_b16 v[96:97], v16 offset:192
    v_mfma_f32_16x16x32_bf16 v[216:219], v[132:135], v[108:111], v[216:219]
    ds_read_b64_tr_b16 v[98:99], v16 offset:1984
    v_mfma_f32_16x16x32_bf16 v[220:223], v[132:135], v[112:115], v[220:223]
    v_mfma_f32_16x16x32_bf16 v[224:227], v[136:139], v[100:103], v[224:227]
    v_mfma_f32_16x16x32_bf16 v[228:231], v[136:139], v[104:107], v[228:231]
    v_mfma_f32_16x16x32_bf16 v[232:235], v[136:139], v[108:111], v[232:235]
    v_mfma_f32_16x16x32_bf16 v[236:239], v[136:139], v[112:115], v[236:239]
    v_mfma_f32_16x16x32_bf16 v[240:243], v[140:143], v[100:103], v[240:243]
    v_mfma_f32_16x16x32_bf16 v[244:247], v[140:143], v[104:107], v[244:247]
    v_mfma_f32_16x16x32_bf16 v[248:251], v[140:143], v[108:111], v[248:251]
    v_mfma_f32_16x16x32_bf16 v[252:255], v[140:143], v[112:115], v[252:255]
    s_waitcnt lgkmcnt(0)
    v_mfma_f32_16x16x32_bf16 v[144:147], v[72:75], v[56:59], v[144:147]
    ds_read_b128 v[100:103], v15 offset:0
    v_mfma_f32_16x16x32_bf16 v[148:151], v[72:75], v[60:63], v[148:151]
    ds_read_b64_tr_b16 v[116:117], v16 offset:14336
    v_mfma_f32_16x16x32_bf16 v[152:155], v[72:75], v[64:67], v[152:155]
    ds_read_b64_tr_b16 v[118:119], v16 offset:16128
    v_mfma_f32_16x16x32_bf16 v[156:159], v[72:75], v[68:71], v[156:159]
    ds_read_b128 v[104:107], v15 offset:2048
    v_mfma_f32_16x16x32_bf16 v[160:163], v[76:79], v[56:59], v[160:163]
    ds_read_b128 v[108:111], v15 offset:4096
    v_mfma_f32_16x16x32_bf16 v[164:167], v[76:79], v[60:63], v[164:167]
    ds_read_b128 v[112:115], v15 offset:6144
    v_mfma_f32_16x16x32_bf16 v[168:171], v[76:79], v[64:67], v[168:171]
    ds_read_b64_tr_b16 v[120:121], v17 offset:14368
    v_mfma_f32_16x16x32_bf16 v[172:175], v[76:79], v[68:71], v[172:175]
    ds_read_b64_tr_b16 v[122:123], v17 offset:16160
    v_mfma_f32_16x16x32_bf16 v[176:179], v[80:83], v[56:59], v[176:179]
    ds_read_b64_tr_b16 v[124:125], v16 offset:14400
    v_mfma_f32_16x16x32_bf16 v[180:183], v[80:83], v[60:63], v[180:183]
    ds_read_b64_tr_b16 v[126:127], v16 offset:16192
    v_mfma_f32_16x16x32_bf16 v[184:187], v[80:83], v[64:67], v[184:187]
    ds_read_b64_tr_b16 v[128:129], v17 offset:14432
    v_mfma_f32_16x16x32_bf16 v[188:191], v[80:83], v[68:71], v[188:191]
    ds_read_b64_tr_b16 v[130:131], v17 offset:16224
    v_mfma_f32_16x16x32_bf16 v[192:195], v[84:87], v[56:59], v[192:195]
    ds_read_b64_tr_b16 v[132:133], v16 offset:14464
    v_mfma_f32_16x16x32_bf16 v[196:199], v[84:87], v[60:63], v[196:199]
    ds_read_b64_tr_b16 v[134:135], v16 offset:16256
    v_mfma_f32_16x16x32_bf16 v[200:203], v[84:87], v[64:67], v[200:203]
    ds_read_b64_tr_b16 v[136:137], v17 offset:14496
    v_mfma_f32_16x16x32_bf16 v[204:207], v[84:87], v[68:71], v[204:207]
    ds_read_b64_tr_b16 v[138:139], v17 offset:16288
    v_mfma_f32_16x16x32_bf16 v[208:211], v[88:91], v[56:59], v[208:211]
    ds_read_b64_tr_b16 v[140:141], v16 offset:14528
    v_mfma_f32_16x16x32_bf16 v[212:215], v[88:91], v[60:63], v[212:215]
    ds_read_b64_tr_b16 v[142:143], v16 offset:16320
    v_mfma_f32_16x16x32_bf16 v[216:219], v[88:91], v[64:67], v[216:219]
    v_mfma_f32_16x16x32_bf16 v[220:223], v[88:91], v[68:71], v[220:223]
    v_mfma_f32_16x16x32_bf16 v[224:227], v[92:95], v[56:59], v[224:227]
    v_mfma_f32_16x16x32_bf16 v[228:231], v[92:95], v[60:63], v[228:231]
    v_mfma_f32_16x16x32_bf16 v[232:235], v[92:95], v[64:67], v[232:235]
    v_mfma_f32_16x16x32_bf16 v[236:239], v[92:95], v[68:71], v[236:239]
    v_mfma_f32_16x16x32_bf16 v[240:243], v[96:99], v[56:59], v[240:243]
    v_mfma_f32_16x16x32_bf16 v[244:247], v[96:99], v[60:63], v[244:247]
    v_mfma_f32_16x16x32_bf16 v[248:251], v[96:99], v[64:67], v[248:251]
    v_mfma_f32_16x16x32_bf16 v[252:255], v[96:99], v[68:71], v[252:255]
    s_waitcnt lgkmcnt(0)
    v_mfma_f32_16x16x32_bf16 v[144:147], v[116:119], v[100:103], v[144:147]
    s_barrier
    v_mfma_f32_16x16x32_bf16 v[148:151], v[116:119], v[104:107], v[148:151]
    ds_read_b128 v[56:59], v6 offset:0
    v_mfma_f32_16x16x32_bf16 v[152:155], v[116:119], v[108:111], v[152:155]
    ds_read_b64_tr_b16 v[72:73], v8 offset:0
    v_mfma_f32_16x16x32_bf16 v[156:159], v[116:119], v[112:115], v[156:159]
    ds_read_b64_tr_b16 v[74:75], v8 offset:1792
    v_mfma_f32_16x16x32_bf16 v[160:163], v[120:123], v[100:103], v[160:163]
    ds_read_b128 v[60:63], v6 offset:2048
    v_mfma_f32_16x16x32_bf16 v[164:167], v[120:123], v[104:107], v[164:167]
    ds_read_b128 v[64:67], v6 offset:4096
    v_mfma_f32_16x16x32_bf16 v[168:171], v[120:123], v[108:111], v[168:171]
    ds_read_b128 v[68:71], v6 offset:6144
    v_mfma_f32_16x16x32_bf16 v[172:175], v[120:123], v[112:115], v[172:175]
    ds_read_b64_tr_b16 v[76:77], v9 offset:32
    v_mfma_f32_16x16x32_bf16 v[176:179], v[124:127], v[100:103], v[176:179]
    ds_read_b64_tr_b16 v[78:79], v9 offset:1824
    v_mfma_f32_16x16x32_bf16 v[180:183], v[124:127], v[104:107], v[180:183]
    ds_read_b64_tr_b16 v[80:81], v8 offset:64
    v_mfma_f32_16x16x32_bf16 v[184:187], v[124:127], v[108:111], v[184:187]
    ds_read_b64_tr_b16 v[82:83], v8 offset:1856
    v_mfma_f32_16x16x32_bf16 v[188:191], v[124:127], v[112:115], v[188:191]
    ds_read_b64_tr_b16 v[84:85], v9 offset:96
    v_mfma_f32_16x16x32_bf16 v[192:195], v[128:131], v[100:103], v[192:195]
    ds_read_b64_tr_b16 v[86:87], v9 offset:1888
    v_mfma_f32_16x16x32_bf16 v[196:199], v[128:131], v[104:107], v[196:199]
    ds_read_b64_tr_b16 v[88:89], v8 offset:128
    v_mfma_f32_16x16x32_bf16 v[200:203], v[128:131], v[108:111], v[200:203]
    ds_read_b64_tr_b16 v[90:91], v8 offset:1920
    v_mfma_f32_16x16x32_bf16 v[204:207], v[128:131], v[112:115], v[204:207]
    ds_read_b64_tr_b16 v[92:93], v9 offset:160
    v_mfma_f32_16x16x32_bf16 v[208:211], v[132:135], v[100:103], v[208:211]
    ds_read_b64_tr_b16 v[94:95], v9 offset:1952
    v_mfma_f32_16x16x32_bf16 v[212:215], v[132:135], v[104:107], v[212:215]
    ds_read_b64_tr_b16 v[96:97], v8 offset:192
    v_mfma_f32_16x16x32_bf16 v[216:219], v[132:135], v[108:111], v[216:219]
    ds_read_b64_tr_b16 v[98:99], v8 offset:1984
    v_mfma_f32_16x16x32_bf16 v[220:223], v[132:135], v[112:115], v[220:223]
    v_mfma_f32_16x16x32_bf16 v[224:227], v[136:139], v[100:103], v[224:227]
    v_mfma_f32_16x16x32_bf16 v[228:231], v[136:139], v[104:107], v[228:231]
    v_mfma_f32_16x16x32_bf16 v[232:235], v[136:139], v[108:111], v[232:235]
    v_mfma_f32_16x16x32_bf16 v[236:239], v[136:139], v[112:115], v[236:239]
    v_mfma_f32_16x16x32_bf16 v[240:243], v[140:143], v[100:103], v[240:243]
    v_mfma_f32_16x16x32_bf16 v[244:247], v[140:143], v[104:107], v[244:247]
    v_mfma_f32_16x16x32_bf16 v[248:251], v[140:143], v[108:111], v[248:251]
    v_mfma_f32_16x16x32_bf16 v[252:255], v[140:143], v[112:115], v[252:255]
    s_waitcnt lgkmcnt(0)
    v_mfma_f32_16x16x32_bf16 v[144:147], v[72:75], v[56:59], v[144:147]
    ds_read_b128 v[100:103], v7 offset:0
    v_mfma_f32_16x16x32_bf16 v[148:151], v[72:75], v[60:63], v[148:151]
    ds_read_b64_tr_b16 v[116:117], v8 offset:14336
    v_mfma_f32_16x16x32_bf16 v[152:155], v[72:75], v[64:67], v[152:155]
    ds_read_b64_tr_b16 v[118:119], v8 offset:16128
    v_mfma_f32_16x16x32_bf16 v[156:159], v[72:75], v[68:71], v[156:159]
    ds_read_b128 v[104:107], v7 offset:2048
    v_mfma_f32_16x16x32_bf16 v[160:163], v[76:79], v[56:59], v[160:163]
    ds_read_b128 v[108:111], v7 offset:4096
    v_mfma_f32_16x16x32_bf16 v[164:167], v[76:79], v[60:63], v[164:167]
    ds_read_b128 v[112:115], v7 offset:6144
    v_mfma_f32_16x16x32_bf16 v[168:171], v[76:79], v[64:67], v[168:171]
    ds_read_b64_tr_b16 v[120:121], v9 offset:14368
    v_mfma_f32_16x16x32_bf16 v[172:175], v[76:79], v[68:71], v[172:175]
    ds_read_b64_tr_b16 v[122:123], v9 offset:16160
    v_mfma_f32_16x16x32_bf16 v[176:179], v[80:83], v[56:59], v[176:179]
    ds_read_b64_tr_b16 v[124:125], v8 offset:14400
    v_mfma_f32_16x16x32_bf16 v[180:183], v[80:83], v[60:63], v[180:183]
    ds_read_b64_tr_b16 v[126:127], v8 offset:16192
    v_mfma_f32_16x16x32_bf16 v[184:187], v[80:83], v[64:67], v[184:187]
    ds_read_b64_tr_b16 v[128:129], v9 offset:14432
    v_mfma_f32_16x16x32_bf16 v[188:191], v[80:83], v[68:71], v[188:191]
    ds_read_b64_tr_b16 v[130:131], v9 offset:16224
    v_mfma_f32_16x16x32_bf16 v[192:195], v[84:87], v[56:59], v[192:195]
    ds_read_b64_tr_b16 v[132:133], v8 offset:14464
    v_mfma_f32_16x16x32_bf16 v[196:199], v[84:87], v[60:63], v[196:199]
    ds_read_b64_tr_b16 v[134:135], v8 offset:16256
    v_mfma_f32_16x16x32_bf16 v[200:203], v[84:87], v[64:67], v[200:203]
    ds_read_b64_tr_b16 v[136:137], v9 offset:14496
    v_mfma_f32_16x16x32_bf16 v[204:207], v[84:87], v[68:71], v[204:207]
    ds_read_b64_tr_b16 v[138:139], v9 offset:16288
    v_mfma_f32_16x16x32_bf16 v[208:211], v[88:91], v[56:59], v[208:211]
    ds_read_b64_tr_b16 v[140:141], v8 offset:14528
    v_mfma_f32_16x16x32_bf16 v[212:215], v[88:91], v[60:63], v[212:215]
    ds_read_b64_tr_b16 v[142:143], v8 offset:16320
    v_mfma_f32_16x16x32_bf16 v[216:219], v[88:91], v[64:67], v[216:219]
    v_mfma_f32_16x16x32_bf16 v[220:223], v[88:91], v[68:71], v[220:223]
    v_mfma_f32_16x16x32_bf16 v[224:227], v[92:95], v[56:59], v[224:227]
    v_mfma_f32_16x16x32_bf16 v[228:231], v[92:95], v[60:63], v[228:231]
    v_mfma_f32_16x16x32_bf16 v[232:235], v[92:95], v[64:67], v[232:235]
    v_mfma_f32_16x16x32_bf16 v[236:239], v[92:95], v[68:71], v[236:239]
    v_mfma_f32_16x16x32_bf16 v[240:243], v[96:99], v[56:59], v[240:243]
    v_mfma_f32_16x16x32_bf16 v[244:247], v[96:99], v[60:63], v[244:247]
    v_mfma_f32_16x16x32_bf16 v[248:251], v[96:99], v[64:67], v[248:251]
    v_mfma_f32_16x16x32_bf16 v[252:255], v[96:99], v[68:71], v[252:255]
    s_waitcnt lgkmcnt(0)
    v_mfma_f32_16x16x32_bf16 v[144:147], v[116:119], v[100:103], v[144:147]
    s_barrier
    v_mfma_f32_16x16x32_bf16 v[148:151], v[116:119], v[104:107], v[148:151]
    ds_read_b128 v[56:59], v10 offset:0
    v_mfma_f32_16x16x32_bf16 v[152:155], v[116:119], v[108:111], v[152:155]
    ds_read_b64_tr_b16 v[72:73], v12 offset:0
    v_mfma_f32_16x16x32_bf16 v[156:159], v[116:119], v[112:115], v[156:159]
    ds_read_b64_tr_b16 v[74:75], v12 offset:1792
    v_mfma_f32_16x16x32_bf16 v[160:163], v[120:123], v[100:103], v[160:163]
    ds_read_b128 v[60:63], v10 offset:2048
    v_mfma_f32_16x16x32_bf16 v[164:167], v[120:123], v[104:107], v[164:167]
    ds_read_b128 v[64:67], v10 offset:4096
    v_mfma_f32_16x16x32_bf16 v[168:171], v[120:123], v[108:111], v[168:171]
    ds_read_b128 v[68:71], v10 offset:6144
    v_mfma_f32_16x16x32_bf16 v[172:175], v[120:123], v[112:115], v[172:175]
    ds_read_b64_tr_b16 v[76:77], v13 offset:32
    v_mfma_f32_16x16x32_bf16 v[176:179], v[124:127], v[100:103], v[176:179]
    ds_read_b64_tr_b16 v[78:79], v13 offset:1824
    v_mfma_f32_16x16x32_bf16 v[180:183], v[124:127], v[104:107], v[180:183]
    ds_read_b64_tr_b16 v[80:81], v12 offset:64
    v_mfma_f32_16x16x32_bf16 v[184:187], v[124:127], v[108:111], v[184:187]
    ds_read_b64_tr_b16 v[82:83], v12 offset:1856
    v_mfma_f32_16x16x32_bf16 v[188:191], v[124:127], v[112:115], v[188:191]
    ds_read_b64_tr_b16 v[84:85], v13 offset:96
    v_mfma_f32_16x16x32_bf16 v[192:195], v[128:131], v[100:103], v[192:195]
    ds_read_b64_tr_b16 v[86:87], v13 offset:1888
    v_mfma_f32_16x16x32_bf16 v[196:199], v[128:131], v[104:107], v[196:199]
    ds_read_b64_tr_b16 v[88:89], v12 offset:128
    v_mfma_f32_16x16x32_bf16 v[200:203], v[128:131], v[108:111], v[200:203]
    ds_read_b64_tr_b16 v[90:91], v12 offset:1920
    v_mfma_f32_16x16x32_bf16 v[204:207], v[128:131], v[112:115], v[204:207]
    ds_read_b64_tr_b16 v[92:93], v13 offset:160
    v_mfma_f32_16x16x32_bf16 v[208:211], v[132:135], v[100:103], v[208:211]
    ds_read_b64_tr_b16 v[94:95], v13 offset:1952
    v_mfma_f32_16x16x32_bf16 v[212:215], v[132:135], v[104:107], v[212:215]
    ds_read_b64_tr_b16 v[96:97], v12 offset:192
    v_mfma_f32_16x16x32_bf16 v[216:219], v[132:135], v[108:111], v[216:219]
    ds_read_b64_tr_b16 v[98:99], v12 offset:1984
    v_mfma_f32_16x16x32_bf16 v[220:223], v[132:135], v[112:115], v[220:223]
    v_mfma_f32_16x16x32_bf16 v[224:227], v[136:139], v[100:103], v[224:227]
    v_mfma_f32_16x16x32_bf16 v[228:231], v[136:139], v[104:107], v[228:231]
    v_mfma_f32_16x16x32_bf16 v[232:235], v[136:139], v[108:111], v[232:235]
    v_mfma_f32_16x16x32_bf16 v[236:239], v[136:139], v[112:115], v[236:239]
    v_mfma_f32_16x16x32_bf16 v[240:243], v[140:143], v[100:103], v[240:243]
    v_mfma_f32_16x16x32_bf16 v[244:247], v[140:143], v[104:107], v[244:247]
    v_mfma_f32_16x16x32_bf16 v[248:251], v[140:143], v[108:111], v[248:251]
    v_mfma_f32_16x16x32_bf16 v[252:255], v[140:143], v[112:115], v[252:255]
    s_sub_u32 s61, s61, 1
    s_cmp_lg_u32 s61, 0
    s_cbranch_scc1 LP_66
    s_waitcnt lgkmcnt(0)
    v_mfma_f32_16x16x32_bf16 v[144:147], v[72:75], v[56:59], v[144:147]
    ds_read_b128 v[100:103], v11 offset:0
    v_mfma_f32_16x16x32_bf16 v[148:151], v[72:75], v[60:63], v[148:151]
    ds_read_b64_tr_b16 v[116:117], v12 offset:14336
    v_mfma_f32_16x16x32_bf16 v[152:155], v[72:75], v[64:67], v[152:155]
    ds_read_b64_tr_b16 v[118:119], v12 offset:16128
    v_mfma_f32_16x16x32_bf16 v[156:159], v[72:75], v[68:71], v[156:159]
    ds_read_b128 v[104:107], v11 offset:2048
    v_mfma_f32_16x16x32_bf16 v[160:163], v[76:79], v[56:59], v[160:163]
    ds_read_b128 v[108:111], v11 offset:4096
    v_mfma_f32_16x16x32_bf16 v[164:167], v[76:79], v[60:63], v[164:167]
    ds_read_b128 v[112:115], v11 offset:6144
    v_mfma_f32_16x16x32_bf16 v[168:171], v[76:79], v[64:67], v[168:171]
    ds_read_b64_tr_b16 v[120:121], v13 offset:14368
    v_mfma_f32_16x16x32_bf16 v[172:175], v[76:79], v[68:71], v[172:175]
    ds_read_b64_tr_b16 v[122:123], v13 offset:16160
    v_mfma_f32_16x16x32_bf16 v[176:179], v[80:83], v[56:59], v[176:179]
    ds_read_b64_tr_b16 v[124:125], v12 offset:14400
    v_mfma_f32_16x16x32_bf16 v[180:183], v[80:83], v[60:63], v[180:183]
    ds_read_b64_tr_b16 v[126:127], v12 offset:16192
    v_mfma_f32_16x16x32_bf16 v[184:187], v[80:83], v[64:67], v[184:187]
    ds_read_b64_tr_b16 v[128:129], v13 offset:14432
    v_mfma_f32_16x16x32_bf16 v[188:191], v[80:83], v[68:71], v[188:191]
    ds_read_b64_tr_b16 v[130:131], v13 offset:16224
    v_mfma_f32_16x16x32_bf16 v[192:195], v[84:87], v[56:59], v[192:195]
    ds_read_b64_tr_b16 v[132:133], v12 offset:14464
    v_mfma_f32_16x16x32_bf16 v[196:199], v[84:87], v[60:63], v[196:199]
    ds_read_b64_tr_b16 v[134:135], v12 offset:16256
    v_mfma_f32_16x16x32_bf16 v[200:203], v[84:87], v[64:67], v[200:203]
    ds_read_b64_tr_b16 v[136:137], v13 offset:14496
    v_mfma_f32_16x16x32_bf16 v[204:207], v[84:87], v[68:71], v[204:207]
    ds_read_b64_tr_b16 v[138:139], v13 offset:16288
    v_mfma_f32_16x16x32_bf16 v[208:211], v[88:91], v[56:59], v[208:211]
    ds_read_b64_tr_b16 v[140:141], v12 offset:14528
    v_mfma_f32_16x16x32_bf16 v[212:215], v[88:91], v[60:63], v[212:215]
    ds_read_b64_tr_b16 v[142:143], v12 offset:16320
    v_mfma_f32_16x16x32_bf16 v[216:219], v[88:91], v[64:67], v[216:219]
    v_and_b32 v2, 15, v1
    v_mfma_f32_16x16x32_bf16 v[220:223], v[88:91], v[68:71], v[220:223]
    v_lshrrev_b32 v3, 4, v1
    v_mfma_f32_16x16x32_bf16 v[224:227], v[92:95], v[56:59], v[224:227]
    v_and_b32 v4, 7, v2
    v_mfma_f32_16x16x32_bf16 v[228:231], v[92:95], v[60:63], v[228:231]
    v_xor_b32 v4, v4, v3
    v_mfma_f32_16x16x32_bf16 v[232:235], v[92:95], v[64:67], v[232:235]
    v_lshlrev_b32 v4, 4, v4
    v_mfma_f32_16x16x32_bf16 v[236:239], v[92:95], v[68:71], v[236:239]
    v_lshlrev_b32 v5, 7, v2
    v_mfma_f32_16x16x32_bf16 v[240:243], v[96:99], v[56:59], v[240:243]
    v_add_u32 v4, v4, v5
    v_mfma_f32_16x16x32_bf16 v[244:247], v[96:99], v[60:63], v[244:247]
    s_lshl_b32 s62, s55, 13
    v_mfma_f32_16x16x32_bf16 v[248:251], v[96:99], v[64:67], v[248:251]
    v_add_u32 v18, s62, v4
    v_mfma_f32_16x16x32_bf16 v[252:255], v[96:99], v[68:71], v[252:255]
    s_waitcnt lgkmcnt(0)
    v_mfma_f32_16x16x32_bf16 v[144:147], v[116:119], v[100:103], v[144:147]
    s_barrier
    v_mfma_f32_16x16x32_bf16 v[148:151], v[116:119], v[104:107], v[148:151]
    ds_read_b128 v[56:59], v14 offset:0
    v_mfma_f32_16x16x32_bf16 v[152:155], v[116:119], v[108:111], v[152:155]
    ds_read_b64_tr_b16 v[72:73], v16 offset:0
    v_mfma_f32_16x16x32_bf16 v[156:159], v[116:119], v[112:115], v[156:159]
    ds_read_b64_tr_b16 v[74:75], v16 offset:1792
    v_mfma_f32_16x16x32_bf16 v[160:163], v[120:123], v[100:103], v[160:163]
    ds_read_b128 v[60:63], v14 offset:2048
    v_mfma_f32_16x16x32_bf16 v[164:167], v[120:123], v[104:107], v[164:167]
    ds_read_b128 v[64:67], v14 offset:4096
    v_mfma_f32_16x16x32_bf16 v[168:171], v[120:123], v[108:111], v[168:171]
    ds_read_b128 v[68:71], v14 offset:6144
    v_mfma_f32_16x16x32_bf16 v[172:175], v[120:123], v[112:115], v[172:175]
    ds_read_b64_tr_b16 v[76:77], v17 offset:32
    v_mfma_f32_16x16x32_bf16 v[176:179], v[124:127], v[100:103], v[176:179]
    ds_read_b64_tr_b16 v[78:79], v17 offset:1824
    v_mfma_f32_16x16x32_bf16 v[180:183], v[124:127], v[104:107], v[180:183]
    ds_read_b64_tr_b16 v[80:81], v16 offset:64
    v_mfma_f32_16x16x32_bf16 v[184:187], v[124:127], v[108:111], v[184:187]
    ds_read_b64_tr_b16 v[82:83], v16 offset:1856
    v_mfma_f32_16x16x32_bf16 v[188:191], v[124:127], v[112:115], v[188:191]
    ds_read_b64_tr_b16 v[84:85], v17 offset:96
    v_mfma_f32_16x16x32_bf16 v[192:195], v[128:131], v[100:103], v[192:195]
    ds_read_b64_tr_b16 v[86:87], v17 offset:1888
    v_mfma_f32_16x16x32_bf16 v[196:199], v[128:131], v[104:107], v[196:199]
    ds_read_b64_tr_b16 v[88:89], v16 offset:128
    v_mfma_f32_16x16x32_bf16 v[200:203], v[128:131], v[108:111], v[200:203]
    ds_read_b64_tr_b16 v[90:91], v16 offset:1920
    v_mfma_f32_16x16x32_bf16 v[204:207], v[128:131], v[112:115], v[204:207]
    ds_read_b64_tr_b16 v[92:93], v17 offset:160
    v_mfma_f32_16x16x32_bf16 v[208:211], v[132:135], v[100:103], v[208:211]
    ds_read_b64_tr_b16 v[94:95], v17 offset:1952
    v_mfma_f32_16x16x32_bf16 v[212:215], v[132:135], v[104:107], v[212:215]
    ds_read_b64_tr_b16 v[96:97], v16 offset:192
    v_mfma_f32_16x16x32_bf16 v[216:219], v[132:135], v[108:111], v[216:219]
    ds_read_b64_tr_b16 v[98:99], v16 offset:1984
    v_mfma_f32_16x16x32_bf16 v[220:223], v[132:135], v[112:115], v[220:223]
    v_xor_b32 v19, 64, v18
    v_mfma_f32_16x16x32_bf16 v[224:227], v[136:139], v[100:103], v[224:227]
    v_lshlrev_b32 v4, 3, v3
    v_mfma_f32_16x16x32_bf16 v[228:231], v[136:139], v[104:107], v[228:231]
    v_lshrrev_b32 v5, 2, v2
    v_mfma_f32_16x16x32_bf16 v[232:235], v[136:139], v[108:111], v[232:235]
    v_add_u32 v4, v4, v5
    v_mfma_f32_16x16x32_bf16 v[236:239], v[136:139], v[112:115], v[236:239]
    v_mul_u32_u24 v4, 384, v4
    v_mfma_f32_16x16x32_bf16 v[240:243], v[140:143], v[100:103], v[240:243]
    v_and_b32 v5, 3, v2
    v_mfma_f32_16x16x32_bf16 v[244:247], v[140:143], v[104:107], v[244:247]
    v_lshlrev_b32 v5, 3, v5
    v_mfma_f32_16x16x32_bf16 v[248:251], v[140:143], v[108:111], v[248:251]
    v_add_u32 v4, v4, v5
    v_mfma_f32_16x16x32_bf16 v[252:255], v[140:143], v[112:115], v[252:255]
    v_add_u32 v4, 18432, v4
    s_waitcnt lgkmcnt(0)
    v_mfma_f32_16x16x32_bf16 v[144:147], v[72:75], v[56:59], v[144:147]
    ds_read_b128 v[100:103], v15 offset:0
    v_mfma_f32_16x16x32_bf16 v[148:151], v[72:75], v[60:63], v[148:151]
    ds_read_b64_tr_b16 v[116:117], v16 offset:14336
    v_mfma_f32_16x16x32_bf16 v[152:155], v[72:75], v[64:67], v[152:155]
    ds_read_b64_tr_b16 v[118:119], v16 offset:16128
    v_mfma_f32_16x16x32_bf16 v[156:159], v[72:75], v[68:71], v[156:159]
    ds_read_b128 v[104:107], v15 offset:2048
    v_mfma_f32_16x16x32_bf16 v[160:163], v[76:79], v[56:59], v[160:163]
    ds_read_b128 v[108:111], v15 offset:4096
    v_mfma_f32_16x16x32_bf16 v[164:167], v[76:79], v[60:63], v[164:167]
    ds_read_b128 v[112:115], v15 offset:6144
    v_mfma_f32_16x16x32_bf16 v[168:171], v[76:79], v[64:67], v[168:171]
    ds_read_b64_tr_b16 v[120:121], v17 offset:14368
    v_mfma_f32_16x16x32_bf16 v[172:175], v[76:79], v[68:71], v[172:175]
    ds_read_b64_tr_b16 v[122:123], v17 offset:16160
    v_mfma_f32_16x16x32_bf16 v[176:179], v[80:83], v[56:59], v[176:179]
    ds_read_b64_tr_b16 v[124:125], v16 offset:14400
    v_mfma_f32_16x16x32_bf16 v[180:183], v[80:83], v[60:63], v[180:183]
    ds_read_b64_tr_b16 v[126:127], v16 offset:16192
    v_mfma_f32_16x16x32_bf16 v[184:187], v[80:83], v[64:67], v[184:187]
    ds_read_b64_tr_b16 v[128:129], v17 offset:14432
    v_mfma_f32_16x16x32_bf16 v[188:191], v[80:83], v[68:71], v[188:191]
    ds_read_b64_tr_b16 v[130:131], v17 offset:16224
    v_mfma_f32_16x16x32_bf16 v[192:195], v[84:87], v[56:59], v[192:195]
    ds_read_b64_tr_b16 v[132:133], v16 offset:14464
    v_mfma_f32_16x16x32_bf16 v[196:199], v[84:87], v[60:63], v[196:199]
    ds_read_b64_tr_b16 v[134:135], v16 offset:16256
    v_mfma_f32_16x16x32_bf16 v[200:203], v[84:87], v[64:67], v[200:203]
    ds_read_b64_tr_b16 v[136:137], v17 offset:14496
    v_mfma_f32_16x16x32_bf16 v[204:207], v[84:87], v[68:71], v[204:207]
    ds_read_b64_tr_b16 v[138:139], v17 offset:16288
    v_mfma_f32_16x16x32_bf16 v[208:211], v[88:91], v[56:59], v[208:211]
    ds_read_b64_tr_b16 v[140:141], v16 offset:14528
    v_mfma_f32_16x16x32_bf16 v[212:215], v[88:91], v[60:63], v[212:215]
    ds_read_b64_tr_b16 v[142:143], v16 offset:16320
    v_mfma_f32_16x16x32_bf16 v[216:219], v[88:91], v[64:67], v[216:219]
    v_lshrrev_b32 v5, 3, v2
    v_mfma_f32_16x16x32_bf16 v[220:223], v[88:91], v[68:71], v[220:223]
    v_and_b32 v5, 1, v5
    v_mfma_f32_16x16x32_bf16 v[224:227], v[92:95], v[56:59], v[224:227]
    v_and_b32 v3, 1, v3
    v_mfma_f32_16x16x32_bf16 v[228:231], v[92:95], v[60:63], v[228:231]
    v_lshlrev_b32 v3, 1, v3
    v_mfma_f32_16x16x32_bf16 v[232:235], v[92:95], v[64:67], v[232:235]
    v_or_b32 v5, v5, v3
    v_mfma_f32_16x16x32_bf16 v[236:239], v[92:95], v[68:71], v[236:239]
    s_lshl_b32 s62, s56, 1
    v_mfma_f32_16x16x32_bf16 v[240:243], v[96:99], v[56:59], v[240:243]
    s_add_u32 s62, s62, 0
    v_mfma_f32_16x16x32_bf16 v[244:247], v[96:99], v[60:63], v[244:247]
    v_xor_b32 v3, s62, v5
    v_mfma_f32_16x16x32_bf16 v[248:251], v[96:99], v[64:67], v[248:251]
    v_lshlrev_b32 v3, 5, v3
    v_mfma_f32_16x16x32_bf16 v[252:255], v[96:99], v[68:71], v[252:255]
    s_waitcnt lgkmcnt(0)
    v_mfma_f32_16x16x32_bf16 v[144:147], v[116:119], v[100:103], v[144:147]
    s_barrier
    v_mfma_f32_16x16x32_bf16 v[148:151], v[116:119], v[104:107], v[148:151]
    ds_read_b128 v[56:59], v6 offset:0
    v_mfma_f32_16x16x32_bf16 v[152:155], v[116:119], v[108:111], v[152:155]
    ds_read_b64_tr_b16 v[72:73], v8 offset:0
    v_mfma_f32_16x16x32_bf16 v[156:159], v[116:119], v[112:115], v[156:159]
    ds_read_b64_tr_b16 v[74:75], v8 offset:1792
    v_mfma_f32_16x16x32_bf16 v[160:163], v[120:123], v[100:103], v[160:163]
    ds_read_b128 v[60:63], v6 offset:2048
    v_mfma_f32_16x16x32_bf16 v[164:167], v[120:123], v[104:107], v[164:167]
    ds_read_b128 v[64:67], v6 offset:4096
    v_mfma_f32_16x16x32_bf16 v[168:171], v[120:123], v[108:111], v[168:171]
    ds_read_b128 v[68:71], v6 offset:6144
    v_mfma_f32_16x16x32_bf16 v[172:175], v[120:123], v[112:115], v[172:175]
    ds_read_b64_tr_b16 v[76:77], v9 offset:32
    v_mfma_f32_16x16x32_bf16 v[176:179], v[124:127], v[100:103], v[176:179]
    ds_read_b64_tr_b16 v[78:79], v9 offset:1824
    v_mfma_f32_16x16x32_bf16 v[180:183], v[124:127], v[104:107], v[180:183]
    ds_read_b64_tr_b16 v[80:81], v8 offset:64
    v_mfma_f32_16x16x32_bf16 v[184:187], v[124:127], v[108:111], v[184:187]
    ds_read_b64_tr_b16 v[82:83], v8 offset:1856
    v_mfma_f32_16x16x32_bf16 v[188:191], v[124:127], v[112:115], v[188:191]
    ds_read_b64_tr_b16 v[84:85], v9 offset:96
    v_mfma_f32_16x16x32_bf16 v[192:195], v[128:131], v[100:103], v[192:195]
    ds_read_b64_tr_b16 v[86:87], v9 offset:1888
    v_mfma_f32_16x16x32_bf16 v[196:199], v[128:131], v[104:107], v[196:199]
    ds_read_b64_tr_b16 v[88:89], v8 offset:128
    v_mfma_f32_16x16x32_bf16 v[200:203], v[128:131], v[108:111], v[200:203]
    ds_read_b64_tr_b16 v[90:91], v8 offset:1920
    v_mfma_f32_16x16x32_bf16 v[204:207], v[128:131], v[112:115], v[204:207]
    ds_read_b64_tr_b16 v[92:93], v9 offset:160
    v_mfma_f32_16x16x32_bf16 v[208:211], v[132:135], v[100:103], v[208:211]
    ds_read_b64_tr_b16 v[94:95], v9 offset:1952
    v_mfma_f32_16x16x32_bf16 v[212:215], v[132:135], v[104:107], v[212:215]
    ds_read_b64_tr_b16 v[96:97], v8 offset:192
    v_mfma_f32_16x16x32_bf16 v[216:219], v[132:135], v[108:111], v[216:219]
    ds_read_b64_tr_b16 v[98:99], v8 offset:1984
    v_mfma_f32_16x16x32_bf16 v[220:223], v[132:135], v[112:115], v[220:223]
    v_add_u32 v20, v4, v3
    v_mfma_f32_16x16x32_bf16 v[224:227], v[136:139], v[100:103], v[224:227]
    s_lshl_b32 s62, s56, 1
    v_mfma_f32_16x16x32_bf16 v[228:231], v[136:139], v[104:107], v[228:231]
    v_mfma_f32_16x16x32_bf16 v[232:235], v[136:139], v[108:111], v[232:235]
    s_add_u32 s62, s62, 1
    v_mfma_f32_16x16x32_bf16 v[236:239], v[136:139], v[112:115], v[236:239]
    v_xor_b32 v3, s62, v5
    v_mfma_f32_16x16x32_bf16 v[240:243], v[140:143], v[100:103], v[240:243]
    v_mfma_f32_16x16x32_bf16 v[244:247], v[140:143], v[104:107], v[244:247]
    v_lshlrev_b32 v3, 5, v3
    v_mfma_f32_16x16x32_bf16 v[248:251], v[140:143], v[108:111], v[248:251]
    v_add_u32 v21, v4, v3
    v_mfma_f32_16x16x32_bf16 v[252:255], v[140:143], v[112:115], v[252:255]
    s_waitcnt lgkmcnt(0)
    v_mfma_f32_16x16x32_bf16 v[144:147], v[72:75], v[56:59], v[144:147]
    ds_read_b128 v[100:103], v7 offset:0
    v_mfma_f32_16x16x32_bf16 v[148:151], v[72:75], v[60:63], v[148:151]
    ds_read_b64_tr_b16 v[116:117], v8 offset:14336
    v_mfma_f32_16x16x32_bf16 v[152:155], v[72:75], v[64:67], v[152:155]
    ds_read_b64_tr_b16 v[118:119], v8 offset:16128
    v_mfma_f32_16x16x32_bf16 v[156:159], v[72:75], v[68:71], v[156:159]
    ds_read_b128 v[104:107], v7 offset:2048
    v_mfma_f32_16x16x32_bf16 v[160:163], v[76:79], v[56:59], v[160:163]
    ds_read_b128 v[108:111], v7 offset:4096
    v_mfma_f32_16x16x32_bf16 v[164:167], v[76:79], v[60:63], v[164:167]
    ds_read_b128 v[112:115], v7 offset:6144
    v_mfma_f32_16x16x32_bf16 v[168:171], v[76:79], v[64:67], v[168:171]
    ds_read_b64_tr_b16 v[120:121], v9 offset:14368
    v_mfma_f32_16x16x32_bf16 v[172:175], v[76:79], v[68:71], v[172:175]
    ds_read_b64_tr_b16 v[122:123], v9 offset:16160
    v_mfma_f32_16x16x32_bf16 v[176:179], v[80:83], v[56:59], v[176:179]
    ds_read_b64_tr_b16 v[124:125], v8 offset:14400
    v_mfma_f32_16x16x32_bf16 v[180:183], v[80:83], v[60:63], v[180:183]
    ds_read_b64_tr_b16 v[126:127], v8 offset:16192
    v_mfma_f32_16x16x32_bf16 v[184:187], v[80:83], v[64:67], v[184:187]
    ds_read_b64_tr_b16 v[128:129], v9 offset:14432
    v_mfma_f32_16x16x32_bf16 v[188:191], v[80:83], v[68:71], v[188:191]
    ds_read_b64_tr_b16 v[130:131], v9 offset:16224
    v_mfma_f32_16x16x32_bf16 v[192:195], v[84:87], v[56:59], v[192:195]
    ds_read_b64_tr_b16 v[132:133], v8 offset:14464
    v_mfma_f32_16x16x32_bf16 v[196:199], v[84:87], v[60:63], v[196:199]
    ds_read_b64_tr_b16 v[134:135], v8 offset:16256
    v_mfma_f32_16x16x32_bf16 v[200:203], v[84:87], v[64:67], v[200:203]
    ds_read_b64_tr_b16 v[136:137], v9 offset:14496
    v_mfma_f32_16x16x32_bf16 v[204:207], v[84:87], v[68:71], v[204:207]
    ds_read_b64_tr_b16 v[138:139], v9 offset:16288
    v_mfma_f32_16x16x32_bf16 v[208:211], v[88:91], v[56:59], v[208:211]
    ds_read_b64_tr_b16 v[140:141], v8 offset:14528
    v_mfma_f32_16x16x32_bf16 v[212:215], v[88:91], v[60:63], v[212:215]
    ds_read_b64_tr_b16 v[142:143], v8 offset:16320
    v_mfma_f32_16x16x32_bf16 v[216:219], v[88:91], v[64:67], v[216:219]
    v_add_u32 v10, 45056, v18
    v_mfma_f32_16x16x32_bf16 v[220:223], v[88:91], v[68:71], v[220:223]
    v_add_u32 v11, 45056, v19
    v_mfma_f32_16x16x32_bf16 v[224:227], v[92:95], v[56:59], v[224:227]
    v_add_u32 v12, 45056, v20
    v_mfma_f32_16x16x32_bf16 v[228:231], v[92:95], v[60:63], v[228:231]
    v_add_u32 v13, 45056, v21
    v_mfma_f32_16x16x32_bf16 v[232:235], v[92:95], v[64:67], v[232:235]
    v_mfma_f32_16x16x32_bf16 v[236:239], v[92:95], v[68:71], v[236:239]
    v_add_u32 v14, 90112, v18
    v_mfma_f32_16x16x32_bf16 v[240:243], v[96:99], v[56:59], v[240:243]
    v_add_u32 v15, 90112, v19
    v_mfma_f32_16x16x32_bf16 v[244:247], v[96:99], v[60:63], v[244:247]
    v_add_u32 v16, 90112, v20
    v_mfma_f32_16x16x32_bf16 v[248:251], v[96:99], v[64:67], v[248:251]
    v_add_u32 v17, 90112, v21
    v_mfma_f32_16x16x32_bf16 v[252:255], v[96:99], v[68:71], v[252:255]
    s_waitcnt lgkmcnt(0)
    v_mfma_f32_16x16x32_bf16 v[144:147], v[116:119], v[100:103], v[144:147]
    s_barrier
    v_mfma_f32_16x16x32_bf16 v[148:151], v[116:119], v[104:107], v[148:151]
    ds_read_b128 v[56:59], v10 offset:0
    v_mfma_f32_16x16x32_bf16 v[152:155], v[116:119], v[108:111], v[152:155]
    ds_read_b64_tr_b16 v[84:85], v12 offset:128
    v_mfma_f32_16x16x32_bf16 v[156:159], v[116:119], v[112:115], v[156:159]
    ds_read_b64_tr_b16 v[86:87], v12 offset:1664
    v_mfma_f32_16x16x32_bf16 v[160:163], v[120:123], v[100:103], v[160:163]
    ds_read_b128 v[60:63], v10 offset:2048
    v_mfma_f32_16x16x32_bf16 v[164:167], v[120:123], v[104:107], v[164:167]
    ds_read_b128 v[64:67], v10 offset:4096
    v_mfma_f32_16x16x32_bf16 v[168:171], v[120:123], v[108:111], v[168:171]
    ds_read_b128 v[68:71], v10 offset:6144
    v_mfma_f32_16x16x32_bf16 v[172:175], v[120:123], v[112:115], v[172:175]
    ds_read_b128 v[72:75], v10 offset:8192
    v_mfma_f32_16x16x32_bf16 v[176:179], v[124:127], v[100:103], v[176:179]
    ds_read_b64_tr_b16 v[88:89], v13 offset:128
    v_mfma_f32_16x16x32_bf16 v[180:183], v[124:127], v[104:107], v[180:183]
    ds_read_b64_tr_b16 v[90:91], v13 offset:1664
    v_mfma_f32_16x16x32_bf16 v[184:187], v[124:127], v[108:111], v[184:187]
    ds_read_b64_tr_b16 v[92:93], v12 offset:256
    v_mfma_f32_16x16x32_bf16 v[188:191], v[124:127], v[112:115], v[188:191]
    ds_read_b64_tr_b16 v[94:95], v12 offset:1792
    v_mfma_f32_16x16x32_bf16 v[192:195], v[128:131], v[100:103], v[192:195]
    ds_read_b64_tr_b16 v[96:97], v13 offset:256
    v_mfma_f32_16x16x32_bf16 v[196:199], v[128:131], v[104:107], v[196:199]
    ds_read_b64_tr_b16 v[98:99], v13 offset:1792
    v_mfma_f32_16x16x32_bf16 v[200:203], v[128:131], v[108:111], v[200:203]
    ds_read_b64_tr_b16 v[76:77], v12 offset:0
    v_mfma_f32_16x16x32_bf16 v[204:207], v[128:131], v[112:115], v[204:207]
    ds_read_b64_tr_b16 v[78:79], v12 offset:1536
    v_mfma_f32_16x16x32_bf16 v[208:211], v[132:135], v[100:103], v[208:211]
    ds_read_b64_tr_b16 v[80:81], v13 offset:0
    v_mfma_f32_16x16x32_bf16 v[212:215], v[132:135], v[104:107], v[212:215]
    ds_read_b64_tr_b16 v[82:83], v13 offset:1536
    v_mfma_f32_16x16x32_bf16 v[216:219], v[132:135], v[108:111], v[216:219]
    v_add_u32 v6, 0, v18
    v_mfma_f32_16x16x32_bf16 v[220:223], v[132:135], v[112:115], v[220:223]
    v_mfma_f32_16x16x32_bf16 v[224:227], v[136:139], v[100:103], v[224:227]
    v_add_u32 v7, 0, v19
    v_mfma_f32_16x16x32_bf16 v[228:231], v[136:139], v[104:107], v[228:231]
    v_mfma_f32_16x16x32_bf16 v[232:235], v[136:139], v[108:111], v[232:235]
    v_mfma_f32_16x16x32_bf16 v[236:239], v[136:139], v[112:115], v[236:239]
    v_add_u32 v8, 0, v20
    v_mfma_f32_16x16x32_bf16 v[240:243], v[140:143], v[100:103], v[240:243]
    v_mfma_f32_16x16x32_bf16 v[244:247], v[140:143], v[104:107], v[244:247]
    v_add_u32 v9, 0, v21
    v_mfma_f32_16x16x32_bf16 v[248:251], v[140:143], v[108:111], v[248:251]
    v_mfma_f32_16x16x32_bf16 v[252:255], v[140:143], v[112:115], v[252:255]
    s_nop 7
    v_lshlrev_b32 v26, 4, v1
    s_lshl_b32 s62, s55, 12
    v_add_u32 v26, s62, v26
    s_mul_i32 s64, s53, 917504
    s_mul_i32 s62, s54, 57344
    s_add_u32 s64, s64, s62
    s_cmp_eq_u32 s56, 0
    s_cbranch_scc0 HE1_67
    s_add_u32 s65, s64, 0
    v_mul_f32 v144, v144, |v144|
    v_mul_f32 v145, v145, |v145|
    v_mul_f32 v146, v146, |v146|
    v_mul_f32 v147, v147, |v147|
    v_cvt_pk_bf16_f32 v100, v144, v145
    v_cvt_pk_bf16_f32 v101, v146, v147
    v_pk_max_i16 v100, v100, 0
    v_pk_max_i16 v101, v101, 0
    v_mul_f32 v160, v160, |v160|
    v_mul_f32 v161, v161, |v161|
    v_mul_f32 v162, v162, |v162|
    v_mul_f32 v163, v163, |v163|
    v_cvt_pk_bf16_f32 v102, v160, v161
    v_cvt_pk_bf16_f32 v103, v162, v163
    v_pk_max_i16 v102, v102, 0
    v_pk_max_i16 v103, v103, 0
    buffer_store_dwordx4 v[100:103], v26, s[28:31], s65 offen offset:0 sc1
    v_mul_f32 v148, v148, |v148|
    v_mul_f32 v149, v149, |v149|
    v_mul_f32 v150, v150, |v150|
    v_mul_f32 v151, v151, |v151|
    v_cvt_pk_bf16_f32 v104, v148, v149
    v_cvt_pk_bf16_f32 v105, v150, v151
    v_pk_max_i16 v104, v104, 0
    v_pk_max_i16 v105, v105, 0
    v_mul_f32 v164, v164, |v164|
    v_mul_f32 v165, v165, |v165|
    v_mul_f32 v166, v166, |v166|
    v_mul_f32 v167, v167, |v167|
    v_cvt_pk_bf16_f32 v106, v164, v165
    v_cvt_pk_bf16_f32 v107, v166, v167
    v_pk_max_i16 v106, v106, 0
    v_pk_max_i16 v107, v107, 0
    buffer_store_dwordx4 v[104:107], v26, s[28:31], s65 offen offset:1024 sc1
    v_mul_f32 v152, v152, |v152|
    v_mul_f32 v153, v153, |v153|
    v_mul_f32 v154, v154, |v154|
    v_mul_f32 v155, v155, |v155|
    v_cvt_pk_bf16_f32 v108, v152, v153
    v_cvt_pk_bf16_f32 v109, v154, v155
    v_pk_max_i16 v108, v108, 0
    v_pk_max_i16 v109, v109, 0
    v_mul_f32 v168, v168, |v168|
    v_mul_f32 v169, v169, |v169|
    v_mul_f32 v170, v170, |v170|
    v_mul_f32 v171, v171, |v171|
    v_cvt_pk_bf16_f32 v110, v168, v169
    v_cvt_pk_bf16_f32 v111, v170, v171
    v_pk_max_i16 v110, v110, 0
    v_pk_max_i16 v111, v111, 0
    buffer_store_dwordx4 v[108:111], v26, s[28:31], s65 offen offset:2048 sc1
    v_mul_f32 v156, v156, |v156|
    v_mul_f32 v157, v157, |v157|
    v_mul_f32 v158, v158, |v158|
    v_mul_f32 v159, v159, |v159|
    v_cvt_pk_bf16_f32 v112, v156, v157
    v_cvt_pk_bf16_f32 v113, v158, v159
    v_pk_max_i16 v112, v112, 0
    v_pk_max_i16 v113, v113, 0
    v_mul_f32 v172, v172, |v172|
    v_mul_f32 v173, v173, |v173|
    v_mul_f32 v174, v174, |v174|
    v_mul_f32 v175, v175, |v175|
    v_cvt_pk_bf16_f32 v114, v172, v173
    v_cvt_pk_bf16_f32 v115, v174, v175
    v_pk_max_i16 v114, v114, 0
    v_pk_max_i16 v115, v115, 0
    buffer_store_dwordx4 v[112:115], v26, s[28:31], s65 offen offset:3072 sc1
    s_add_u32 s65, s64, 8192
    v_mul_f32 v176, v176, |v176|
    v_mul_f32 v177, v177, |v177|
    v_mul_f32 v178, v178, |v178|
    v_mul_f32 v179, v179, |v179|
    v_cvt_pk_bf16_f32 v116, v176, v177
    v_cvt_pk_bf16_f32 v117, v178, v179
    v_pk_max_i16 v116, v116, 0
    v_pk_max_i16 v117, v117, 0
    v_mul_f32 v192, v192, |v192|
    v_mul_f32 v193, v193, |v193|
    v_mul_f32 v194, v194, |v194|
    v_mul_f32 v195, v195, |v195|
    v_cvt_pk_bf16_f32 v118, v192, v193
    v_cvt_pk_bf16_f32 v119, v194, v195
    v_pk_max_i16 v118, v118, 0
    v_pk_max_i16 v119, v119, 0
    buffer_store_dwordx4 v[116:119], v26, s[28:31], s65 offen offset:0 sc1
    v_mul_f32 v180, v180, |v180|
    v_mul_f32 v181, v181, |v181|
    v_mul_f32 v182, v182, |v182|
    v_mul_f32 v183, v183, |v183|
    v_cvt_pk_bf16_f32 v120, v180, v181
    v_cvt_pk_bf16_f32 v121, v182, v183
    v_pk_max_i16 v120, v120, 0
    v_pk_max_i16 v121, v121, 0
    v_mul_f32 v196, v196, |v196|
    v_mul_f32 v197, v197, |v197|
    v_mul_f32 v198, v198, |v198|
    v_mul_f32 v199, v199, |v199|
    v_cvt_pk_bf16_f32 v122, v196, v197
    v_cvt_pk_bf16_f32 v123, v198, v199
    v_pk_max_i16 v122, v122, 0
    v_pk_max_i16 v123, v123, 0
    buffer_store_dwordx4 v[120:123], v26, s[28:31], s65 offen offset:1024 sc1
    v_mul_f32 v184, v184, |v184|
    v_mul_f32 v185, v185, |v185|
    v_mul_f32 v186, v186, |v186|
    v_mul_f32 v187, v187, |v187|
    v_cvt_pk_bf16_f32 v124, v184, v185
    v_cvt_pk_bf16_f32 v125, v186, v187
    v_pk_max_i16 v124, v124, 0
    v_pk_max_i16 v125, v125, 0
    v_mul_f32 v200, v200, |v200|
    v_mul_f32 v201, v201, |v201|
    v_mul_f32 v202, v202, |v202|
    v_mul_f32 v203, v203, |v203|
    v_cvt_pk_bf16_f32 v126, v200, v201
    v_cvt_pk_bf16_f32 v127, v202, v203
    v_pk_max_i16 v126, v126, 0
    v_pk_max_i16 v127, v127, 0
    buffer_store_dwordx4 v[124:127], v26, s[28:31], s65 offen offset:2048 sc1
    v_mul_f32 v188, v188, |v188|
    v_mul_f32 v189, v189, |v189|
    v_mul_f32 v190, v190, |v190|
    v_mul_f32 v191, v191, |v191|
    v_cvt_pk_bf16_f32 v128, v188, v189
    v_cvt_pk_bf16_f32 v129, v190, v191
    v_pk_max_i16 v128, v128, 0
    v_pk_max_i16 v129, v129, 0
    v_mul_f32 v204, v204, |v204|
    v_mul_f32 v205, v205, |v205|
    v_mul_f32 v206, v206, |v206|
    v_mul_f32 v207, v207, |v207|
    v_cvt_pk_bf16_f32 v130, v204, v205
    v_cvt_pk_bf16_f32 v131, v206, v207
    v_pk_max_i16 v130, v130, 0
    v_pk_max_i16 v131, v131, 0
    buffer_store_dwordx4 v[128:131], v26, s[28:31], s65 offen offset:3072 sc1
    s_add_u32 s65, s64, 16384
    v_mul_f32 v208, v208, |v208|
    v_mul_f32 v209, v209, |v209|
    v_mul_f32 v210, v210, |v210|
    v_mul_f32 v211, v211, |v211|
    v_cvt_pk_bf16_f32 v100, v208, v209
    v_cvt_pk_bf16_f32 v101, v210, v211
    v_pk_max_i16 v100, v100, 0
    v_pk_max_i16 v101, v101, 0
    v_mul_f32 v224, v224, |v224|
    v_mul_f32 v225, v225, |v225|
    v_mul_f32 v226, v226, |v226|
    v_mul_f32 v227, v227, |v227|
    v_cvt_pk_bf16_f32 v102, v224, v225
    v_cvt_pk_bf16_f32 v103, v226, v227
    v_pk_max_i16 v102, v102, 0
    v_pk_max_i16 v103, v103, 0
    buffer_store_dwordx4 v[100:103], v26, s[28:31], s65 offen offset:0 sc1
    v_mul_f32 v212, v212, |v212|
    v_mul_f32 v213, v213, |v213|
    v_mul_f32 v214, v214, |v214|
    v_mul_f32 v215, v215, |v215|
    v_cvt_pk_bf16_f32 v104, v212, v213
    v_cvt_pk_bf16_f32 v105, v214, v215
    v_pk_max_i16 v104, v104, 0
    v_pk_max_i16 v105, v105, 0
    v_mul_f32 v228, v228, |v228|
    v_mul_f32 v229, v229, |v229|
    v_mul_f32 v230, v230, |v230|
    v_mul_f32 v231, v231, |v231|
    v_cvt_pk_bf16_f32 v106, v228, v229
    v_cvt_pk_bf16_f32 v107, v230, v231
    v_pk_max_i16 v106, v106, 0
    v_pk_max_i16 v107, v107, 0
    buffer_store_dwordx4 v[104:107], v26, s[28:31], s65 offen offset:1024 sc1
    v_mul_f32 v216, v216, |v216|
    v_mul_f32 v217, v217, |v217|
    v_mul_f32 v218, v218, |v218|
    v_mul_f32 v219, v219, |v219|
    v_cvt_pk_bf16_f32 v108, v216, v217
    v_cvt_pk_bf16_f32 v109, v218, v219
    v_pk_max_i16 v108, v108, 0
    v_pk_max_i16 v109, v109, 0
    v_mul_f32 v232, v232, |v232|
    v_mul_f32 v233, v233, |v233|
    v_mul_f32 v234, v234, |v234|
    v_mul_f32 v235, v235, |v235|
    v_cvt_pk_bf16_f32 v110, v232, v233
    v_cvt_pk_bf16_f32 v111, v234, v235
    v_pk_max_i16 v110, v110, 0
    v_pk_max_i16 v111, v111, 0
    buffer_store_dwordx4 v[108:111], v26, s[28:31], s65 offen offset:2048 sc1
    v_mul_f32 v220, v220, |v220|
    v_mul_f32 v221, v221, |v221|
    v_mul_f32 v222, v222, |v222|
    v_mul_f32 v223, v223, |v223|
    v_cvt_pk_bf16_f32 v112, v220, v221
    v_cvt_pk_bf16_f32 v113, v222, v223
    v_pk_max_i16 v112, v112, 0
    v_pk_max_i16 v113, v113, 0
    v_mul_f32 v236, v236, |v236|
    v_mul_f32 v237, v237, |v237|
    v_mul_f32 v238, v238, |v238|
    v_mul_f32 v239, v239, |v239|
    v_cvt_pk_bf16_f32 v114, v236, v237
    v_cvt_pk_bf16_f32 v115, v238, v239
    v_pk_max_i16 v114, v114, 0
    v_pk_max_i16 v115, v115, 0
    buffer_store_dwordx4 v[112:115], v26, s[28:31], s65 offen offset:3072 sc1
    s_add_u32 s65, s64, 24576
    v_mul_f32 v240, v240, |v240|
    v_mul_f32 v241, v241, |v241|
    v_mul_f32 v242, v242, |v242|
    v_mul_f32 v243, v243, |v243|
    v_cvt_pk_bf16_f32 v116, v240, v241
    v_cvt_pk_bf16_f32 v117, v242, v243
    v_pk_max_i16 v116, v116, 0
    v_pk_max_i16 v117, v117, 0
    buffer_store_dwordx2 v[116:117], v26, s[28:31], s65 offen offset:0 sc1
    v_mul_f32 v244, v244, |v244|
    v_mul_f32 v245, v245, |v245|
    v_mul_f32 v246, v246, |v246|
    v_mul_f32 v247, v247, |v247|
    v_cvt_pk_bf16_f32 v120, v244, v245
    v_cvt_pk_bf16_f32 v121, v246, v247
    v_pk_max_i16 v120, v120, 0
    v_pk_max_i16 v121, v121, 0
    buffer_store_dwordx2 v[120:121], v26, s[28:31], s65 offen offset:1024 sc1
    v_mul_f32 v248, v248, |v248|
    v_mul_f32 v249, v249, |v249|
    v_mul_f32 v250, v250, |v250|
    v_mul_f32 v251, v251, |v251|
    v_cvt_pk_bf16_f32 v124, v248, v249
    v_cvt_pk_bf16_f32 v125, v250, v251
    v_pk_max_i16 v124, v124, 0
    v_pk_max_i16 v125, v125, 0
    buffer_store_dwordx2 v[124:125], v26, s[28:31], s65 offen offset:2048 sc1
    v_mul_f32 v252, v252, |v252|
    v_mul_f32 v253, v253, |v253|
    v_mul_f32 v254, v254, |v254|
    v_mul_f32 v255, v255, |v255|
    v_cvt_pk_bf16_f32 v128, v252, v253
    v_cvt_pk_bf16_f32 v129, v254, v255
    v_pk_max_i16 v128, v128, 0
    v_pk_max_i16 v129, v129, 0
    buffer_store_dwordx2 v[128:129], v26, s[28:31], s65 offen offset:3072 sc1
    s_branch HE2_68
HE1_67:
    s_add_u32 s65, s64, 32768
    v_mul_f32 v160, v160, |v160|
    v_mul_f32 v161, v161, |v161|
    v_mul_f32 v162, v162, |v162|
    v_mul_f32 v163, v163, |v163|
    v_cvt_pk_bf16_f32 v100, v160, v161
    v_cvt_pk_bf16_f32 v101, v162, v163
    v_pk_max_i16 v100, v100, 0
    v_pk_max_i16 v101, v101, 0
    v_mul_f32 v176, v176, |v176|
    v_mul_f32 v177, v177, |v177|
    v_mul_f32 v178, v178, |v178|
    v_mul_f32 v179, v179, |v179|
    v_cvt_pk_bf16_f32 v102, v176, v177
    v_cvt_pk_bf16_f32 v103, v178, v179
    v_pk_max_i16 v102, v102, 0
    v_pk_max_i16 v103, v103, 0
    buffer_store_dwordx4 v[100:103], v26, s[28:31], s65 offen offset:0 sc1
    v_mul_f32 v164, v164, |v164|
    v_mul_f32 v165, v165, |v165|
    v_mul_f32 v166, v166, |v166|
    v_mul_f32 v167, v167, |v167|
    v_cvt_pk_bf16_f32 v104, v164, v165
    v_cvt_pk_bf16_f32 v105, v166, v167
    v_pk_max_i16 v104, v104, 0
    v_pk_max_i16 v105, v105, 0
    v_mul_f32 v180, v180, |v180|
    v_mul_f32 v181, v181, |v181|
    v_mul_f32 v182, v182, |v182|
    v_mul_f32 v183, v183, |v183|
    v_cvt_pk_bf16_f32 v106, v180, v181
    v_cvt_pk_bf16_f32 v107, v182, v183
    v_pk_max_i16 v106, v106, 0
    v_pk_max_i16 v107, v107, 0
    buffer_store_dwordx4 v[104:107], v26, s[28:31], s65 offen offset:1024 sc1
    v_mul_f32 v168, v168, |v168|
    v_mul_f32 v169, v169, |v169|
    v_mul_f32 v170, v170, |v170|
    v_mul_f32 v171, v171, |v171|
    v_cvt_pk_bf16_f32 v108, v168, v169
    v_cvt_pk_bf16_f32 v109, v170, v171
    v_pk_max_i16 v108, v108, 0
    v_pk_max_i16 v109, v109, 0
    v_mul_f32 v184, v184, |v184|
    v_mul_f32 v185, v185, |v185|
    v_mul_f32 v186, v186, |v186|
    v_mul_f32 v187, v187, |v187|
    v_cvt_pk_bf16_f32 v110, v184, v185
    v_cvt_pk_bf16_f32 v111, v186, v187
    v_pk_max_i16 v110, v110, 0
    v_pk_max_i16 v111, v111, 0
    buffer_store_dwordx4 v[108:111], v26, s[28:31], s65 offen offset:2048 sc1
    v_mul_f32 v172, v172, |v172|
    v_mul_f32 v173, v173, |v173|
    v_mul_f32 v174, v174, |v174|
    v_mul_f32 v175, v175, |v175|
    v_cvt_pk_bf16_f32 v112, v172, v173
    v_cvt_pk_bf16_f32 v113, v174, v175
    v_pk_max_i16 v112, v112, 0
    v_pk_max_i16 v113, v113, 0
    v_mul_f32 v188, v188, |v188|
    v_mul_f32 v189, v189, |v189|
    v_mul_f32 v190, v190, |v190|
    v_mul_f32 v191, v191, |v191|
    v_cvt_pk_bf16_f32 v114, v188, v189
    v_cvt_pk_bf16_f32 v115, v190, v191
    v_pk_max_i16 v114, v114, 0
    v_pk_max_i16 v115, v115, 0
    buffer_store_dwordx4 v[112:115], v26, s[28:31], s65 offen offset:3072 sc1
    s_add_u32 s65, s64, 40960
    v_mul_f32 v192, v192, |v192|
    v_mul_f32 v193, v193, |v193|
    v_mul_f32 v194, v194, |v194|
    v_mul_f32 v195, v195, |v195|
    v_cvt_pk_bf16_f32 v116, v192, v193
    v_cvt_pk_bf16_f32 v117, v194, v195
    v_pk_max_i16 v116, v116, 0
    v_pk_max_i16 v117, v117, 0
    v_mul_f32 v208, v208, |v208|
    v_mul_f32 v209, v209, |v209|
    v_mul_f32 v210, v210, |v210|
    v_mul_f32 v211, v211, |v211|
    v_cvt_pk_bf16_f32 v118, v208, v209
    v_cvt_pk_bf16_f32 v119, v210, v211
    v_pk_max_i16 v118, v118, 0
    v_pk_max_i16 v119, v119, 0
    buffer_store_dwordx4 v[116:119], v26, s[28:31], s65 offen offset:0 sc1
    v_mul_f32 v196, v196, |v196|
    v_mul_f32 v197, v197, |v197|
    v_mul_f32 v198, v198, |v198|
    v_mul_f32 v199, v199, |v199|
    v_cvt_pk_bf16_f32 v120, v196, v197
    v_cvt_pk_bf16_f32 v121, v198, v199
    v_pk_max_i16 v120, v120, 0
    v_pk_max_i16 v121, v121, 0
    v_mul_f32 v212, v212, |v212|
    v_mul_f32 v213, v213, |v213|
    v_mul_f32 v214, v214, |v214|
    v_mul_f32 v215, v215, |v215|
    v_cvt_pk_bf16_f32 v122, v212, v213
    v_cvt_pk_bf16_f32 v123, v214, v215
    v_pk_max_i16 v122, v122, 0
    v_pk_max_i16 v123, v123, 0
    buffer_store_dwordx4 v[120:123], v26, s[28:31], s65 offen offset:1024 sc1
    v_mul_f32 v200, v200, |v200|
    v_mul_f32 v201, v201, |v201|
    v_mul_f32 v202, v202, |v202|
    v_mul_f32 v203, v203, |v203|
    v_cvt_pk_bf16_f32 v124, v200, v201
    v_cvt_pk_bf16_f32 v125, v202, v203
    v_pk_max_i16 v124, v124, 0
    v_pk_max_i16 v125, v125, 0
    v_mul_f32 v216, v216, |v216|
    v_mul_f32 v217, v217, |v217|
    v_mul_f32 v218, v218, |v218|
    v_mul_f32 v219, v219, |v219|
    v_cvt_pk_bf16_f32 v126, v216, v217
    v_cvt_pk_bf16_f32 v127, v218, v219
    v_pk_max_i16 v126, v126, 0
    v_pk_max_i16 v127, v127, 0
    buffer_store_dwordx4 v[124:127], v26, s[28:31], s65 offen offset:2048 sc1
    v_mul_f32 v204, v204, |v204|
    v_mul_f32 v205, v205, |v205|
    v_mul_f32 v206, v206, |v206|
    v_mul_f32 v207, v207, |v207|
    v_cvt_pk_bf16_f32 v128, v204, v205
    v_cvt_pk_bf16_f32 v129, v206, v207
    v_pk_max_i16 v128, v128, 0
    v_pk_max_i16 v129, v129, 0
    v_mul_f32 v220, v220, |v220|
    v_mul_f32 v221, v221, |v221|
    v_mul_f32 v222, v222, |v222|
    v_mul_f32 v223, v223, |v223|
    v_cvt_pk_bf16_f32 v130, v220, v221
    v_cvt_pk_bf16_f32 v131, v222, v223
    v_pk_max_i16 v130, v130, 0
    v_pk_max_i16 v131, v131, 0
    buffer_store_dwordx4 v[128:131], v26, s[28:31], s65 offen offset:3072 sc1
    s_add_u32 s65, s64, 49152
    v_mul_f32 v224, v224, |v224|
    v_mul_f32 v225, v225, |v225|
    v_mul_f32 v226, v226, |v226|
    v_mul_f32 v227, v227, |v227|
    v_cvt_pk_bf16_f32 v100, v224, v225
    v_cvt_pk_bf16_f32 v101, v226, v227
    v_pk_max_i16 v100, v100, 0
    v_pk_max_i16 v101, v101, 0
    v_mul_f32 v240, v240, |v240|
    v_mul_f32 v241, v241, |v241|
    v_mul_f32 v242, v242, |v242|
    v_mul_f32 v243, v243, |v243|
    v_cvt_pk_bf16_f32 v102, v240, v241
    v_cvt_pk_bf16_f32 v103, v242, v243
    v_pk_max_i16 v102, v102, 0
    v_pk_max_i16 v103, v103, 0
    buffer_store_dwordx4 v[100:103], v26, s[28:31], s65 offen offset:0 sc1
    v_mul_f32 v228, v228, |v228|
    v_mul_f32 v229, v229, |v229|
    v_mul_f32 v230, v230, |v230|
    v_mul_f32 v231, v231, |v231|
    v_cvt_pk_bf16_f32 v104, v228, v229
    v_cvt_pk_bf16_f32 v105, v230, v231
    v_pk_max_i16 v104, v104, 0
    v_pk_max_i16 v105, v105, 0
    v_mul_f32 v244, v244, |v244|
    v_mul_f32 v245, v245, |v245|
    v_mul_f32 v246, v246, |v246|
    v_mul_f32 v247, v247, |v247|
    v_cvt_pk_bf16_f32 v106, v244, v245
    v_cvt_pk_bf16_f32 v107, v246, v247
    v_pk_max_i16 v106, v106, 0
    v_pk_max_i16 v107, v107, 0
    buffer_store_dwordx4 v[104:107], v26, s[28:31], s65 offen offset:1024 sc1
    v_mul_f32 v232, v232, |v232|
    v_mul_f32 v233, v233, |v233|
    v_mul_f32 v234, v234, |v234|
    v_mul_f32 v235, v235, |v235|
    v_cvt_pk_bf16_f32 v108, v232, v233
    v_cvt_pk_bf16_f32 v109, v234, v235
    v_pk_max_i16 v108, v108, 0
    v_pk_max_i16 v109, v109, 0
    v_mul_f32 v248, v248, |v248|
    v_mul_f32 v249, v249, |v249|
    v_mul_f32 v250, v250, |v250|
    v_mul_f32 v251, v251, |v251|
    v_cvt_pk_bf16_f32 v110, v248, v249
    v_cvt_pk_bf16_f32 v111, v250, v251
    v_pk_max_i16 v110, v110, 0
    v_pk_max_i16 v111, v111, 0
    buffer_store_dwordx4 v[108:111], v26, s[28:31], s65 offen offset:2048 sc1
    v_mul_f32 v236, v236, |v236|
    v_mul_f32 v237, v237, |v237|
    v_mul_f32 v238, v238, |v238|
    v_mul_f32 v239, v239, |v239|
    v_cvt_pk_bf16_f32 v112, v236, v237
    v_cvt_pk_bf16_f32 v113, v238, v239
    v_pk_max_i16 v112, v112, 0
    v_pk_max_i16 v113, v113, 0
    v_mul_f32 v252, v252, |v252|
    v_mul_f32 v253, v253, |v253|
    v_mul_f32 v254, v254, |v254|
    v_mul_f32 v255, v255, |v255|
    v_cvt_pk_bf16_f32 v114, v252, v253
    v_cvt_pk_bf16_f32 v115, v254, v255
    v_pk_max_i16 v114, v114, 0
    v_pk_max_i16 v115, v115, 0
    buffer_store_dwordx4 v[112:115], v26, s[28:31], s65 offen offset:3072 sc1
    s_add_u32 s65, s64, 24584
    v_mul_f32 v144, v144, |v144|
    v_mul_f32 v145, v145, |v145|
    v_mul_f32 v146, v146, |v146|
    v_mul_f32 v147, v147, |v147|
    v_cvt_pk_bf16_f32 v116, v144, v145
    v_cvt_pk_bf16_f32 v117, v146, v147
    v_pk_max_i16 v116, v116, 0
    v_pk_max_i16 v117, v117, 0
    buffer_store_dwordx2 v[116:117], v26, s[28:31], s65 offen offset:0 sc1
    v_mul_f32 v148, v148, |v148|
    v_mul_f32 v149, v149, |v149|
    v_mul_f32 v150, v150, |v150|
    v_mul_f32 v151, v151, |v151|
    v_cvt_pk_bf16_f32 v120, v148, v149
    v_cvt_pk_bf16_f32 v121, v150, v151
    v_pk_max_i16 v120, v120, 0
    v_pk_max_i16 v121, v121, 0
    buffer_store_dwordx2 v[120:121], v26, s[28:31], s65 offen offset:1024 sc1
    v_mul_f32 v152, v152, |v152|
    v_mul_f32 v153, v153, |v153|
    v_mul_f32 v154, v154, |v154|
    v_mul_f32 v155, v155, |v155|
    v_cvt_pk_bf16_f32 v124, v152, v153
    v_cvt_pk_bf16_f32 v125, v154, v155
    v_pk_max_i16 v124, v124, 0
    v_pk_max_i16 v125, v125, 0
    buffer_store_dwordx2 v[124:125], v26, s[28:31], s65 offen offset:2048 sc1
    v_mul_f32 v156, v156, |v156|
    v_mul_f32 v157, v157, |v157|
    v_mul_f32 v158, v158, |v158|
    v_mul_f32 v159, v159, |v159|
    v_cvt_pk_bf16_f32 v128, v156, v157
    v_cvt_pk_bf16_f32 v129, v158, v159
    v_pk_max_i16 v128, v128, 0
    v_pk_max_i16 v129, v129, 0
    buffer_store_dwordx2 v[128:129], v26, s[28:31], s65 offen offset:3072 sc1
HE2_68:
    s_waitcnt lgkmcnt(0)
    v_mfma_f32_16x16x32_bf16 v[176:179], v[84:87], v[56:59], 0
    ds_read_b128 v[100:103], v11 offset:0
    v_mfma_f32_16x16x32_bf16 v[180:183], v[84:87], v[60:63], 0
    ds_read_b64_tr_b16 v[128:129], v12 offset:12416
    v_mfma_f32_16x16x32_bf16 v[184:187], v[84:87], v[64:67], 0
    ds_read_b64_tr_b16 v[130:131], v12 offset:13952
    v_mfma_f32_16x16x32_bf16 v[188:191], v[84:87], v[68:71], 0
    ds_read_b128 v[104:107], v11 offset:2048
    v_mfma_f32_16x16x32_bf16 v[192:195], v[84:87], v[72:75], 0
    ds_read_b128 v[108:111], v11 offset:4096
    v_mfma_f32_16x16x32_bf16 v[196:199], v[88:91], v[56:59], 0
    ds_read_b128 v[112:115], v11 offset:6144
    v_mfma_f32_16x16x32_bf16 v[200:203], v[88:91], v[60:63], 0
    ds_read_b128 v[116:119], v11 offset:8192
    v_mfma_f32_16x16x32_bf16 v[204:207], v[88:91], v[64:67], 0
    ds_read_b64_tr_b16 v[132:133], v13 offset:12416
    v_mfma_f32_16x16x32_bf16 v[208:211], v[88:91], v[68:71], 0
    ds_read_b64_tr_b16 v[134:135], v13 offset:13952
    v_mfma_f32_16x16x32_bf16 v[212:215], v[88:91], v[72:75], 0
    ds_read_b64_tr_b16 v[136:137], v12 offset:12544
    v_mfma_f32_16x16x32_bf16 v[216:219], v[56:59], v[92:95], 0
    ds_read_b64_tr_b16 v[138:139], v12 offset:14080
    v_mfma_f32_16x16x32_bf16 v[220:223], v[60:63], v[92:95], 0
    ds_read_b64_tr_b16 v[140:141], v13 offset:12544
    v_mfma_f32_16x16x32_bf16 v[224:227], v[64:67], v[92:95], 0
    ds_read_b64_tr_b16 v[142:143], v13 offset:14080
    v_mfma_f32_16x16x32_bf16 v[228:231], v[68:71], v[92:95], 0
    ds_read_b64_tr_b16 v[120:121], v12 offset:12288
    v_mfma_f32_16x16x32_bf16 v[232:235], v[72:75], v[92:95], 0
    ds_read_b64_tr_b16 v[122:123], v12 offset:13824
    v_mfma_f32_16x16x32_bf16 v[236:239], v[56:59], v[96:99], 0
    ds_read_b64_tr_b16 v[124:125], v13 offset:12288
    v_mfma_f32_16x16x32_bf16 v[240:243], v[60:63], v[96:99], 0
    ds_read_b64_tr_b16 v[126:127], v13 offset:13824
    v_mfma_f32_16x16x32_bf16 v[244:247], v[64:67], v[96:99], 0
    v_and_b32 v2, 15, v1
    v_mfma_f32_16x16x32_bf16 v[248:251], v[68:71], v[96:99], 0
    v_lshrrev_b32 v3, 4, v1
    v_mfma_f32_16x16x32_bf16 v[252:255], v[72:75], v[96:99], 0
    v_lshlrev_b32 v3, 2, v3
    v_mfma_f32_16x16x32_bf16 v[144:147], v[76:79], v[60:63], 0
    v_mfma_f32_16x16x32_bf16 v[148:151], v[76:79], v[64:67], 0
    v_sub_u32 v2, v2, v3
    v_mfma_f32_16x16x32_bf16 v[152:155], v[76:79], v[68:71], 0
    v_mov_b32 v4, 0xf149f2ca
    v_mfma_f32_16x16x32_bf16 v[156:159], v[76:79], v[72:75], 0
    v_add_u32 v3, 16, v2
    v_mfma_f32_16x16x32_bf16 v[160:163], v[80:83], v[60:63], 0
    v_mfma_f32_16x16x32_bf16 v[164:167], v[80:83], v[64:67], 0
    v_and_b32 v5, 0xfffffff1, v3
    v_mfma_f32_16x16x32_bf16 v[168:171], v[80:83], v[68:71], 0
    v_cmp_eq_u32 s[44:45], 0, v5
    v_mfma_f32_16x16x32_bf16 v[172:175], v[80:83], v[72:75], 0
    s_waitcnt lgkmcnt(0)
    v_mfma_f32_16x16x32_bf16 v[176:179], v[128:131], v[100:103], v[176:179]
    s_barrier
    v_mfma_f32_16x16x32_bf16 v[180:183], v[128:131], v[104:107], v[180:183]
    ds_read_b128 v[56:59], v14 offset:0
    v_mfma_f32_16x16x32_bf16 v[184:187], v[128:131], v[108:111], v[184:187]
    ds_read_b64_tr_b16 v[84:85], v16 offset:128
    v_mfma_f32_16x16x32_bf16 v[188:191], v[128:131], v[112:115], v[188:191]
    ds_read_b64_tr_b16 v[86:87], v16 offset:1664
    v_mfma_f32_16x16x32_bf16 v[192:195], v[128:131], v[116:119], v[192:195]
    ds_read_b128 v[60:63], v14 offset:2048
    v_mfma_f32_16x16x32_bf16 v[196:199], v[132:135], v[100:103], v[196:199]
    ds_read_b128 v[64:67], v14 offset:4096
    v_mfma_f32_16x16x32_bf16 v[200:203], v[132:135], v[104:107], v[200:203]
    ds_read_b128 v[68:71], v14 offset:6144
    v_mfma_f32_16x16x32_bf16 v[204:207], v[132:135], v[108:111], v[204:207]
    ds_read_b128 v[72:75], v14 offset:8192
    v_mfma_f32_16x16x32_bf16 v[208:211], v[132:135], v[112:115], v[208:211]
    ds_read_b64_tr_b16 v[88:89], v17 offset:128
    v_mfma_f32_16x16x32_bf16 v[212:215], v[132:135], v[116:119], v[212:215]
    ds_read_b64_tr_b16 v[90:91], v17 offset:1664
    v_mfma_f32_16x16x32_bf16 v[216:219], v[100:103], v[136:139], v[216:219]
    ds_read_b64_tr_b16 v[92:93], v16 offset:256
    v_mfma_f32_16x16x32_bf16 v[220:223], v[104:107], v[136:139], v[220:223]
    ds_read_b64_tr_b16 v[94:95], v16 offset:1792
    v_mfma_f32_16x16x32_bf16 v[224:227], v[108:111], v[136:139], v[224:227]
    ds_read_b64_tr_b16 v[96:97], v17 offset:256
    v_mfma_f32_16x16x32_bf16 v[228:231], v[112:115], v[136:139], v[228:231]
    ds_read_b64_tr_b16 v[98:99], v17 offset:1792
    v_mfma_f32_16x16x32_bf16 v[232:235], v[116:119], v[136:139], v[232:235]
    ds_read_b64_tr_b16 v[76:77], v16 offset:0
    v_mfma_f32_16x16x32_bf16 v[236:239], v[100:103], v[140:143], v[236:239]
    ds_read_b64_tr_b16 v[78:79], v16 offset:1536
    v_mfma_f32_16x16x32_bf16 v[240:243], v[104:107], v[140:143], v[240:243]
    ds_read_b64_tr_b16 v[80:81], v17 offset:0
    v_mfma_f32_16x16x32_bf16 v[244:247], v[108:111], v[140:143], v[244:247]
    ds_read_b64_tr_b16 v[82:83], v17 offset:1536
    v_mfma_f32_16x16x32_bf16 v[248:251], v[112:115], v[140:143], v[248:251]
    v_add_u32 v3, 15, v2
    v_mfma_f32_16x16x32_bf16 v[252:255], v[116:119], v[140:143], v[252:255]
    v_and_b32 v5, 0xfffffff1, v3
    v_mfma_f32_16x16x32_bf16 v[144:147], v[120:123], v[104:107], v[144:147]
    v_cmp_eq_u32 s[46:47], 0, v5
    v_mfma_f32_16x16x32_bf16 v[148:151], v[120:123], v[108:111], v[148:151]
    v_add_u32 v3, 14, v2
    v_mfma_f32_16x16x32_bf16 v[152:155], v[120:123], v[112:115], v[152:155]
    v_mfma_f32_16x16x32_bf16 v[156:159], v[120:123], v[116:119], v[156:159]
    v_and_b32 v5, 0xfffffff1, v3
    v_mfma_f32_16x16x32_bf16 v[160:163], v[124:127], v[104:107], v[160:163]
    v_cmp_eq_u32 s[48:49], 0, v5
    v_mfma_f32_16x16x32_bf16 v[164:167], v[124:127], v[108:111], v[164:167]
    v_add_u32 v3, 13, v2
    v_mfma_f32_16x16x32_bf16 v[168:171], v[124:127], v[112:115], v[168:171]
    v_and_b32 v5, 0xfffffff1, v3
    v_mfma_f32_16x16x32_bf16 v[172:175], v[124:127], v[116:119], v[172:175]
    s_waitcnt lgkmcnt(0)
    v_mfma_f32_16x16x32_bf16 v[176:179], v[84:87], v[56:59], v[176:179]
    ds_read_b128 v[100:103], v15 offset:0
    v_mfma_f32_16x16x32_bf16 v[180:183], v[84:87], v[60:63], v[180:183]
    ds_read_b64_tr_b16 v[128:129], v16 offset:12416
    v_mfma_f32_16x16x32_bf16 v[184:187], v[84:87], v[64:67], v[184:187]
    ds_read_b64_tr_b16 v[130:131], v16 offset:13952
    v_mfma_f32_16x16x32_bf16 v[188:191], v[84:87], v[68:71], v[188:191]
    ds_read_b128 v[104:107], v15 offset:2048
    v_mfma_f32_16x16x32_bf16 v[192:195], v[84:87], v[72:75], v[192:195]
    ds_read_b128 v[108:111], v15 offset:4096
    v_mfma_f32_16x16x32_bf16 v[196:199], v[88:91], v[56:59], v[196:199]
    ds_read_b128 v[112:115], v15 offset:6144
    v_mfma_f32_16x16x32_bf16 v[200:203], v[88:91], v[60:63], v[200:203]
    ds_read_b128 v[116:119], v15 offset:8192
    v_mfma_f32_16x16x32_bf16 v[204:207], v[88:91], v[64:67], v[204:207]
    ds_read_b64_tr_b16 v[132:133], v17 offset:12416
    v_mfma_f32_16x16x32_bf16 v[208:211], v[88:91], v[68:71], v[208:211]
    ds_read_b64_tr_b16 v[134:135], v17 offset:13952
    v_mfma_f32_16x16x32_bf16 v[212:215], v[88:91], v[72:75], v[212:215]
    ds_read_b64_tr_b16 v[136:137], v16 offset:12544
    v_mfma_f32_16x16x32_bf16 v[216:219], v[56:59], v[92:95], v[216:219]
    ds_read_b64_tr_b16 v[138:139], v16 offset:14080
    v_mfma_f32_16x16x32_bf16 v[220:223], v[60:63], v[92:95], v[220:223]
    ds_read_b64_tr_b16 v[140:141], v17 offset:12544
    v_mfma_f32_16x16x32_bf16 v[224:227], v[64:67], v[92:95], v[224:227]
    ds_read_b64_tr_b16 v[142:143], v17 offset:14080
    v_mfma_f32_16x16x32_bf16 v[228:231], v[68:71], v[92:95], v[228:231]
    ds_read_b64_tr_b16 v[120:121], v16 offset:12288
    v_mfma_f32_16x16x32_bf16 v[232:235], v[72:75], v[92:95], v[232:235]
    ds_read_b64_tr_b16 v[122:123], v16 offset:13824
    v_mfma_f32_16x16x32_bf16 v[236:239], v[56:59], v[96:99], v[236:239]
    ds_read_b64_tr_b16 v[124:125], v17 offset:12288
    v_mfma_f32_16x16x32_bf16 v[240:243], v[60:63], v[96:99], v[240:243]
    ds_read_b64_tr_b16 v[126:127], v17 offset:13824
    v_mfma_f32_16x16x32_bf16 v[244:247], v[64:67], v[96:99], v[244:247]
    v_cmp_eq_u32 s[50:51], 0, v5
    v_mfma_f32_16x16x32_bf16 v[248:251], v[68:71], v[96:99], v[248:251]
    s_or_b32 s62, s53, s55
    v_mfma_f32_16x16x32_bf16 v[252:255], v[72:75], v[96:99], v[252:255]
    v_nop
    v_mfma_f32_16x16x32_bf16 v[144:147], v[76:79], v[60:63], v[144:147]
    v_mfma_f32_16x16x32_bf16 v[148:151], v[76:79], v[64:67], v[148:151]
    v_cndmask_b32 v28, v4, 0, s[44:45]
    v_mfma_f32_16x16x32_bf16 v[152:155], v[76:79], v[68:71], v[152:155]
    v_cndmask_b32 v29, v4, 0, s[46:47]
    v_mfma_f32_16x16x32_bf16 v[156:159], v[76:79], v[72:75], v[156:159]
    v_cndmask_b32 v30, v4, 0, s[48:49]
    v_mfma_f32_16x16x32_bf16 v[160:163], v[80:83], v[60:63], v[160:163]
    v_mfma_f32_16x16x32_bf16 v[164:167], v[80:83], v[64:67], v[164:167]
    v_cndmask_b32 v31, v4, 0, s[50:51]
    v_mfma_f32_16x16x32_bf16 v[168:171], v[80:83], v[68:71], v[168:171]
    v_add_u32 v3, 0, v2
    v_mfma_f32_16x16x32_bf16 v[172:175], v[80:83], v[72:75], v[172:175]
    s_waitcnt lgkmcnt(0)
    v_mfma_f32_16x16x32_bf16 v[176:179], v[128:131], v[100:103], v[176:179]
    s_barrier
    v_mfma_f32_16x16x32_bf16 v[180:183], v[128:131], v[104:107], v[180:183]
    ds_read_b128 v[56:59], v6 offset:0
    v_mfma_f32_16x16x32_bf16 v[184:187], v[128:131], v[108:111], v[184:187]
    ds_read_b64_tr_b16 v[84:85], v8 offset:128
    v_mfma_f32_16x16x32_bf16 v[188:191], v[128:131], v[112:115], v[188:191]
    ds_read_b64_tr_b16 v[86:87], v8 offset:1664
    v_mfma_f32_16x16x32_bf16 v[192:195], v[128:131], v[116:119], v[192:195]
    ds_read_b128 v[60:63], v6 offset:2048
    v_mfma_f32_16x16x32_bf16 v[196:199], v[132:135], v[100:103], v[196:199]
    ds_read_b128 v[64:67], v6 offset:4096
    v_mfma_f32_16x16x32_bf16 v[200:203], v[132:135], v[104:107], v[200:203]
    ds_read_b128 v[68:71], v6 offset:6144
    v_mfma_f32_16x16x32_bf16 v[204:207], v[132:135], v[108:111], v[204:207]
    ds_read_b128 v[72:75], v6 offset:8192
    v_mfma_f32_16x16x32_bf16 v[208:211], v[132:135], v[112:115], v[208:211]
    ds_read_b64_tr_b16 v[88:89], v9 offset:128
    v_mfma_f32_16x16x32_bf16 v[212:215], v[132:135], v[116:119], v[212:215]
    ds_read_b64_tr_b16 v[90:91], v9 offset:1664
    v_mfma_f32_16x16x32_bf16 v[216:219], v[100:103], v[136:139], v[216:219]
    ds_read_b64_tr_b16 v[92:93], v8 offset:256
    v_mfma_f32_16x16x32_bf16 v[220:223], v[104:107], v[136:139], v[220:223]
    ds_read_b64_tr_b16 v[94:95], v8 offset:1792
    v_mfma_f32_16x16x32_bf16 v[224:227], v[108:111], v[136:139], v[224:227]
    ds_read_b64_tr_b16 v[96:97], v9 offset:256
    v_mfma_f32_16x16x32_bf16 v[228:231], v[112:115], v[136:139], v[228:231]
    ds_read_b64_tr_b16 v[98:99], v9 offset:1792
    v_mfma_f32_16x16x32_bf16 v[232:235], v[116:119], v[136:139], v[232:235]
    ds_read_b64_tr_b16 v[76:77], v8 offset:0
    v_mfma_f32_16x16x32_bf16 v[236:239], v[100:103], v[140:143], v[236:239]
    ds_read_b64_tr_b16 v[78:79], v8 offset:1536
    v_mfma_f32_16x16x32_bf16 v[240:243], v[104:107], v[140:143], v[240:243]
    ds_read_b64_tr_b16 v[80:81], v9 offset:0
    v_mfma_f32_16x16x32_bf16 v[244:247], v[108:111], v[140:143], v[244:247]
    ds_read_b64_tr_b16 v[82:83], v9 offset:1536
    v_mfma_f32_16x16x32_bf16 v[248:251], v[112:115], v[140:143], v[248:251]
    v_and_b32 v5, 0xfffffff1, v3
    v_mfma_f32_16x16x32_bf16 v[252:255], v[116:119], v[140:143], v[252:255]
    v_cmp_eq_u32 s[44:45], 0, v5
    v_mfma_f32_16x16x32_bf16 v[144:147], v[120:123], v[104:107], v[144:147]
    v_add_u32 v3, -1, v2
    v_mfma_f32_16x16x32_bf16 v[148:151], v[120:123], v[108:111], v[148:151]
    v_and_b32 v5, 0xfffffff1, v3
    v_mfma_f32_16x16x32_bf16 v[152:155], v[120:123], v[112:115], v[152:155]
    v_mfma_f32_16x16x32_bf16 v[156:159], v[120:123], v[116:119], v[156:159]
    v_cmp_eq_u32 s[46:47], 0, v5
    v_mfma_f32_16x16x32_bf16 v[160:163], v[124:127], v[104:107], v[160:163]
    v_add_u32 v3, -2, v2
    v_mfma_f32_16x16x32_bf16 v[164:167], v[124:127], v[108:111], v[164:167]
    v_and_b32 v5, 0xfffffff1, v3
    v_mfma_f32_16x16x32_bf16 v[168:171], v[124:127], v[112:115], v[168:171]
    v_cmp_eq_u32 s[48:49], 0, v5
    v_mfma_f32_16x16x32_bf16 v[172:175], v[124:127], v[116:119], v[172:175]
    s_waitcnt lgkmcnt(0)
    v_mfma_f32_16x16x32_bf16 v[176:179], v[84:87], v[56:59], v[176:179]
    ds_read_b128 v[100:103], v7 offset:0
    v_mfma_f32_16x16x32_bf16 v[180:183], v[84:87], v[60:63], v[180:183]
    ds_read_b64_tr_b16 v[128:129], v8 offset:12416
    v_mfma_f32_16x16x32_bf16 v[184:187], v[84:87], v[64:67], v[184:187]
    ds_read_b64_tr_b16 v[130:131], v8 offset:13952
    v_mfma_f32_16x16x32_bf16 v[188:191], v[84:87], v[68:71], v[188:191]
    ds_read_b128 v[104:107], v7 offset:2048
    v_mfma_f32_16x16x32_bf16 v[192:195], v[84:87], v[72:75], v[192:195]
    ds_read_b128 v[108:111], v7 offset:4096
    v_mfma_f32_16x16x32_bf16 v[196:199], v[88:91], v[56:59], v[196:199]
    ds_read_b128 v[112:115], v7 offset:6144
    v_mfma_f32_16x16x32_bf16 v[200:203], v[88:91], v[60:63], v[200:203]
    ds_read_b128 v[116:119], v7 offset:8192
    v_mfma_f32_16x16x32_bf16 v[204:207], v[88:91], v[64:67], v[204:207]
    ds_read_b64_tr_b16 v[132:133], v9 offset:12416
    v_mfma_f32_16x16x32_bf16 v[208:211], v[88:91], v[68:71], v[208:211]
    ds_read_b64_tr_b16 v[134:135], v9 offset:13952
    v_mfma_f32_16x16x32_bf16 v[212:215], v[88:91], v[72:75], v[212:215]
    ds_read_b64_tr_b16 v[136:137], v8 offset:12544
    v_mfma_f32_16x16x32_bf16 v[216:219], v[56:59], v[92:95], v[216:219]
    ds_read_b64_tr_b16 v[138:139], v8 offset:14080
    v_mfma_f32_16x16x32_bf16 v[220:223], v[60:63], v[92:95], v[220:223]
    ds_read_b64_tr_b16 v[140:141], v9 offset:12544
    v_mfma_f32_16x16x32_bf16 v[224:227], v[64:67], v[92:95], v[224:227]
    ds_read_b64_tr_b16 v[142:143], v9 offset:14080
    v_mfma_f32_16x16x32_bf16 v[228:231], v[68:71], v[92:95], v[228:231]
    ds_read_b64_tr_b16 v[120:121], v8 offset:12288
    v_mfma_f32_16x16x32_bf16 v[232:235], v[72:75], v[92:95], v[232:235]
    ds_read_b64_tr_b16 v[122:123], v8 offset:13824
    v_mfma_f32_16x16x32_bf16 v[236:239], v[56:59], v[96:99], v[236:239]
    ds_read_b64_tr_b16 v[124:125], v9 offset:12288
    v_mfma_f32_16x16x32_bf16 v[240:243], v[60:63], v[96:99], v[240:243]
    ds_read_b64_tr_b16 v[126:127], v9 offset:13824
    v_mfma_f32_16x16x32_bf16 v[244:247], v[64:67], v[96:99], v[244:247]
    v_add_u32 v3, -3, v2
    v_mfma_f32_16x16x32_bf16 v[248:251], v[68:71], v[96:99], v[248:251]
    v_and_b32 v5, 0xfffffff1, v3
    v_mfma_f32_16x16x32_bf16 v[252:255], v[72:75], v[96:99], v[252:255]
    v_cmp_eq_u32 s[50:51], 0, v5
    v_mfma_f32_16x16x32_bf16 v[144:147], v[76:79], v[60:63], v[144:147]
    v_mfma_f32_16x16x32_bf16 v[148:151], v[76:79], v[64:67], v[148:151]
    s_cmp_eq_u32 s62, 0
    v_mfma_f32_16x16x32_bf16 v[152:155], v[76:79], v[68:71], v[152:155]
    v_nop
    v_mfma_f32_16x16x32_bf16 v[156:159], v[76:79], v[72:75], v[156:159]
    v_cndmask_b32 v32, v4, 0, s[44:45]
    v_mfma_f32_16x16x32_bf16 v[160:163], v[80:83], v[60:63], v[160:163]
    v_mfma_f32_16x16x32_bf16 v[164:167], v[80:83], v[64:67], v[164:167]
    v_cndmask_b32 v33, v4, 0, s[46:47]
    v_mfma_f32_16x16x32_bf16 v[168:171], v[80:83], v[68:71], v[168:171]
    v_cndmask_b32 v34, v4, 0, s[48:49]
    v_mfma_f32_16x16x32_bf16 v[172:175], v[80:83], v[72:75], v[172:175]
    s_waitcnt lgkmcnt(0)
    v_mfma_f32_16x16x32_bf16 v[176:179], v[128:131], v[100:103], v[176:179]
    s_barrier
    v_mfma_f32_16x16x32_bf16 v[180:183], v[128:131], v[104:107], v[180:183]
    ds_read_b128 v[56:59], v10 offset:0
    v_mfma_f32_16x16x32_bf16 v[184:187], v[128:131], v[108:111], v[184:187]
    ds_read_b64_tr_b16 v[84:85], v12 offset:128
    v_mfma_f32_16x16x32_bf16 v[188:191], v[128:131], v[112:115], v[188:191]
    ds_read_b64_tr_b16 v[86:87], v12 offset:1664
    v_mfma_f32_16x16x32_bf16 v[192:195], v[128:131], v[116:119], v[192:195]
    ds_read_b128 v[60:63], v10 offset:2048
    v_mfma_f32_16x16x32_bf16 v[196:199], v[132:135], v[100:103], v[196:199]
    ds_read_b128 v[64:67], v10 offset:4096
    v_mfma_f32_16x16x32_bf16 v[200:203], v[132:135], v[104:107], v[200:203]
    ds_read_b128 v[68:71], v10 offset:6144
    v_mfma_f32_16x16x32_bf16 v[204:207], v[132:135], v[108:111], v[204:207]
    ds_read_b128 v[72:75], v10 offset:8192
    v_mfma_f32_16x16x32_bf16 v[208:211], v[132:135], v[112:115], v[208:211]
    ds_read_b64_tr_b16 v[88:89], v13 offset:128
    v_mfma_f32_16x16x32_bf16 v[212:215], v[132:135], v[116:119], v[212:215]
    ds_read_b64_tr_b16 v[90:91], v13 offset:1664
    v_mfma_f32_16x16x32_bf16 v[216:219], v[100:103], v[136:139], v[216:219]
    ds_read_b64_tr_b16 v[92:93], v12 offset:256
    v_mfma_f32_16x16x32_bf16 v[220:223], v[104:107], v[136:139], v[220:223]
    ds_read_b64_tr_b16 v[94:95], v12 offset:1792
    v_mfma_f32_16x16x32_bf16 v[224:227], v[108:111], v[136:139], v[224:227]
    ds_read_b64_tr_b16 v[96:97], v13 offset:256
    v_mfma_f32_16x16x32_bf16 v[228:231], v[112:115], v[136:139], v[228:231]
    ds_read_b64_tr_b16 v[98:99], v13 offset:1792
    v_mfma_f32_16x16x32_bf16 v[232:235], v[116:119], v[136:139], v[232:235]
    ds_read_b64_tr_b16 v[76:77], v12 offset:0
    v_mfma_f32_16x16x32_bf16 v[236:239], v[100:103], v[140:143], v[236:239]
    ds_read_b64_tr_b16 v[78:79], v12 offset:1536
    v_mfma_f32_16x16x32_bf16 v[240:243], v[104:107], v[140:143], v[240:243]
    ds_read_b64_tr_b16 v[80:81], v13 offset:0
    v_mfma_f32_16x16x32_bf16 v[244:247], v[108:111], v[140:143], v[244:247]
    ds_read_b64_tr_b16 v[82:83], v13 offset:1536
    v_mfma_f32_16x16x32_bf16 v[248:251], v[112:115], v[140:143], v[248:251]
    v_cndmask_b32 v35, v4, 0, s[50:51]
    v_mfma_f32_16x16x32_bf16 v[252:255], v[116:119], v[140:143], v[252:255]
    s_cmp_eq_u32 s62, 0
    v_mfma_f32_16x16x32_bf16 v[144:147], v[120:123], v[104:107], v[144:147]
    s_cselect_b64 s[44:45], -1, 0
    v_mfma_f32_16x16x32_bf16 v[148:151], v[120:123], v[108:111], v[148:151]
    v_mfma_f32_16x16x32_bf16 v[152:155], v[120:123], v[112:115], v[152:155]
    v_cndmask_b32 v36, v28, v4, s[44:45]
    v_mfma_f32_16x16x32_bf16 v[156:159], v[120:123], v[116:119], v[156:159]
    v_cndmask_b32 v37, v29, v4, s[44:45]
    v_mfma_f32_16x16x32_bf16 v[160:163], v[124:127], v[104:107], v[160:163]
    v_mfma_f32_16x16x32_bf16 v[164:167], v[124:127], v[108:111], v[164:167]
    v_cndmask_b32 v38, v30, v4, s[44:45]
    v_mfma_f32_16x16x32_bf16 v[168:171], v[124:127], v[112:115], v[168:171]
    v_cndmask_b32 v39, v31, v4, s[44:45]
    v_mfma_f32_16x16x32_bf16 v[172:175], v[124:127], v[116:119], v[172:175]
    s_mov_b32 s61, 4
LP_69:
    s_waitcnt lgkmcnt(0)
    v_mfma_f32_16x16x32_bf16 v[176:179], v[84:87], v[56:59], v[176:179]
    ds_read_b128 v[100:103], v11 offset:0
    v_mfma_f32_16x16x32_bf16 v[180:183], v[84:87], v[60:63], v[180:183]
    ds_read_b64_tr_b16 v[128:129], v12 offset:12416
    v_mfma_f32_16x16x32_bf16 v[184:187], v[84:87], v[64:67], v[184:187]
    ds_read_b64_tr_b16 v[130:131], v12 offset:13952
    v_mfma_f32_16x16x32_bf16 v[188:191], v[84:87], v[68:71], v[188:191]
    ds_read_b128 v[104:107], v11 offset:2048
    v_mfma_f32_16x16x32_bf16 v[192:195], v[84:87], v[72:75], v[192:195]
    ds_read_b128 v[108:111], v11 offset:4096
    v_mfma_f32_16x16x32_bf16 v[196:199], v[88:91], v[56:59], v[196:199]
    ds_read_b128 v[112:115], v11 offset:6144
    v_mfma_f32_16x16x32_bf16 v[200:203], v[88:91], v[60:63], v[200:203]
    ds_read_b128 v[116:119], v11 offset:8192
    v_mfma_f32_16x16x32_bf16 v[204:207], v[88:91], v[64:67], v[204:207]
    ds_read_b64_tr_b16 v[132:133], v13 offset:12416
    v_mfma_f32_16x16x32_bf16 v[208:211], v[88:91], v[68:71], v[208:211]
    ds_read_b64_tr_b16 v[134:135], v13 offset:13952
    v_mfma_f32_16x16x32_bf16 v[212:215], v[88:91], v[72:75], v[212:215]
    ds_read_b64_tr_b16 v[136:137], v12 offset:12544
    v_mfma_f32_16x16x32_bf16 v[216:219], v[56:59], v[92:95], v[216:219]
    ds_read_b64_tr_b16 v[138:139], v12 offset:14080
    v_mfma_f32_16x16x32_bf16 v[220:223], v[60:63], v[92:95], v[220:223]
    ds_read_b64_tr_b16 v[140:141], v13 offset:12544
    v_mfma_f32_16x16x32_bf16 v[224:227], v[64:67], v[92:95], v[224:227]
    ds_read_b64_tr_b16 v[142:143], v13 offset:14080
    v_mfma_f32_16x16x32_bf16 v[228:231], v[68:71], v[92:95], v[228:231]
    ds_read_b64_tr_b16 v[120:121], v12 offset:12288
    v_mfma_f32_16x16x32_bf16 v[232:235], v[72:75], v[92:95], v[232:235]
    ds_read_b64_tr_b16 v[122:123], v12 offset:13824
    v_mfma_f32_16x16x32_bf16 v[236:239], v[56:59], v[96:99], v[236:239]
    ds_read_b64_tr_b16 v[124:125], v13 offset:12288
    v_mfma_f32_16x16x32_bf16 v[240:243], v[60:63], v[96:99], v[240:243]
    ds_read_b64_tr_b16 v[126:127], v13 offset:13824
    v_mfma_f32_16x16x32_bf16 v[244:247], v[64:67], v[96:99], v[244:247]
    v_mfma_f32_16x16x32_bf16 v[248:251], v[68:71], v[96:99], v[248:251]
    v_mfma_f32_16x16x32_bf16 v[252:255], v[72:75], v[96:99], v[252:255]
    v_mfma_f32_16x16x32_bf16 v[144:147], v[76:79], v[60:63], v[144:147]
    v_mfma_f32_16x16x32_bf16 v[148:151], v[76:79], v[64:67], v[148:151]
    v_mfma_f32_16x16x32_bf16 v[152:155], v[76:79], v[68:71], v[152:155]
    v_mfma_f32_16x16x32_bf16 v[156:159], v[76:79], v[72:75], v[156:159]
    v_mfma_f32_16x16x32_bf16 v[160:163], v[80:83], v[60:63], v[160:163]
    v_mfma_f32_16x16x32_bf16 v[164:167], v[80:83], v[64:67], v[164:167]
    v_mfma_f32_16x16x32_bf16 v[168:171], v[80:83], v[68:71], v[168:171]
    v_mfma_f32_16x16x32_bf16 v[172:175], v[80:83], v[72:75], v[172:175]
    s_waitcnt lgkmcnt(0)
    v_mfma_f32_16x16x32_bf16 v[176:179], v[128:131], v[100:103], v[176:179]
    s_waitcnt vmcnt(0)
    s_barrier
    v_mfma_f32_16x16x32_bf16 v[180:183], v[128:131], v[104:107], v[180:183]
    ds_read_b128 v[56:59], v14 offset:0
    v_mfma_f32_16x16x32_bf16 v[184:187], v[128:131], v[108:111], v[184:187]
    ds_read_b64_tr_b16 v[84:85], v16 offset:128
    v_mfma_f32_16x16x32_bf16 v[188:191], v[128:131], v[112:115], v[188:191]
    ds_read_b64_tr_b16 v[86:87], v16 offset:1664
    v_mfma_f32_16x16x32_bf16 v[192:195], v[128:131], v[116:119], v[192:195]
    ds_read_b128 v[60:63], v14 offset:2048
    v_mfma_f32_16x16x32_bf16 v[196:199], v[132:135], v[100:103], v[196:199]
    ds_read_b128 v[64:67], v14 offset:4096
    v_mfma_f32_16x16x32_bf16 v[200:203], v[132:135], v[104:107], v[200:203]
    ds_read_b128 v[68:71], v14 offset:6144
    v_mfma_f32_16x16x32_bf16 v[204:207], v[132:135], v[108:111], v[204:207]
    ds_read_b128 v[72:75], v14 offset:8192
    v_mfma_f32_16x16x32_bf16 v[208:211], v[132:135], v[112:115], v[208:211]
    ds_read_b64_tr_b16 v[88:89], v17 offset:128
    v_mfma_f32_16x16x32_bf16 v[212:215], v[132:135], v[116:119], v[212:215]
    ds_read_b64_tr_b16 v[90:91], v17 offset:1664
    v_mfma_f32_16x16x32_bf16 v[216:219], v[100:103], v[136:139], v[216:219]
    ds_read_b64_tr_b16 v[92:93], v16 offset:256
    v_mfma_f32_16x16x32_bf16 v[220:223], v[104:107], v[136:139], v[220:223]
    ds_read_b64_tr_b16 v[94:95], v16 offset:1792
    v_mfma_f32_16x16x32_bf16 v[224:227], v[108:111], v[136:139], v[224:227]
    ds_read_b64_tr_b16 v[96:97], v17 offset:256
    v_mfma_f32_16x16x32_bf16 v[228:231], v[112:115], v[136:139], v[228:231]
    ds_read_b64_tr_b16 v[98:99], v17 offset:1792
    v_mfma_f32_16x16x32_bf16 v[232:235], v[116:119], v[136:139], v[232:235]
    ds_read_b64_tr_b16 v[76:77], v16 offset:0
    v_mfma_f32_16x16x32_bf16 v[236:239], v[100:103], v[140:143], v[236:239]
    ds_read_b64_tr_b16 v[78:79], v16 offset:1536
    v_mfma_f32_16x16x32_bf16 v[240:243], v[104:107], v[140:143], v[240:243]
    ds_read_b64_tr_b16 v[80:81], v17 offset:0
    v_mfma_f32_16x16x32_bf16 v[244:247], v[108:111], v[140:143], v[244:247]
    ds_read_b64_tr_b16 v[82:83], v17 offset:1536
    v_mfma_f32_16x16x32_bf16 v[248:251], v[112:115], v[140:143], v[248:251]
    v_mfma_f32_16x16x32_bf16 v[252:255], v[116:119], v[140:143], v[252:255]
    v_mfma_f32_16x16x32_bf16 v[144:147], v[120:123], v[104:107], v[144:147]
    v_mfma_f32_16x16x32_bf16 v[148:151], v[120:123], v[108:111], v[148:151]
    v_mfma_f32_16x16x32_bf16 v[152:155], v[120:123], v[112:115], v[152:155]
    v_mfma_f32_16x16x32_bf16 v[156:159], v[120:123], v[116:119], v[156:159]
    v_mfma_f32_16x16x32_bf16 v[160:163], v[124:127], v[104:107], v[160:163]
    v_mfma_f32_16x16x32_bf16 v[164:167], v[124:127], v[108:111], v[164:167]
    v_mfma_f32_16x16x32_bf16 v[168:171], v[124:127], v[112:115], v[168:171]
    v_mfma_f32_16x16x32_bf16 v[172:175], v[124:127], v[116:119], v[172:175]
    s_waitcnt lgkmcnt(0)
    v_mfma_f32_16x16x32_bf16 v[176:179], v[84:87], v[56:59], v[176:179]
    ds_read_b128 v[100:103], v15 offset:0
    v_mfma_f32_16x16x32_bf16 v[180:183], v[84:87], v[60:63], v[180:183]
    ds_read_b64_tr_b16 v[128:129], v16 offset:12416
    v_mfma_f32_16x16x32_bf16 v[184:187], v[84:87], v[64:67], v[184:187]
    ds_read_b64_tr_b16 v[130:131], v16 offset:13952
    v_mfma_f32_16x16x32_bf16 v[188:191], v[84:87], v[68:71], v[188:191]
    ds_read_b128 v[104:107], v15 offset:2048
    v_mfma_f32_16x16x32_bf16 v[192:195], v[84:87], v[72:75], v[192:195]
    ds_read_b128 v[108:111], v15 offset:4096
    v_mfma_f32_16x16x32_bf16 v[196:199], v[88:91], v[56:59], v[196:199]
    ds_read_b128 v[112:115], v15 offset:6144
    v_mfma_f32_16x16x32_bf16 v[200:203], v[88:91], v[60:63], v[200:203]
    ds_read_b128 v[116:119], v15 offset:8192
    v_mfma_f32_16x16x32_bf16 v[204:207], v[88:91], v[64:67], v[204:207]
    ds_read_b64_tr_b16 v[132:133], v17 offset:12416
    v_mfma_f32_16x16x32_bf16 v[208:211], v[88:91], v[68:71], v[208:211]
    ds_read_b64_tr_b16 v[134:135], v17 offset:13952
    v_mfma_f32_16x16x32_bf16 v[212:215], v[88:91], v[72:75], v[212:215]
    ds_read_b64_tr_b16 v[136:137], v16 offset:12544
    v_mfma_f32_16x16x32_bf16 v[216:219], v[56:59], v[92:95], v[216:219]
    ds_read_b64_tr_b16 v[138:139], v16 offset:14080
    v_mfma_f32_16x16x32_bf16 v[220:223], v[60:63], v[92:95], v[220:223]
    ds_read_b64_tr_b16 v[140:141], v17 offset:12544
    v_mfma_f32_16x16x32_bf16 v[224:227], v[64:67], v[92:95], v[224:227]
    ds_read_b64_tr_b16 v[142:143], v17 offset:14080
    v_mfma_f32_16x16x32_bf16 v[228:231], v[68:71], v[92:95], v[228:231]
    ds_read_b64_tr_b16 v[120:121], v16 offset:12288
    v_mfma_f32_16x16x32_bf16 v[232:235], v[72:75], v[92:95], v[232:235]
    ds_read_b64_tr_b16 v[122:123], v16 offset:13824
    v_mfma_f32_16x16x32_bf16 v[236:239], v[56:59], v[96:99], v[236:239]
    ds_read_b64_tr_b16 v[124:125], v17 offset:12288
    v_mfma_f32_16x16x32_bf16 v[240:243], v[60:63], v[96:99], v[240:243]
    ds_read_b64_tr_b16 v[126:127], v17 offset:13824
    v_mfma_f32_16x16x32_bf16 v[244:247], v[64:67], v[96:99], v[244:247]
    v_mfma_f32_16x16x32_bf16 v[248:251], v[68:71], v[96:99], v[248:251]
    v_mfma_f32_16x16x32_bf16 v[252:255], v[72:75], v[96:99], v[252:255]
    v_mfma_f32_16x16x32_bf16 v[144:147], v[76:79], v[60:63], v[144:147]
    v_mfma_f32_16x16x32_bf16 v[148:151], v[76:79], v[64:67], v[148:151]
    v_mfma_f32_16x16x32_bf16 v[152:155], v[76:79], v[68:71], v[152:155]
    v_mfma_f32_16x16x32_bf16 v[156:159], v[76:79], v[72:75], v[156:159]
    v_mfma_f32_16x16x32_bf16 v[160:163], v[80:83], v[60:63], v[160:163]
    v_mfma_f32_16x16x32_bf16 v[164:167], v[80:83], v[64:67], v[164:167]
    v_mfma_f32_16x16x32_bf16 v[168:171], v[80:83], v[68:71], v[168:171]
    v_mfma_f32_16x16x32_bf16 v[172:175], v[80:83], v[72:75], v[172:175]
    s_waitcnt lgkmcnt(0)
    v_mfma_f32_16x16x32_bf16 v[176:179], v[128:131], v[100:103], v[176:179]
    s_barrier
    v_mfma_f32_16x16x32_bf16 v[180:183], v[128:131], v[104:107], v[180:183]
    ds_read_b128 v[56:59], v6 offset:0
    v_mfma_f32_16x16x32_bf16 v[184:187], v[128:131], v[108:111], v[184:187]
    ds_read_b64_tr_b16 v[84:85], v8 offset:128
    v_mfma_f32_16x16x32_bf16 v[188:191], v[128:131], v[112:115], v[188:191]
    ds_read_b64_tr_b16 v[86:87], v8 offset:1664
    v_mfma_f32_16x16x32_bf16 v[192:195], v[128:131], v[116:119], v[192:195]
    ds_read_b128 v[60:63], v6 offset:2048
    v_mfma_f32_16x16x32_bf16 v[196:199], v[132:135], v[100:103], v[196:199]
    ds_read_b128 v[64:67], v6 offset:4096
    v_mfma_f32_16x16x32_bf16 v[200:203], v[132:135], v[104:107], v[200:203]
    ds_read_b128 v[68:71], v6 offset:6144
    v_mfma_f32_16x16x32_bf16 v[204:207], v[132:135], v[108:111], v[204:207]
    ds_read_b128 v[72:75], v6 offset:8192
    v_mfma_f32_16x16x32_bf16 v[208:211], v[132:135], v[112:115], v[208:211]
    ds_read_b64_tr_b16 v[88:89], v9 offset:128
    v_mfma_f32_16x16x32_bf16 v[212:215], v[132:135], v[116:119], v[212:215]
    ds_read_b64_tr_b16 v[90:91], v9 offset:1664
    v_mfma_f32_16x16x32_bf16 v[216:219], v[100:103], v[136:139], v[216:219]
    ds_read_b64_tr_b16 v[92:93], v8 offset:256
    v_mfma_f32_16x16x32_bf16 v[220:223], v[104:107], v[136:139], v[220:223]
    ds_read_b64_tr_b16 v[94:95], v8 offset:1792
    v_mfma_f32_16x16x32_bf16 v[224:227], v[108:111], v[136:139], v[224:227]
    ds_read_b64_tr_b16 v[96:97], v9 offset:256
    v_mfma_f32_16x16x32_bf16 v[228:231], v[112:115], v[136:139], v[228:231]
    ds_read_b64_tr_b16 v[98:99], v9 offset:1792
    v_mfma_f32_16x16x32_bf16 v[232:235], v[116:119], v[136:139], v[232:235]
    ds_read_b64_tr_b16 v[76:77], v8 offset:0
    v_mfma_f32_16x16x32_bf16 v[236:239], v[100:103], v[140:143], v[236:239]
    ds_read_b64_tr_b16 v[78:79], v8 offset:1536
    v_mfma_f32_16x16x32_bf16 v[240:243], v[104:107], v[140:143], v[240:243]
    ds_read_b64_tr_b16 v[80:81], v9 offset:0
    v_mfma_f32_16x16x32_bf16 v[244:247], v[108:111], v[140:143], v[244:247]
    ds_read_b64_tr_b16 v[82:83], v9 offset:1536
    v_mfma_f32_16x16x32_bf16 v[248:251], v[112:115], v[140:143], v[248:251]
    v_mfma_f32_16x16x32_bf16 v[252:255], v[116:119], v[140:143], v[252:255]
    v_mfma_f32_16x16x32_bf16 v[144:147], v[120:123], v[104:107], v[144:147]
    v_mfma_f32_16x16x32_bf16 v[148:151], v[120:123], v[108:111], v[148:151]
    v_mfma_f32_16x16x32_bf16 v[152:155], v[120:123], v[112:115], v[152:155]
    v_mfma_f32_16x16x32_bf16 v[156:159], v[120:123], v[116:119], v[156:159]
    v_mfma_f32_16x16x32_bf16 v[160:163], v[124:127], v[104:107], v[160:163]
    v_mfma_f32_16x16x32_bf16 v[164:167], v[124:127], v[108:111], v[164:167]
    v_mfma_f32_16x16x32_bf16 v[168:171], v[124:127], v[112:115], v[168:171]
    v_mfma_f32_16x16x32_bf16 v[172:175], v[124:127], v[116:119], v[172:175]
    s_waitcnt lgkmcnt(0)
    v_mfma_f32_16x16x32_bf16 v[176:179], v[84:87], v[56:59], v[176:179]
    ds_read_b128 v[100:103], v7 offset:0
    v_mfma_f32_16x16x32_bf16 v[180:183], v[84:87], v[60:63], v[180:183]
    ds_read_b64_tr_b16 v[128:129], v8 offset:12416
    v_mfma_f32_16x16x32_bf16 v[184:187], v[84:87], v[64:67], v[184:187]
    ds_read_b64_tr_b16 v[130:131], v8 offset:13952
    v_mfma_f32_16x16x32_bf16 v[188:191], v[84:87], v[68:71], v[188:191]
    ds_read_b128 v[104:107], v7 offset:2048
    v_mfma_f32_16x16x32_bf16 v[192:195], v[84:87], v[72:75], v[192:195]
    ds_read_b128 v[108:111], v7 offset:4096
    v_mfma_f32_16x16x32_bf16 v[196:199], v[88:91], v[56:59], v[196:199]
    ds_read_b128 v[112:115], v7 offset:6144
    v_mfma_f32_16x16x32_bf16 v[200:203], v[88:91], v[60:63], v[200:203]
    ds_read_b128 v[116:119], v7 offset:8192
    v_mfma_f32_16x16x32_bf16 v[204:207], v[88:91], v[64:67], v[204:207]
    ds_read_b64_tr_b16 v[132:133], v9 offset:12416
    v_mfma_f32_16x16x32_bf16 v[208:211], v[88:91], v[68:71], v[208:211]
    ds_read_b64_tr_b16 v[134:135], v9 offset:13952
    v_mfma_f32_16x16x32_bf16 v[212:215], v[88:91], v[72:75], v[212:215]
    ds_read_b64_tr_b16 v[136:137], v8 offset:12544
    v_mfma_f32_16x16x32_bf16 v[216:219], v[56:59], v[92:95], v[216:219]
    ds_read_b64_tr_b16 v[138:139], v8 offset:14080
    v_mfma_f32_16x16x32_bf16 v[220:223], v[60:63], v[92:95], v[220:223]
    ds_read_b64_tr_b16 v[140:141], v9 offset:12544
    v_mfma_f32_16x16x32_bf16 v[224:227], v[64:67], v[92:95], v[224:227]
    ds_read_b64_tr_b16 v[142:143], v9 offset:14080
    v_mfma_f32_16x16x32_bf16 v[228:231], v[68:71], v[92:95], v[228:231]
    ds_read_b64_tr_b16 v[120:121], v8 offset:12288
    v_mfma_f32_16x16x32_bf16 v[232:235], v[72:75], v[92:95], v[232:235]
    ds_read_b64_tr_b16 v[122:123], v8 offset:13824
    v_mfma_f32_16x16x32_bf16 v[236:239], v[56:59], v[96:99], v[236:239]
    ds_read_b64_tr_b16 v[124:125], v9 offset:12288
    v_mfma_f32_16x16x32_bf16 v[240:243], v[60:63], v[96:99], v[240:243]
    ds_read_b64_tr_b16 v[126:127], v9 offset:13824
    v_mfma_f32_16x16x32_bf16 v[244:247], v[64:67], v[96:99], v[244:247]
    v_mfma_f32_16x16x32_bf16 v[248:251], v[68:71], v[96:99], v[248:251]
    v_mfma_f32_16x16x32_bf16 v[252:255], v[72:75], v[96:99], v[252:255]
    v_mfma_f32_16x16x32_bf16 v[144:147], v[76:79], v[60:63], v[144:147]
    v_mfma_f32_16x16x32_bf16 v[148:151], v[76:79], v[64:67], v[148:151]
    v_mfma_f32_16x16x32_bf16 v[152:155], v[76:79], v[68:71], v[152:155]
    v_mfma_f32_16x16x32_bf16 v[156:159], v[76:79], v[72:75], v[156:159]
    v_mfma_f32_16x16x32_bf16 v[160:163], v[80:83], v[60:63], v[160:163]
    v_mfma_f32_16x16x32_bf16 v[164:167], v[80:83], v[64:67], v[164:167]
    v_mfma_f32_16x16x32_bf16 v[168:171], v[80:83], v[68:71], v[168:171]
    v_mfma_f32_16x16x32_bf16 v[172:175], v[80:83], v[72:75], v[172:175]
    s_waitcnt lgkmcnt(0)
    v_mfma_f32_16x16x32_bf16 v[176:179], v[128:131], v[100:103], v[176:179]
    s_barrier
    v_mfma_f32_16x16x32_bf16 v[180:183], v[128:131], v[104:107], v[180:183]
    ds_read_b128 v[56:59], v10 offset:0
    v_mfma_f32_16x16x32_bf16 v[184:187], v[128:131], v[108:111], v[184:187]
    ds_read_b64_tr_b16 v[84:85], v12 offset:128
    v_mfma_f32_16x16x32_bf16 v[188:191], v[128:131], v[112:115], v[188:191]
    ds_read_b64_tr_b16 v[86:87], v12 offset:1664
    v_mfma_f32_16x16x32_bf16 v[192:195], v[128:131], v[116:119], v[192:195]
    ds_read_b128 v[60:63], v10 offset:2048
    v_mfma_f32_16x16x32_bf16 v[196:199], v[132:135], v[100:103], v[196:199]
    ds_read_b128 v[64:67], v10 offset:4096
    v_mfma_f32_16x16x32_bf16 v[200:203], v[132:135], v[104:107], v[200:203]
    ds_read_b128 v[68:71], v10 offset:6144
    v_mfma_f32_16x16x32_bf16 v[204:207], v[132:135], v[108:111], v[204:207]
    ds_read_b128 v[72:75], v10 offset:8192
    v_mfma_f32_16x16x32_bf16 v[208:211], v[132:135], v[112:115], v[208:211]
    ds_read_b64_tr_b16 v[88:89], v13 offset:128
    v_mfma_f32_16x16x32_bf16 v[212:215], v[132:135], v[116:119], v[212:215]
    ds_read_b64_tr_b16 v[90:91], v13 offset:1664
    v_mfma_f32_16x16x32_bf16 v[216:219], v[100:103], v[136:139], v[216:219]
    ds_read_b64_tr_b16 v[92:93], v12 offset:256
    v_mfma_f32_16x16x32_bf16 v[220:223], v[104:107], v[136:139], v[220:223]
    ds_read_b64_tr_b16 v[94:95], v12 offset:1792
    v_mfma_f32_16x16x32_bf16 v[224:227], v[108:111], v[136:139], v[224:227]
    ds_read_b64_tr_b16 v[96:97], v13 offset:256
    v_mfma_f32_16x16x32_bf16 v[228:231], v[112:115], v[136:139], v[228:231]
    ds_read_b64_tr_b16 v[98:99], v13 offset:1792
    v_mfma_f32_16x16x32_bf16 v[232:235], v[116:119], v[136:139], v[232:235]
    ds_read_b64_tr_b16 v[76:77], v12 offset:0
    v_mfma_f32_16x16x32_bf16 v[236:239], v[100:103], v[140:143], v[236:239]
    ds_read_b64_tr_b16 v[78:79], v12 offset:1536
    v_mfma_f32_16x16x32_bf16 v[240:243], v[104:107], v[140:143], v[240:243]
    ds_read_b64_tr_b16 v[80:81], v13 offset:0
    v_mfma_f32_16x16x32_bf16 v[244:247], v[108:111], v[140:143], v[244:247]
    ds_read_b64_tr_b16 v[82:83], v13 offset:1536
    v_mfma_f32_16x16x32_bf16 v[248:251], v[112:115], v[140:143], v[248:251]
    v_mfma_f32_16x16x32_bf16 v[252:255], v[116:119], v[140:143], v[252:255]
    v_mfma_f32_16x16x32_bf16 v[144:147], v[120:123], v[104:107], v[144:147]
    v_mfma_f32_16x16x32_bf16 v[148:151], v[120:123], v[108:111], v[148:151]
    v_mfma_f32_16x16x32_bf16 v[152:155], v[120:123], v[112:115], v[152:155]
    v_mfma_f32_16x16x32_bf16 v[156:159], v[120:123], v[116:119], v[156:159]
    v_mfma_f32_16x16x32_bf16 v[160:163], v[124:127], v[104:107], v[160:163]
    v_mfma_f32_16x16x32_bf16 v[164:167], v[124:127], v[108:111], v[164:167]
    v_mfma_f32_16x16x32_bf16 v[168:171], v[124:127], v[112:115], v[168:171]
    v_mfma_f32_16x16x32_bf16 v[172:175], v[124:127], v[116:119], v[172:175]
    s_sub_u32 s61, s61, 1
    s_cmp_lg_u32 s61, 0
    s_cbranch_scc1 LP_69
    v_and_b32 v2, 15, v1
    v_lshlrev_b32 v5, 2, v2
    s_lshl_b32 s62, s55, 8
    s_add_u32 s62, s62, 88064
    v_add_u32 v5, s62, v5
    s_waitcnt lgkmcnt(0)
    v_mfma_f32_16x16x32_bf16 v[176:179], v[84:87], v[56:59], v[176:179]
    ds_read_b128 v[100:103], v11 offset:0
    ds_read_b32 v18, v5 offset:0
    v_mfma_f32_16x16x32_bf16 v[180:183], v[84:87], v[60:63], v[180:183]
    ds_read_b64_tr_b16 v[128:129], v12 offset:12416
    v_mfma_f32_16x16x32_bf16 v[184:187], v[84:87], v[64:67], v[184:187]
    ds_read_b64_tr_b16 v[130:131], v12 offset:13952
    v_mfma_f32_16x16x32_bf16 v[188:191], v[84:87], v[68:71], v[188:191]
    ds_read_b128 v[104:107], v11 offset:2048
    v_mfma_f32_16x16x32_bf16 v[192:195], v[84:87], v[72:75], v[192:195]
    ds_read_b128 v[108:111], v11 offset:4096
    v_mfma_f32_16x16x32_bf16 v[196:199], v[88:91], v[56:59], v[196:199]
    ds_read_b128 v[112:115], v11 offset:6144
    v_mfma_f32_16x16x32_bf16 v[200:203], v[88:91], v[60:63], v[200:203]
    ds_read_b128 v[116:119], v11 offset:8192
    v_mfma_f32_16x16x32_bf16 v[204:207], v[88:91], v[64:67], v[204:207]
    ds_read_b64_tr_b16 v[132:133], v13 offset:12416
    ds_read_b32 v19, v5 offset:64
    v_mfma_f32_16x16x32_bf16 v[208:211], v[88:91], v[68:71], v[208:211]
    ds_read_b64_tr_b16 v[134:135], v13 offset:13952
    v_mfma_f32_16x16x32_bf16 v[212:215], v[88:91], v[72:75], v[212:215]
    ds_read_b64_tr_b16 v[136:137], v12 offset:12544
    v_mfma_f32_16x16x32_bf16 v[216:219], v[56:59], v[92:95], v[216:219]
    ds_read_b64_tr_b16 v[138:139], v12 offset:14080
    v_mfma_f32_16x16x32_bf16 v[220:223], v[60:63], v[92:95], v[220:223]
    ds_read_b64_tr_b16 v[140:141], v13 offset:12544
    v_mfma_f32_16x16x32_bf16 v[224:227], v[64:67], v[92:95], v[224:227]
    ds_read_b64_tr_b16 v[142:143], v13 offset:14080
    v_mfma_f32_16x16x32_bf16 v[228:231], v[68:71], v[92:95], v[228:231]
    ds_read_b64_tr_b16 v[120:121], v12 offset:12288
    v_mfma_f32_16x16x32_bf16 v[232:235], v[72:75], v[92:95], v[232:235]
    ds_read_b64_tr_b16 v[122:123], v12 offset:13824
    ds_read_b32 v20, v5 offset:128
    v_mfma_f32_16x16x32_bf16 v[236:239], v[56:59], v[96:99], v[236:239]
    ds_read_b64_tr_b16 v[124:125], v13 offset:12288
    v_mfma_f32_16x16x32_bf16 v[240:243], v[60:63], v[96:99], v[240:243]
    ds_read_b64_tr_b16 v[126:127], v13 offset:13824
    v_mfma_f32_16x16x32_bf16 v[244:247], v[64:67], v[96:99], v[244:247]
    v_mfma_f32_16x16x32_bf16 v[248:251], v[68:71], v[96:99], v[248:251]
    v_mfma_f32_16x16x32_bf16 v[252:255], v[72:75], v[96:99], v[252:255]
    v_mfma_f32_16x16x32_bf16 v[144:147], v[76:79], v[60:63], v[144:147]
    v_mfma_f32_16x16x32_bf16 v[148:151], v[76:79], v[64:67], v[148:151]
    ds_read_b32 v21, v5 offset:192
    v_mfma_f32_16x16x32_bf16 v[152:155], v[76:79], v[68:71], v[152:155]
    v_mfma_f32_16x16x32_bf16 v[156:159], v[76:79], v[72:75], v[156:159]
    v_mfma_f32_16x16x32_bf16 v[160:163], v[80:83], v[60:63], v[160:163]
    v_mfma_f32_16x16x32_bf16 v[164:167], v[80:83], v[64:67], v[164:167]
    v_mfma_f32_16x16x32_bf16 v[168:171], v[80:83], v[68:71], v[168:171]
    v_mfma_f32_16x16x32_bf16 v[172:175], v[80:83], v[72:75], v[172:175]
    s_waitcnt lgkmcnt(0)
    v_mfma_f32_16x16x32_bf16 v[176:179], v[128:131], v[100:103], v[176:179]
    s_barrier
    v_mfma_f32_16x16x32_bf16 v[180:183], v[128:131], v[104:107], v[180:183]
    v_mfma_f32_16x16x32_bf16 v[184:187], v[128:131], v[108:111], v[184:187]
    v_mfma_f32_16x16x32_bf16 v[188:191], v[128:131], v[112:115], v[188:191]
    v_mfma_f32_16x16x32_bf16 v[192:195], v[128:131], v[116:119], v[192:195]
    v_mfma_f32_16x16x32_bf16 v[196:199], v[132:135], v[100:103], v[196:199]
    v_mfma_f32_16x16x32_bf16 v[200:203], v[132:135], v[104:107], v[200:203]
    v_mfma_f32_16x16x32_bf16 v[204:207], v[132:135], v[108:111], v[204:207]
    v_mfma_f32_16x16x32_bf16 v[208:211], v[132:135], v[112:115], v[208:211]
    v_mfma_f32_16x16x32_bf16 v[212:215], v[132:135], v[116:119], v[212:215]
    v_mfma_f32_16x16x32_bf16 v[216:219], v[100:103], v[136:139], v[216:219]
    v_mfma_f32_16x16x32_bf16 v[220:223], v[104:107], v[136:139], v[220:223]
    v_mfma_f32_16x16x32_bf16 v[224:227], v[108:111], v[136:139], v[224:227]
    v_mfma_f32_16x16x32_bf16 v[228:231], v[112:115], v[136:139], v[228:231]
    v_mfma_f32_16x16x32_bf16 v[232:235], v[116:119], v[136:139], v[232:235]
    v_mfma_f32_16x16x32_bf16 v[236:239], v[100:103], v[140:143], v[236:239]
    v_mfma_f32_16x16x32_bf16 v[240:243], v[104:107], v[140:143], v[240:243]
    v_mfma_f32_16x16x32_bf16 v[244:247], v[108:111], v[140:143], v[244:247]
    v_mfma_f32_16x16x32_bf16 v[248:251], v[112:115], v[140:143], v[248:251]
    v_mfma_f32_16x16x32_bf16 v[252:255], v[116:119], v[140:143], v[252:255]
    v_mfma_f32_16x16x32_bf16 v[144:147], v[120:123], v[104:107], v[144:147]
    v_mfma_f32_16x16x32_bf16 v[148:151], v[120:123], v[108:111], v[148:151]
    v_mfma_f32_16x16x32_bf16 v[152:155], v[120:123], v[112:115], v[152:155]
    v_mfma_f32_16x16x32_bf16 v[156:159], v[120:123], v[116:119], v[156:159]
    v_mfma_f32_16x16x32_bf16 v[160:163], v[124:127], v[104:107], v[160:163]
    v_mfma_f32_16x16x32_bf16 v[164:167], v[124:127], v[108:111], v[164:167]
    v_mfma_f32_16x16x32_bf16 v[168:171], v[124:127], v[112:115], v[168:171]
    v_mfma_f32_16x16x32_bf16 v[172:175], v[124:127], v[116:119], v[172:175]
    v_and_b32 v2, 15, v1
    s_nop 7
    v_cvt_pk_bf16_f32 v56, v144, v145
    v_cvt_pk_bf16_f32 v57, v146, v147
    v_cvt_pk_bf16_f32 v58, v160, v161
    v_cvt_pk_bf16_f32 v59, v162, v163
    v_cvt_pk_bf16_f32 v60, v148, v149
    v_cvt_pk_bf16_f32 v61, v150, v151
    v_cvt_pk_bf16_f32 v62, v164, v165
    v_cvt_pk_bf16_f32 v63, v166, v167
    v_cvt_pk_bf16_f32 v64, v152, v153
    v_cvt_pk_bf16_f32 v65, v154, v155
    v_cvt_pk_bf16_f32 v66, v168, v169
    v_cvt_pk_bf16_f32 v67, v170, v171
    v_cvt_pk_bf16_f32 v68, v156, v157
    v_cvt_pk_bf16_f32 v69, v158, v159
    v_cvt_pk_bf16_f32 v70, v172, v173
    v_cvt_pk_bf16_f32 v71, v174, v175
    v_cvt_pk_bf16_f32 v72, v176, v177
    v_cvt_pk_bf16_f32 v73, v178, v179
    v_cvt_pk_bf16_f32 v74, v196, v197
    v_cvt_pk_bf16_f32 v75, v198, v199
    v_cvt_pk_bf16_f32 v76, v180, v181
    v_cvt_pk_bf16_f32 v77, v182, v183
    v_cvt_pk_bf16_f32 v78, v200, v201
    v_cvt_pk_bf16_f32 v79, v202, v203
    v_cvt_pk_bf16_f32 v80, v184, v185
    v_cvt_pk_bf16_f32 v81, v186, v187
    v_cvt_pk_bf16_f32 v82, v204, v205
    v_cvt_pk_bf16_f32 v83, v206, v207
    v_cvt_pk_bf16_f32 v84, v188, v189
    v_cvt_pk_bf16_f32 v85, v190, v191
    v_cvt_pk_bf16_f32 v86, v208, v209
    v_cvt_pk_bf16_f32 v87, v210, v211
    v_cvt_pk_bf16_f32 v88, v192, v193
    v_cvt_pk_bf16_f32 v89, v194, v195
    v_cvt_pk_bf16_f32 v90, v212, v213
    v_cvt_pk_bf16_f32 v91, v214, v215
    s_nop 1
    v_mfma_f32_16x16x32_bf16 v[112:115], v[72:75], v[56:59], 0
    v_mfma_f32_16x16x32_bf16 v[116:119], v[76:79], v[56:59], 0
    v_mfma_f32_16x16x32_bf16 v[120:123], v[76:79], v[60:63], 0
    v_mfma_f32_16x16x32_bf16 v[124:127], v[80:83], v[60:63], 0
    v_mfma_f32_16x16x32_bf16 v[128:131], v[80:83], v[64:67], 0
    v_mfma_f32_16x16x32_bf16 v[132:135], v[84:87], v[64:67], 0
    v_mfma_f32_16x16x32_bf16 v[136:139], v[84:87], v[68:71], 0
    v_mfma_f32_16x16x32_bf16 v[140:143], v[88:91], v[68:71], 0
    v_cvt_pk_bf16_f32 v92, v216, v217
    v_cvt_pk_bf16_f32 v93, v218, v219
    v_cvt_pk_bf16_f32 v94, v220, v221
    v_cvt_pk_bf16_f32 v95, v222, v223
    v_cvt_pk_bf16_f32 v96, v224, v225
    v_cvt_pk_bf16_f32 v97, v226, v227
    v_cvt_pk_bf16_f32 v98, v228, v229
    v_cvt_pk_bf16_f32 v99, v230, v231
    v_cvt_pk_bf16_f32 v100, v232, v233
    v_cvt_pk_bf16_f32 v101, v234, v235
    v_cvt_pk_bf16_f32 v102, v236, v237
    v_cvt_pk_bf16_f32 v103, v238, v239
    v_cvt_pk_bf16_f32 v104, v240, v241
    v_cvt_pk_bf16_f32 v105, v242, v243
    v_cvt_pk_bf16_f32 v106, v244, v245
    v_cvt_pk_bf16_f32 v107, v246, v247
    v_cvt_pk_bf16_f32 v108, v248, v249
    v_cvt_pk_bf16_f32 v109, v250, v251
    v_cvt_pk_bf16_f32 v110, v252, v253
    v_cvt_pk_bf16_f32 v111, v254, v255
    s_mov_b32 s62, 0x3e8293ee
    s_waitcnt lgkmcnt(0)
    v_sub_f32 v22, 1.0, v18
    v_sub_f32 v23, 1.0, v19
    v_sub_f32 v24, 1.0, v20
    v_sub_f32 v25, 1.0, v21
    v_cvt_pk_bf16_f32 v22, v22, v22
    v_cvt_pk_bf16_f32 v23, v23, v23
    v_cvt_pk_bf16_f32 v24, v24, v24
    v_cvt_pk_bf16_f32 v25, v25, v25
    v_lshlrev_b32 v22, 16, v22
    v_lshlrev_b32 v23, 16, v23
    v_lshlrev_b32 v24, 16, v24
    v_lshlrev_b32 v25, 16, v25
    v_fma_f32 v112, v112, s62, v36
    v_fma_f32 v113, v113, s62, v37
    v_fma_f32 v114, v114, s62, v38
    v_fma_f32 v115, v115, s62, v39
    v_fma_f32 v116, v116, s62, v32
    v_fma_f32 v117, v117, s62, v33
    v_fma_f32 v118, v118, s62, v34
    v_fma_f32 v119, v119, s62, v35
    v_fma_f32 v120, v120, s62, v28
    v_fma_f32 v121, v121, s62, v29
    v_fma_f32 v122, v122, s62, v30
    v_fma_f32 v123, v123, s62, v31
    v_fma_f32 v124, v124, s62, v32
    v_fma_f32 v125, v125, s62, v33
    v_fma_f32 v126, v126, s62, v34
    v_fma_f32 v127, v127, s62, v35
    v_fma_f32 v128, v128, s62, v28
    v_fma_f32 v129, v129, s62, v29
    v_fma_f32 v130, v130, s62, v30
    v_fma_f32 v131, v131, s62, v31
    v_fma_f32 v132, v132, s62, v32
    v_fma_f32 v133, v133, s62, v33
    v_fma_f32 v134, v134, s62, v34
    v_fma_f32 v135, v135, s62, v35
    v_fma_f32 v136, v136, s62, v28
    v_fma_f32 v137, v137, s62, v29
    v_fma_f32 v138, v138, s62, v30
    v_fma_f32 v139, v139, s62, v31
    v_fma_f32 v140, v140, s62, v32
    v_fma_f32 v141, v141, s62, v33
    v_fma_f32 v142, v142, s62, v34
    v_fma_f32 v143, v143, s62, v35
    v_max3_f32 v40, v112, v113, v114
    v_max3_f32 v40, v40, v115, v116
    v_max3_f32 v40, v40, v117, v118
    v_max_f32 v40, v40, v119
    v_max3_f32 v41, v120, v121, v122
    v_max3_f32 v41, v41, v123, v124
    v_max3_f32 v41, v41, v125, v126
    v_max_f32 v41, v41, v127
    v_max3_f32 v42, v128, v129, v130
    v_max3_f32 v42, v42, v131, v132
    v_max3_f32 v42, v42, v133, v134
    v_max_f32 v42, v42, v135
    v_max3_f32 v43, v136, v137, v138
    v_max3_f32 v43, v43, v139, v140
    v_max3_f32 v43, v43, v141, v142
    v_max_f32 v43, v43, v143
    v_mov_b32 v44, v40
    v_mov_b32 v45, v41
    v_mov_b32 v46, v42
    v_mov_b32 v47, v43
    s_nop 0
    v_permlane32_swap_b32 v40, v44
    v_permlane32_swap_b32 v41, v45
    v_permlane32_swap_b32 v42, v46
    v_permlane32_swap_b32 v43, v47
    s_nop 0
    v_max_f32 v40, v40, v44
    v_max_f32 v41, v41, v45
    v_max_f32 v42, v42, v46
    v_max_f32 v43, v43, v47
    v_mov_b32 v44, v40
    v_mov_b32 v45, v41
    v_mov_b32 v46, v42
    v_mov_b32 v47, v43
    s_nop 0
    v_permlane16_swap_b32 v40, v44
    v_permlane16_swap_b32 v41, v45
    v_permlane16_swap_b32 v42, v46
    v_permlane16_swap_b32 v43, v47
    s_nop 0
    v_max_f32 v40, v40, v44
    v_max_f32 v41, v41, v45
    v_max_f32 v42, v42, v46
    v_max_f32 v43, v43, v47
    v_sub_f32 v112, v112, v40
    v_sub_f32 v113, v113, v40
    v_sub_f32 v114, v114, v40
    v_sub_f32 v115, v115, v40
    v_sub_f32 v116, v116, v40
    v_sub_f32 v117, v117, v40
    v_sub_f32 v118, v118, v40
    v_sub_f32 v119, v119, v40
    v_sub_f32 v120, v120, v41
    v_sub_f32 v121, v121, v41
    v_sub_f32 v122, v122, v41
    v_sub_f32 v123, v123, v41
    v_sub_f32 v124, v124, v41
    v_sub_f32 v125, v125, v41
    v_sub_f32 v126, v126, v41
    v_sub_f32 v127, v127, v41
    v_sub_f32 v128, v128, v42
    v_sub_f32 v129, v129, v42
    v_sub_f32 v130, v130, v42
    v_sub_f32 v131, v131, v42
    v_sub_f32 v132, v132, v42
    v_sub_f32 v133, v133, v42
    v_sub_f32 v134, v134, v42
    v_sub_f32 v135, v135, v42
    v_sub_f32 v136, v136, v43
    v_sub_f32 v137, v137, v43
    v_sub_f32 v138, v138, v43
    v_sub_f32 v139, v139, v43
    v_sub_f32 v140, v140, v43
    v_sub_f32 v141, v141, v43
    v_sub_f32 v142, v142, v43
    v_sub_f32 v143, v143, v43
    v_exp_f32 v112, v112
    v_exp_f32 v113, v113
    v_exp_f32 v114, v114
    v_exp_f32 v115, v115
    v_exp_f32 v116, v116
    v_exp_f32 v117, v117
    v_exp_f32 v118, v118
    v_exp_f32 v119, v119
    v_exp_f32 v120, v120
    v_exp_f32 v121, v121
    v_exp_f32 v122, v122
    v_exp_f32 v123, v123
    v_exp_f32 v124, v124
    v_exp_f32 v125, v125
    v_exp_f32 v126, v126
    v_exp_f32 v127, v127
    v_exp_f32 v128, v128
    v_exp_f32 v129, v129
    v_exp_f32 v130, v130
    v_exp_f32 v131, v131
    v_exp_f32 v132, v132
    v_exp_f32 v133, v133
    v_exp_f32 v134, v134
    v_exp_f32 v135, v135
    v_exp_f32 v136, v136
    v_exp_f32 v137, v137
    v_exp_f32 v138, v138
    v_exp_f32 v139, v139
    v_exp_f32 v140, v140
    v_exp_f32 v141, v141
    v_exp_f32 v142, v142
    v_exp_f32 v143, v143
    s_nop 0
    v_add_f32 v40, v112, v113
    v_add_f32 v40, v40, v114
    v_add_f32 v40, v40, v115
    v_add_f32 v40, v40, v116
    v_add_f32 v40, v40, v117
    v_add_f32 v40, v40, v118
    v_add_f32 v40, v40, v119
    v_add_f32 v41, v120, v121
    v_add_f32 v41, v41, v122
    v_add_f32 v41, v41, v123
    v_add_f32 v41, v41, v124
    v_add_f32 v41, v41, v125
    v_add_f32 v41, v41, v126
    v_add_f32 v41, v41, v127
    v_add_f32 v42, v128, v129
    v_add_f32 v42, v42, v130
    v_add_f32 v42, v42, v131
    v_add_f32 v42, v42, v132
    v_add_f32 v42, v42, v133
    v_add_f32 v42, v42, v134
    v_add_f32 v42, v42, v135
    v_add_f32 v43, v136, v137
    v_add_f32 v43, v43, v138
    v_add_f32 v43, v43, v139
    v_add_f32 v43, v43, v140
    v_add_f32 v43, v43, v141
    v_add_f32 v43, v43, v142
    v_add_f32 v43, v43, v143
    v_mov_b32 v44, v40
    v_mov_b32 v45, v41
    v_mov_b32 v46, v42
    v_mov_b32 v47, v43
    s_nop 0
    v_permlane32_swap_b32 v40, v44
    v_permlane32_swap_b32 v41, v45
    v_permlane32_swap_b32 v42, v46
    v_permlane32_swap_b32 v43, v47
    s_nop 0
    v_add_f32 v40, v40, v44
    v_add_f32 v41, v41, v45
    v_add_f32 v42, v42, v46
    v_add_f32 v43, v43, v47
    v_mov_b32 v44, v40
    v_mov_b32 v45, v41
    v_mov_b32 v46, v42
    v_mov_b32 v47, v43
    s_nop 0
    v_permlane16_swap_b32 v40, v44
    v_permlane16_swap_b32 v41, v45
    v_permlane16_swap_b32 v42, v46
    v_permlane16_swap_b32 v43, v47
    s_nop 0
    v_add_f32 v40, v40, v44
    v_add_f32 v41, v41, v45
    v_add_f32 v42, v42, v46
    v_add_f32 v43, v43, v47
    v_rcp_f32 v40, v40
    v_rcp_f32 v41, v41
    v_rcp_f32 v42, v42
    v_rcp_f32 v43, v43
    s_nop 0
    v_mul_f32 v40, v40, v18
    v_mul_f32 v41, v41, v19
    v_mul_f32 v42, v42, v20
    v_mul_f32 v43, v43, v21
    v_mul_f32 v112, v112, v40
    v_mul_f32 v113, v113, v40
    v_mul_f32 v114, v114, v40
    v_mul_f32 v115, v115, v40
    v_mul_f32 v116, v116, v40
    v_mul_f32 v117, v117, v40
    v_mul_f32 v118, v118, v40
    v_mul_f32 v119, v119, v40
    v_mul_f32 v120, v120, v41
    v_mul_f32 v121, v121, v41
    v_mul_f32 v122, v122, v41
    v_mul_f32 v123, v123, v41
    v_mul_f32 v124, v124, v41
    v_mul_f32 v125, v125, v41
    v_mul_f32 v126, v126, v41
    v_mul_f32 v127, v127, v41
    v_mul_f32 v128, v128, v42
    v_mul_f32 v129, v129, v42
    v_mul_f32 v130, v130, v42
    v_mul_f32 v131, v131, v42
    v_mul_f32 v132, v132, v42
    v_mul_f32 v133, v133, v42
    v_mul_f32 v134, v134, v42
    v_mul_f32 v135, v135, v42
    v_mul_f32 v136, v136, v43
    v_mul_f32 v137, v137, v43
    v_mul_f32 v138, v138, v43
    v_mul_f32 v139, v139, v43
    v_mul_f32 v140, v140, v43
    v_mul_f32 v141, v141, v43
    v_mul_f32 v142, v142, v43
    v_mul_f32 v143, v143, v43
    v_cvt_pk_bf16_f32 v56, v112, v113
    v_cvt_pk_bf16_f32 v57, v114, v115
    v_cvt_pk_bf16_f32 v58, v116, v117
    v_cvt_pk_bf16_f32 v59, v118, v119
    v_cvt_pk_bf16_f32 v60, v120, v121
    v_cvt_pk_bf16_f32 v61, v122, v123
    v_cvt_pk_bf16_f32 v62, v124, v125
    v_cvt_pk_bf16_f32 v63, v126, v127
    v_cvt_pk_bf16_f32 v64, v128, v129
    v_cvt_pk_bf16_f32 v65, v130, v131
    v_cvt_pk_bf16_f32 v66, v132, v133
    v_cvt_pk_bf16_f32 v67, v134, v135
    v_cvt_pk_bf16_f32 v68, v136, v137
    v_cvt_pk_bf16_f32 v69, v138, v139
    v_cvt_pk_bf16_f32 v70, v140, v141
    v_cvt_pk_bf16_f32 v71, v142, v143
    s_nop 1
    v_mfma_f32_16x16x32_bf16 v[112:115], v[92:95], v[56:59], 0
    v_mfma_f32_16x16x32_bf16 v[116:119], v[102:105], v[56:59], 0
    v_mfma_f32_16x16x32_bf16 v[120:123], v[94:97], v[60:63], 0
    v_mfma_f32_16x16x32_bf16 v[124:127], v[104:107], v[60:63], 0
    v_mfma_f32_16x16x32_bf16 v[128:131], v[96:99], v[64:67], 0
    v_mfma_f32_16x16x32_bf16 v[132:135], v[106:109], v[64:67], 0
    v_mfma_f32_16x16x32_bf16 v[136:139], v[98:101], v[68:71], 0
    v_mfma_f32_16x16x32_bf16 v[140:143], v[108:111], v[68:71], 0
    v_lshlrev_b32 v26, 4, v1
    s_lshl_b32 s62, s55, 12
    v_add_u32 v26, s62, v26
    s_lshl_b32 s64, s53, 5
    s_lshl_b32 s62, s54, 1
    s_add_u32 s64, s64, s62
    s_add_u32 s64, s64, s56
    s_lshl_b32 s64, s64, 13
    s_add_u32 s64, s64, 0xe00000
    s_nop 3
    v_cvt_pk_bf16_f32 v72, v112, v113
    v_cvt_pk_bf16_f32 v73, v114, v115
    v_cvt_pk_bf16_f32 v74, v116, v117
    v_cvt_pk_bf16_f32 v75, v118, v119
    buffer_store_dwordx4 v[72:75], v26, s[28:31], s64 offen offset:0 sc1
    v_cvt_pk_bf16_f32 v76, v120, v121
    v_cvt_pk_bf16_f32 v77, v122, v123
    v_cvt_pk_bf16_f32 v78, v124, v125
    v_cvt_pk_bf16_f32 v79, v126, v127
    buffer_store_dwordx4 v[76:79], v26, s[28:31], s64 offen offset:1024 sc1
    v_cvt_pk_bf16_f32 v80, v128, v129
    v_cvt_pk_bf16_f32 v81, v130, v131
    v_cvt_pk_bf16_f32 v82, v132, v133
    v_cvt_pk_bf16_f32 v83, v134, v135
    buffer_store_dwordx4 v[80:83], v26, s[28:31], s64 offen offset:2048 sc1
    v_cvt_pk_bf16_f32 v84, v136, v137
    v_cvt_pk_bf16_f32 v85, v138, v139
    v_cvt_pk_bf16_f32 v86, v140, v141
    v_cvt_pk_bf16_f32 v87, v142, v143
    buffer_store_dwordx4 v[84:87], v26, s[28:31], s64 offen offset:3072 sc1
    v_lshlrev_b32 v4, 4, v1
    s_lshl_b32 s62, s55, 12
    v_add_u32 v6, s62, v4
    v_and_b32 v2, 15, v1
    v_lshrrev_b32 v3, 4, v1
    v_lshlrev_b32 v4, 2, v3
    v_lshrrev_b32 v5, 2, v2
    v_add_u32 v4, v4, v5
    v_and_b32 v5, 7, v4
    v_lshlrev_b32 v4, 8, v4
    v_and_b32 v2, 3, v2
    v_lshlrev_b32 v2, 3, v2
    v_add_u32 v4, v4, v2
    v_add_u32 v4, 16384, v4
    s_lshl_b32 s62, s56, 2
    s_add_u32 s62, s62, 0
    v_xor_b32 v2, s62, v5
    v_lshlrev_b32 v2, 5, v2
    v_add_u32 v7, v4, v2
    s_lshl_b32 s62, s56, 2
    s_add_u32 s62, s62, 1
    v_xor_b32 v2, s62, v5
    v_lshlrev_b32 v2, 5, v2
    v_add_u32 v8, v4, v2
    s_lshl_b32 s62, s56, 2
    s_add_u32 s62, s62, 2
    v_xor_b32 v2, s62, v5
    v_lshlrev_b32 v2, 5, v2
    v_add_u32 v9, v4, v2
    s_lshl_b32 s62, s56, 2
    s_add_u32 s62, s62, 3
    v_xor_b32 v2, s62, v5
    v_lshlrev_b32 v2, 5, v2
    v_add_u32 v10, v4, v2
    s_cmp_eq_u32 s57, 0
    s_cbranch_scc0 KB_70
    v_add_u32 v11, 65536, v6
    v_add_u32 v12, 65536, v7
    v_add_u32 v13, 65536, v8
    v_add_u32 v14, 65536, v9
    v_add_u32 v15, 65536, v10
    v_add_u32 v248, 131072, v6
    v_add_u32 v249, 131072, v7
    v_add_u32 v250, 131072, v8
    v_add_u32 v251, 131072, v9
    v_add_u32 v252, 131072, v10
    ds_read_b128 v[56:59], v11 offset:32768
    ds_read_b64_tr_b16 v[72:73], v12 offset:32768
    ds_read_b64_tr_b16 v[74:75], v12 offset:36864
    ds_read_b128 v[60:63], v11 offset:33792
    ds_read_b128 v[64:67], v11 offset:34816
    ds_read_b128 v[68:71], v11 offset:35840
    ds_read_b64_tr_b16 v[76:77], v13 offset:32768
    ds_read_b64_tr_b16 v[78:79], v13 offset:36864
    ds_read_b64_tr_b16 v[80:81], v14 offset:32768
    ds_read_b64_tr_b16 v[82:83], v14 offset:36864
    ds_read_b64_tr_b16 v[84:85], v15 offset:32768
    ds_read_b64_tr_b16 v[86:87], v15 offset:36864
    s_waitcnt lgkmcnt(0)
    v_mfma_f32_16x16x32_bf16 v[120:123], v[72:75], v[56:59], 0
    ds_read_b64_tr_b16 v[104:105], v12 offset:40960
    ds_read_b64_tr_b16 v[106:107], v12 offset:45056
    v_mfma_f32_16x16x32_bf16 v[124:127], v[72:75], v[60:63], 0
    ds_read_b128 v[88:91], v11 offset:40960
    v_mfma_f32_16x16x32_bf16 v[128:131], v[72:75], v[64:67], 0
    ds_read_b128 v[92:95], v11 offset:41984
    v_mfma_f32_16x16x32_bf16 v[132:135], v[72:75], v[68:71], 0
    ds_read_b128 v[96:99], v11 offset:43008
    ds_read_b128 v[100:103], v11 offset:44032
    v_mfma_f32_16x16x32_bf16 v[136:139], v[76:79], v[56:59], 0
    ds_read_b64_tr_b16 v[108:109], v13 offset:40960
    v_mfma_f32_16x16x32_bf16 v[140:143], v[76:79], v[60:63], 0
    ds_read_b64_tr_b16 v[110:111], v13 offset:45056
    v_mfma_f32_16x16x32_bf16 v[144:147], v[76:79], v[64:67], 0
    ds_read_b64_tr_b16 v[112:113], v14 offset:40960
    ds_read_b64_tr_b16 v[114:115], v14 offset:45056
    v_mfma_f32_16x16x32_bf16 v[148:151], v[76:79], v[68:71], 0
    ds_read_b64_tr_b16 v[116:117], v15 offset:40960
    v_mfma_f32_16x16x32_bf16 v[152:155], v[80:83], v[56:59], 0
    ds_read_b64_tr_b16 v[118:119], v15 offset:45056
    v_mfma_f32_16x16x32_bf16 v[156:159], v[80:83], v[60:63], 0
    v_mfma_f32_16x16x32_bf16 v[160:163], v[80:83], v[64:67], 0
    v_mfma_f32_16x16x32_bf16 v[164:167], v[80:83], v[68:71], 0
    v_mfma_f32_16x16x32_bf16 v[168:171], v[84:87], v[56:59], 0
    v_mfma_f32_16x16x32_bf16 v[172:175], v[84:87], v[60:63], 0
    v_mfma_f32_16x16x32_bf16 v[176:179], v[84:87], v[64:67], 0
    v_mfma_f32_16x16x32_bf16 v[180:183], v[84:87], v[68:71], 0
    s_waitcnt lgkmcnt(0)
    v_mfma_f32_16x16x32_bf16 v[120:123], v[104:107], v[88:91], v[120:123]
    s_barrier
    v_mfma_f32_16x16x32_bf16 v[124:127], v[104:107], v[92:95], v[124:127]
    ds_read_b128 v[56:59], v248 offset:0
    v_mfma_f32_16x16x32_bf16 v[128:131], v[104:107], v[96:99], v[128:131]
    ds_read_b64_tr_b16 v[72:73], v249 offset:0
    v_mfma_f32_16x16x32_bf16 v[132:135], v[104:107], v[100:103], v[132:135]
    ds_read_b64_tr_b16 v[74:75], v249 offset:4096
    v_mfma_f32_16x16x32_bf16 v[136:139], v[108:111], v[88:91], v[136:139]
    ds_read_b128 v[60:63], v248 offset:1024
    v_mfma_f32_16x16x32_bf16 v[140:143], v[108:111], v[92:95], v[140:143]
    ds_read_b128 v[64:67], v248 offset:2048
    v_mfma_f32_16x16x32_bf16 v[144:147], v[108:111], v[96:99], v[144:147]
    ds_read_b128 v[68:71], v248 offset:3072
    v_mfma_f32_16x16x32_bf16 v[148:151], v[108:111], v[100:103], v[148:151]
    ds_read_b64_tr_b16 v[76:77], v250 offset:0
    v_mfma_f32_16x16x32_bf16 v[152:155], v[112:115], v[88:91], v[152:155]
    ds_read_b64_tr_b16 v[78:79], v250 offset:4096
    v_mfma_f32_16x16x32_bf16 v[156:159], v[112:115], v[92:95], v[156:159]
    ds_read_b64_tr_b16 v[80:81], v251 offset:0
    v_mfma_f32_16x16x32_bf16 v[160:163], v[112:115], v[96:99], v[160:163]
    ds_read_b64_tr_b16 v[82:83], v251 offset:4096
    v_mfma_f32_16x16x32_bf16 v[164:167], v[112:115], v[100:103], v[164:167]
    ds_read_b64_tr_b16 v[84:85], v252 offset:0
    v_mfma_f32_16x16x32_bf16 v[168:171], v[116:119], v[88:91], v[168:171]
    ds_read_b64_tr_b16 v[86:87], v252 offset:4096
    v_mfma_f32_16x16x32_bf16 v[172:175], v[116:119], v[92:95], v[172:175]
    ds_read_b64_tr_b16 v[104:105], v249 offset:8192
    v_mfma_f32_16x16x32_bf16 v[176:179], v[116:119], v[96:99], v[176:179]
    ds_read_b64_tr_b16 v[106:107], v249 offset:12288
    v_mfma_f32_16x16x32_bf16 v[180:183], v[116:119], v[100:103], v[180:183]
    ds_read_b64_tr_b16 v[108:109], v250 offset:8192
    s_waitcnt lgkmcnt(7)
    v_mfma_f32_16x16x32_bf16 v[120:123], v[72:75], v[56:59], v[120:123]
    ds_read_b128 v[88:91], v248 offset:8192
    v_mfma_f32_16x16x32_bf16 v[124:127], v[72:75], v[60:63], v[124:127]
    ds_read_b128 v[92:95], v248 offset:9216
    v_mfma_f32_16x16x32_bf16 v[128:131], v[72:75], v[64:67], v[128:131]
    ds_read_b128 v[96:99], v248 offset:10240
    v_mfma_f32_16x16x32_bf16 v[132:135], v[72:75], v[68:71], v[132:135]
    ds_read_b128 v[100:103], v248 offset:11264
    v_mfma_f32_16x16x32_bf16 v[136:139], v[76:79], v[56:59], v[136:139]
    ds_read_b64_tr_b16 v[110:111], v250 offset:12288
    v_mfma_f32_16x16x32_bf16 v[140:143], v[76:79], v[60:63], v[140:143]
    ds_read_b64_tr_b16 v[112:113], v251 offset:8192
    v_mfma_f32_16x16x32_bf16 v[144:147], v[76:79], v[64:67], v[144:147]
    ds_read_b64_tr_b16 v[114:115], v251 offset:12288
    v_mfma_f32_16x16x32_bf16 v[148:151], v[76:79], v[68:71], v[148:151]
    ds_read_b64_tr_b16 v[116:117], v252 offset:8192
    s_waitcnt lgkmcnt(13)
    v_mfma_f32_16x16x32_bf16 v[152:155], v[80:83], v[56:59], v[152:155]
    ds_read_b64_tr_b16 v[118:119], v252 offset:12288
    v_mfma_f32_16x16x32_bf16 v[156:159], v[80:83], v[60:63], v[156:159]
    v_mfma_f32_16x16x32_bf16 v[160:163], v[80:83], v[64:67], v[160:163]
    v_mfma_f32_16x16x32_bf16 v[164:167], v[80:83], v[68:71], v[164:167]
    s_waitcnt lgkmcnt(12)
    v_mfma_f32_16x16x32_bf16 v[168:171], v[84:87], v[56:59], v[168:171]
    v_mfma_f32_16x16x32_bf16 v[172:175], v[84:87], v[60:63], v[172:175]
    v_mfma_f32_16x16x32_bf16 v[176:179], v[84:87], v[64:67], v[176:179]
    v_mfma_f32_16x16x32_bf16 v[180:183], v[84:87], v[68:71], v[180:183]
    s_waitcnt lgkmcnt(0)
    v_mfma_f32_16x16x32_bf16 v[120:123], v[104:107], v[88:91], v[120:123]
    s_barrier
    v_mfma_f32_16x16x32_bf16 v[124:127], v[104:107], v[92:95], v[124:127]
    ds_read_b128 v[56:59], v6 offset:0
    v_mfma_f32_16x16x32_bf16 v[128:131], v[104:107], v[96:99], v[128:131]
    ds_read_b64_tr_b16 v[72:73], v7 offset:0
    v_mfma_f32_16x16x32_bf16 v[132:135], v[104:107], v[100:103], v[132:135]
    ds_read_b64_tr_b16 v[74:75], v7 offset:4096
    v_mfma_f32_16x16x32_bf16 v[136:139], v[108:111], v[88:91], v[136:139]
    ds_read_b128 v[60:63], v6 offset:1024
    v_mfma_f32_16x16x32_bf16 v[140:143], v[108:111], v[92:95], v[140:143]
    ds_read_b128 v[64:67], v6 offset:2048
    v_mfma_f32_16x16x32_bf16 v[144:147], v[108:111], v[96:99], v[144:147]
    ds_read_b128 v[68:71], v6 offset:3072
    v_mfma_f32_16x16x32_bf16 v[148:151], v[108:111], v[100:103], v[148:151]
    ds_read_b64_tr_b16 v[76:77], v8 offset:0
    v_mfma_f32_16x16x32_bf16 v[152:155], v[112:115], v[88:91], v[152:155]
    ds_read_b64_tr_b16 v[78:79], v8 offset:4096
    v_mfma_f32_16x16x32_bf16 v[156:159], v[112:115], v[92:95], v[156:159]
    ds_read_b64_tr_b16 v[80:81], v9 offset:0
    v_mfma_f32_16x16x32_bf16 v[160:163], v[112:115], v[96:99], v[160:163]
    ds_read_b64_tr_b16 v[82:83], v9 offset:4096
    v_mfma_f32_16x16x32_bf16 v[164:167], v[112:115], v[100:103], v[164:167]
    ds_read_b64_tr_b16 v[84:85], v10 offset:0
    v_mfma_f32_16x16x32_bf16 v[168:171], v[116:119], v[88:91], v[168:171]
    ds_read_b64_tr_b16 v[86:87], v10 offset:4096
    v_mfma_f32_16x16x32_bf16 v[172:175], v[116:119], v[92:95], v[172:175]
    ds_read_b64_tr_b16 v[104:105], v7 offset:8192
    v_mfma_f32_16x16x32_bf16 v[176:179], v[116:119], v[96:99], v[176:179]
    ds_read_b64_tr_b16 v[106:107], v7 offset:12288
    v_mfma_f32_16x16x32_bf16 v[180:183], v[116:119], v[100:103], v[180:183]
    ds_read_b64_tr_b16 v[108:109], v8 offset:8192
    s_waitcnt lgkmcnt(7)
    v_mfma_f32_16x16x32_bf16 v[120:123], v[72:75], v[56:59], v[120:123]
    ds_read_b128 v[88:91], v6 offset:8192
    v_mfma_f32_16x16x32_bf16 v[124:127], v[72:75], v[60:63], v[124:127]
    ds_read_b128 v[92:95], v6 offset:9216
    v_mfma_f32_16x16x32_bf16 v[128:131], v[72:75], v[64:67], v[128:131]
    ds_read_b128 v[96:99], v6 offset:10240
    v_mfma_f32_16x16x32_bf16 v[132:135], v[72:75], v[68:71], v[132:135]
    ds_read_b128 v[100:103], v6 offset:11264
    v_mfma_f32_16x16x32_bf16 v[136:139], v[76:79], v[56:59], v[136:139]
    ds_read_b64_tr_b16 v[110:111], v8 offset:12288
    v_mfma_f32_16x16x32_bf16 v[140:143], v[76:79], v[60:63], v[140:143]
    ds_read_b64_tr_b16 v[112:113], v9 offset:8192
    v_mfma_f32_16x16x32_bf16 v[144:147], v[76:79], v[64:67], v[144:147]
    ds_read_b64_tr_b16 v[114:115], v9 offset:12288
    v_mfma_f32_16x16x32_bf16 v[148:151], v[76:79], v[68:71], v[148:151]
    ds_read_b64_tr_b16 v[116:117], v10 offset:8192
    s_waitcnt lgkmcnt(13)
    v_mfma_f32_16x16x32_bf16 v[152:155], v[80:83], v[56:59], v[152:155]
    ds_read_b64_tr_b16 v[118:119], v10 offset:12288
    v_mfma_f32_16x16x32_bf16 v[156:159], v[80:83], v[60:63], v[156:159]
    v_mfma_f32_16x16x32_bf16 v[160:163], v[80:83], v[64:67], v[160:163]
    v_mfma_f32_16x16x32_bf16 v[164:167], v[80:83], v[68:71], v[164:167]
    s_waitcnt lgkmcnt(12)
    v_mfma_f32_16x16x32_bf16 v[168:171], v[84:87], v[56:59], v[168:171]
    v_mfma_f32_16x16x32_bf16 v[172:175], v[84:87], v[60:63], v[172:175]
    v_mfma_f32_16x16x32_bf16 v[176:179], v[84:87], v[64:67], v[176:179]
    v_mfma_f32_16x16x32_bf16 v[180:183], v[84:87], v[68:71], v[180:183]
    s_waitcnt lgkmcnt(0)
    v_mfma_f32_16x16x32_bf16 v[120:123], v[104:107], v[88:91], v[120:123]
    s_barrier
    v_mfma_f32_16x16x32_bf16 v[124:127], v[104:107], v[92:95], v[124:127]
    ds_read_b128 v[56:59], v6 offset:32768
    v_mfma_f32_16x16x32_bf16 v[128:131], v[104:107], v[96:99], v[128:131]
    ds_read_b64_tr_b16 v[72:73], v7 offset:32768
    v_mfma_f32_16x16x32_bf16 v[132:135], v[104:107], v[100:103], v[132:135]
    ds_read_b64_tr_b16 v[74:75], v7 offset:36864
    v_mfma_f32_16x16x32_bf16 v[136:139], v[108:111], v[88:91], v[136:139]
    ds_read_b128 v[60:63], v6 offset:33792
    v_mfma_f32_16x16x32_bf16 v[140:143], v[108:111], v[92:95], v[140:143]
    ds_read_b128 v[64:67], v6 offset:34816
    v_mfma_f32_16x16x32_bf16 v[144:147], v[108:111], v[96:99], v[144:147]
    ds_read_b128 v[68:71], v6 offset:35840
    v_mfma_f32_16x16x32_bf16 v[148:151], v[108:111], v[100:103], v[148:151]
    ds_read_b64_tr_b16 v[76:77], v8 offset:32768
    v_mfma_f32_16x16x32_bf16 v[152:155], v[112:115], v[88:91], v[152:155]
    ds_read_b64_tr_b16 v[78:79], v8 offset:36864
    v_mfma_f32_16x16x32_bf16 v[156:159], v[112:115], v[92:95], v[156:159]
    ds_read_b64_tr_b16 v[80:81], v9 offset:32768
    v_mfma_f32_16x16x32_bf16 v[160:163], v[112:115], v[96:99], v[160:163]
    ds_read_b64_tr_b16 v[82:83], v9 offset:36864
    v_mfma_f32_16x16x32_bf16 v[164:167], v[112:115], v[100:103], v[164:167]
    ds_read_b64_tr_b16 v[84:85], v10 offset:32768
    v_mfma_f32_16x16x32_bf16 v[168:171], v[116:119], v[88:91], v[168:171]
    ds_read_b64_tr_b16 v[86:87], v10 offset:36864
    v_mfma_f32_16x16x32_bf16 v[172:175], v[116:119], v[92:95], v[172:175]
    ds_read_b64_tr_b16 v[104:105], v7 offset:40960
    v_mfma_f32_16x16x32_bf16 v[176:179], v[116:119], v[96:99], v[176:179]
    ds_read_b64_tr_b16 v[106:107], v7 offset:45056
    v_mfma_f32_16x16x32_bf16 v[180:183], v[116:119], v[100:103], v[180:183]
    ds_read_b64_tr_b16 v[108:109], v8 offset:40960
    s_mov_b32 s61, 3
LP_72:
    s_waitcnt lgkmcnt(7)
    v_mfma_f32_16x16x32_bf16 v[120:123], v[72:75], v[56:59], v[120:123]
    ds_read_b128 v[88:91], v6 offset:40960
    v_mfma_f32_16x16x32_bf16 v[124:127], v[72:75], v[60:63], v[124:127]
    ds_read_b128 v[92:95], v6 offset:41984
    v_mfma_f32_16x16x32_bf16 v[128:131], v[72:75], v[64:67], v[128:131]
    ds_read_b128 v[96:99], v6 offset:43008
    v_mfma_f32_16x16x32_bf16 v[132:135], v[72:75], v[68:71], v[132:135]
    ds_read_b128 v[100:103], v6 offset:44032
    v_mfma_f32_16x16x32_bf16 v[136:139], v[76:79], v[56:59], v[136:139]
    ds_read_b64_tr_b16 v[110:111], v8 offset:45056
    v_mfma_f32_16x16x32_bf16 v[140:143], v[76:79], v[60:63], v[140:143]
    ds_read_b64_tr_b16 v[112:113], v9 offset:40960
    v_mfma_f32_16x16x32_bf16 v[144:147], v[76:79], v[64:67], v[144:147]
    ds_read_b64_tr_b16 v[114:115], v9 offset:45056
    v_mfma_f32_16x16x32_bf16 v[148:151], v[76:79], v[68:71], v[148:151]
    ds_read_b64_tr_b16 v[116:117], v10 offset:40960
    s_waitcnt lgkmcnt(13)
    v_mfma_f32_16x16x32_bf16 v[152:155], v[80:83], v[56:59], v[152:155]
    ds_read_b64_tr_b16 v[118:119], v10 offset:45056
    v_mfma_f32_16x16x32_bf16 v[156:159], v[80:83], v[60:63], v[156:159]
    v_mfma_f32_16x16x32_bf16 v[160:163], v[80:83], v[64:67], v[160:163]
    v_mfma_f32_16x16x32_bf16 v[164:167], v[80:83], v[68:71], v[164:167]
    s_waitcnt lgkmcnt(12)
    v_mfma_f32_16x16x32_bf16 v[168:171], v[84:87], v[56:59], v[168:171]
    v_mfma_f32_16x16x32_bf16 v[172:175], v[84:87], v[60:63], v[172:175]
    v_mfma_f32_16x16x32_bf16 v[176:179], v[84:87], v[64:67], v[176:179]
    v_mfma_f32_16x16x32_bf16 v[180:183], v[84:87], v[68:71], v[180:183]
    s_waitcnt lgkmcnt(0)
    v_mfma_f32_16x16x32_bf16 v[120:123], v[104:107], v[88:91], v[120:123]
    s_waitcnt vmcnt(0)
    s_barrier
    v_mfma_f32_16x16x32_bf16 v[124:127], v[104:107], v[92:95], v[124:127]
    ds_read_b128 v[56:59], v11 offset:0
    v_mfma_f32_16x16x32_bf16 v[128:131], v[104:107], v[96:99], v[128:131]
    ds_read_b64_tr_b16 v[72:73], v12 offset:0
    v_mfma_f32_16x16x32_bf16 v[132:135], v[104:107], v[100:103], v[132:135]
    ds_read_b64_tr_b16 v[74:75], v12 offset:4096
    v_mfma_f32_16x16x32_bf16 v[136:139], v[108:111], v[88:91], v[136:139]
    ds_read_b128 v[60:63], v11 offset:1024
    v_mfma_f32_16x16x32_bf16 v[140:143], v[108:111], v[92:95], v[140:143]
    ds_read_b128 v[64:67], v11 offset:2048
    v_mfma_f32_16x16x32_bf16 v[144:147], v[108:111], v[96:99], v[144:147]
    ds_read_b128 v[68:71], v11 offset:3072
    v_mfma_f32_16x16x32_bf16 v[148:151], v[108:111], v[100:103], v[148:151]
    ds_read_b64_tr_b16 v[76:77], v13 offset:0
    v_mfma_f32_16x16x32_bf16 v[152:155], v[112:115], v[88:91], v[152:155]
    ds_read_b64_tr_b16 v[78:79], v13 offset:4096
    v_mfma_f32_16x16x32_bf16 v[156:159], v[112:115], v[92:95], v[156:159]
    ds_read_b64_tr_b16 v[80:81], v14 offset:0
    v_mfma_f32_16x16x32_bf16 v[160:163], v[112:115], v[96:99], v[160:163]
    ds_read_b64_tr_b16 v[82:83], v14 offset:4096
    v_mfma_f32_16x16x32_bf16 v[164:167], v[112:115], v[100:103], v[164:167]
    ds_read_b64_tr_b16 v[84:85], v15 offset:0
    v_mfma_f32_16x16x32_bf16 v[168:171], v[116:119], v[88:91], v[168:171]
    ds_read_b64_tr_b16 v[86:87], v15 offset:4096
    v_mfma_f32_16x16x32_bf16 v[172:175], v[116:119], v[92:95], v[172:175]
    ds_read_b64_tr_b16 v[104:105], v12 offset:8192
    v_mfma_f32_16x16x32_bf16 v[176:179], v[116:119], v[96:99], v[176:179]
    ds_read_b64_tr_b16 v[106:107], v12 offset:12288
    v_mfma_f32_16x16x32_bf16 v[180:183], v[116:119], v[100:103], v[180:183]
    ds_read_b64_tr_b16 v[108:109], v13 offset:8192
    s_waitcnt lgkmcnt(7)
    v_mfma_f32_16x16x32_bf16 v[120:123], v[72:75], v[56:59], v[120:123]
    ds_read_b128 v[88:91], v11 offset:8192
    v_mfma_f32_16x16x32_bf16 v[124:127], v[72:75], v[60:63], v[124:127]
    ds_read_b128 v[92:95], v11 offset:9216
    v_mfma_f32_16x16x32_bf16 v[128:131], v[72:75], v[64:67], v[128:131]
    ds_read_b128 v[96:99], v11 offset:10240
    v_mfma_f32_16x16x32_bf16 v[132:135], v[72:75], v[68:71], v[132:135]
    ds_read_b128 v[100:103], v11 offset:11264
    v_mfma_f32_16x16x32_bf16 v[136:139], v[76:79], v[56:59], v[136:139]
    ds_read_b64_tr_b16 v[110:111], v13 offset:12288
    v_mfma_f32_16x16x32_bf16 v[140:143], v[76:79], v[60:63], v[140:143]
    ds_read_b64_tr_b16 v[112:113], v14 offset:8192
    v_mfma_f32_16x16x32_bf16 v[144:147], v[76:79], v[64:67], v[144:147]
    ds_read_b64_tr_b16 v[114:115], v14 offset:12288
    v_mfma_f32_16x16x32_bf16 v[148:151], v[76:79], v[68:71], v[148:151]
    ds_read_b64_tr_b16 v[116:117], v15 offset:8192
    s_waitcnt lgkmcnt(13)
    v_mfma_f32_16x16x32_bf16 v[152:155], v[80:83], v[56:59], v[152:155]
    ds_read_b64_tr_b16 v[118:119], v15 offset:12288
    v_mfma_f32_16x16x32_bf16 v[156:159], v[80:83], v[60:63], v[156:159]
    v_mfma_f32_16x16x32_bf16 v[160:163], v[80:83], v[64:67], v[160:163]
    v_mfma_f32_16x16x32_bf16 v[164:167], v[80:83], v[68:71], v[164:167]
    s_waitcnt lgkmcnt(12)
    v_mfma_f32_16x16x32_bf16 v[168:171], v[84:87], v[56:59], v[168:171]
    v_mfma_f32_16x16x32_bf16 v[172:175], v[84:87], v[60:63], v[172:175]
    v_mfma_f32_16x16x32_bf16 v[176:179], v[84:87], v[64:67], v[176:179]
    v_mfma_f32_16x16x32_bf16 v[180:183], v[84:87], v[68:71], v[180:183]
    s_waitcnt lgkmcnt(0)
    v_mfma_f32_16x16x32_bf16 v[120:123], v[104:107], v[88:91], v[120:123]
    s_barrier
    v_mfma_f32_16x16x32_bf16 v[124:127], v[104:107], v[92:95], v[124:127]
    ds_read_b128 v[56:59], v11 offset:32768
    v_mfma_f32_16x16x32_bf16 v[128:131], v[104:107], v[96:99], v[128:131]
    ds_read_b64_tr_b16 v[72:73], v12 offset:32768
    v_mfma_f32_16x16x32_bf16 v[132:135], v[104:107], v[100:103], v[132:135]
    ds_read_b64_tr_b16 v[74:75], v12 offset:36864
    v_mfma_f32_16x16x32_bf16 v[136:139], v[108:111], v[88:91], v[136:139]
    ds_read_b128 v[60:63], v11 offset:33792
    v_mfma_f32_16x16x32_bf16 v[140:143], v[108:111], v[92:95], v[140:143]
    ds_read_b128 v[64:67], v11 offset:34816
    v_mfma_f32_16x16x32_bf16 v[144:147], v[108:111], v[96:99], v[144:147]
    ds_read_b128 v[68:71], v11 offset:35840
    v_mfma_f32_16x16x32_bf16 v[148:151], v[108:111], v[100:103], v[148:151]
    ds_read_b64_tr_b16 v[76:77], v13 offset:32768
    v_mfma_f32_16x16x32_bf16 v[152:155], v[112:115], v[88:91], v[152:155]
    ds_read_b64_tr_b16 v[78:79], v13 offset:36864
    v_mfma_f32_16x16x32_bf16 v[156:159], v[112:115], v[92:95], v[156:159]
    ds_read_b64_tr_b16 v[80:81], v14 offset:32768
    v_mfma_f32_16x16x32_bf16 v[160:163], v[112:115], v[96:99], v[160:163]
    ds_read_b64_tr_b16 v[82:83], v14 offset:36864
    v_mfma_f32_16x16x32_bf16 v[164:167], v[112:115], v[100:103], v[164:167]
    ds_read_b64_tr_b16 v[84:85], v15 offset:32768
    v_mfma_f32_16x16x32_bf16 v[168:171], v[116:119], v[88:91], v[168:171]
    ds_read_b64_tr_b16 v[86:87], v15 offset:36864
    v_mfma_f32_16x16x32_bf16 v[172:175], v[116:119], v[92:95], v[172:175]
    ds_read_b64_tr_b16 v[104:105], v12 offset:40960
    v_mfma_f32_16x16x32_bf16 v[176:179], v[116:119], v[96:99], v[176:179]
    ds_read_b64_tr_b16 v[106:107], v12 offset:45056
    v_mfma_f32_16x16x32_bf16 v[180:183], v[116:119], v[100:103], v[180:183]
    ds_read_b64_tr_b16 v[108:109], v13 offset:40960
    s_waitcnt lgkmcnt(7)
    v_mfma_f32_16x16x32_bf16 v[120:123], v[72:75], v[56:59], v[120:123]
    ds_read_b128 v[88:91], v11 offset:40960
    v_mfma_f32_16x16x32_bf16 v[124:127], v[72:75], v[60:63], v[124:127]
    ds_read_b128 v[92:95], v11 offset:41984
    v_mfma_f32_16x16x32_bf16 v[128:131], v[72:75], v[64:67], v[128:131]
    ds_read_b128 v[96:99], v11 offset:43008
    v_mfma_f32_16x16x32_bf16 v[132:135], v[72:75], v[68:71], v[132:135]
    ds_read_b128 v[100:103], v11 offset:44032
    v_mfma_f32_16x16x32_bf16 v[136:139], v[76:79], v[56:59], v[136:139]
    ds_read_b64_tr_b16 v[110:111], v13 offset:45056
    v_mfma_f32_16x16x32_bf16 v[140:143], v[76:79], v[60:63], v[140:143]
    ds_read_b64_tr_b16 v[112:113], v14 offset:40960
    v_mfma_f32_16x16x32_bf16 v[144:147], v[76:79], v[64:67], v[144:147]
    ds_read_b64_tr_b16 v[114:115], v14 offset:45056
    v_mfma_f32_16x16x32_bf16 v[148:151], v[76:79], v[68:71], v[148:151]
    ds_read_b64_tr_b16 v[116:117], v15 offset:40960
    s_waitcnt lgkmcnt(13)
    v_mfma_f32_16x16x32_bf16 v[152:155], v[80:83], v[56:59], v[152:155]
    ds_read_b64_tr_b16 v[118:119], v15 offset:45056
    v_mfma_f32_16x16x32_bf16 v[156:159], v[80:83], v[60:63], v[156:159]
    v_mfma_f32_16x16x32_bf16 v[160:163], v[80:83], v[64:67], v[160:163]
    v_mfma_f32_16x16x32_bf16 v[164:167], v[80:83], v[68:71], v[164:167]
    s_waitcnt lgkmcnt(12)
    v_mfma_f32_16x16x32_bf16 v[168:171], v[84:87], v[56:59], v[168:171]
    v_mfma_f32_16x16x32_bf16 v[172:175], v[84:87], v[60:63], v[172:175]
    v_mfma_f32_16x16x32_bf16 v[176:179], v[84:87], v[64:67], v[176:179]
    v_mfma_f32_16x16x32_bf16 v[180:183], v[84:87], v[68:71], v[180:183]
    s_waitcnt lgkmcnt(0)
    v_mfma_f32_16x16x32_bf16 v[120:123], v[104:107], v[88:91], v[120:123]
    s_barrier
    v_mfma_f32_16x16x32_bf16 v[124:127], v[104:107], v[92:95], v[124:127]
    ds_read_b128 v[56:59], v248 offset:0
    v_mfma_f32_16x16x32_bf16 v[128:131], v[104:107], v[96:99], v[128:131]
    ds_read_b64_tr_b16 v[72:73], v249 offset:0
    v_mfma_f32_16x16x32_bf16 v[132:135], v[104:107], v[100:103], v[132:135]
    ds_read_b64_tr_b16 v[74:75], v249 offset:4096
    v_mfma_f32_16x16x32_bf16 v[136:139], v[108:111], v[88:91], v[136:139]
    ds_read_b128 v[60:63], v248 offset:1024
    v_mfma_f32_16x16x32_bf16 v[140:143], v[108:111], v[92:95], v[140:143]
    ds_read_b128 v[64:67], v248 offset:2048
    v_mfma_f32_16x16x32_bf16 v[144:147], v[108:111], v[96:99], v[144:147]
    ds_read_b128 v[68:71], v248 offset:3072
    v_mfma_f32_16x16x32_bf16 v[148:151], v[108:111], v[100:103], v[148:151]
    ds_read_b64_tr_b16 v[76:77], v250 offset:0
    v_mfma_f32_16x16x32_bf16 v[152:155], v[112:115], v[88:91], v[152:155]
    ds_read_b64_tr_b16 v[78:79], v250 offset:4096
    v_mfma_f32_16x16x32_bf16 v[156:159], v[112:115], v[92:95], v[156:159]
    ds_read_b64_tr_b16 v[80:81], v251 offset:0
    v_mfma_f32_16x16x32_bf16 v[160:163], v[112:115], v[96:99], v[160:163]
    ds_read_b64_tr_b16 v[82:83], v251 offset:4096
    v_mfma_f32_16x16x32_bf16 v[164:167], v[112:115], v[100:103], v[164:167]
    ds_read_b64_tr_b16 v[84:85], v252 offset:0
    v_mfma_f32_16x16x32_bf16 v[168:171], v[116:119], v[88:91], v[168:171]
    ds_read_b64_tr_b16 v[86:87], v252 offset:4096
    v_mfma_f32_16x16x32_bf16 v[172:175], v[116:119], v[92:95], v[172:175]
    ds_read_b64_tr_b16 v[104:105], v249 offset:8192
    v_mfma_f32_16x16x32_bf16 v[176:179], v[116:119], v[96:99], v[176:179]
    ds_read_b64_tr_b16 v[106:107], v249 offset:12288
    v_mfma_f32_16x16x32_bf16 v[180:183], v[116:119], v[100:103], v[180:183]
    ds_read_b64_tr_b16 v[108:109], v250 offset:8192
    s_waitcnt lgkmcnt(7)
    v_mfma_f32_16x16x32_bf16 v[120:123], v[72:75], v[56:59], v[120:123]
    ds_read_b128 v[88:91], v248 offset:8192
    v_mfma_f32_16x16x32_bf16 v[124:127], v[72:75], v[60:63], v[124:127]
    ds_read_b128 v[92:95], v248 offset:9216
    v_mfma_f32_16x16x32_bf16 v[128:131], v[72:75], v[64:67], v[128:131]
    ds_read_b128 v[96:99], v248 offset:10240
    v_mfma_f32_16x16x32_bf16 v[132:135], v[72:75], v[68:71], v[132:135]
    ds_read_b128 v[100:103], v248 offset:11264
    v_mfma_f32_16x16x32_bf16 v[136:139], v[76:79], v[56:59], v[136:139]
    ds_read_b64_tr_b16 v[110:111], v250 offset:12288
    v_mfma_f32_16x16x32_bf16 v[140:143], v[76:79], v[60:63], v[140:143]
    ds_read_b64_tr_b16 v[112:113], v251 offset:8192
    v_mfma_f32_16x16x32_bf16 v[144:147], v[76:79], v[64:67], v[144:147]
    ds_read_b64_tr_b16 v[114:115], v251 offset:12288
    v_mfma_f32_16x16x32_bf16 v[148:151], v[76:79], v[68:71], v[148:151]
    ds_read_b64_tr_b16 v[116:117], v252 offset:8192
    s_waitcnt lgkmcnt(13)
    v_mfma_f32_16x16x32_bf16 v[152:155], v[80:83], v[56:59], v[152:155]
    ds_read_b64_tr_b16 v[118:119], v252 offset:12288
    v_mfma_f32_16x16x32_bf16 v[156:159], v[80:83], v[60:63], v[156:159]
    v_mfma_f32_16x16x32_bf16 v[160:163], v[80:83], v[64:67], v[160:163]
    v_mfma_f32_16x16x32_bf16 v[164:167], v[80:83], v[68:71], v[164:167]
    s_waitcnt lgkmcnt(12)
    v_mfma_f32_16x16x32_bf16 v[168:171], v[84:87], v[56:59], v[168:171]
    v_mfma_f32_16x16x32_bf16 v[172:175], v[84:87], v[60:63], v[172:175]
    v_mfma_f32_16x16x32_bf16 v[176:179], v[84:87], v[64:67], v[176:179]
    v_mfma_f32_16x16x32_bf16 v[180:183], v[84:87], v[68:71], v[180:183]
    s_waitcnt lgkmcnt(0)
    v_mfma_f32_16x16x32_bf16 v[120:123], v[104:107], v[88:91], v[120:123]
    s_barrier
    v_mfma_f32_16x16x32_bf16 v[124:127], v[104:107], v[92:95], v[124:127]
    ds_read_b128 v[56:59], v6 offset:0
    v_mfma_f32_16x16x32_bf16 v[128:131], v[104:107], v[96:99], v[128:131]
    ds_read_b64_tr_b16 v[72:73], v7 offset:0
    v_mfma_f32_16x16x32_bf16 v[132:135], v[104:107], v[100:103], v[132:135]
    ds_read_b64_tr_b16 v[74:75], v7 offset:4096
    v_mfma_f32_16x16x32_bf16 v[136:139], v[108:111], v[88:91], v[136:139]
    ds_read_b128 v[60:63], v6 offset:1024
    v_mfma_f32_16x16x32_bf16 v[140:143], v[108:111], v[92:95], v[140:143]
    ds_read_b128 v[64:67], v6 offset:2048
    v_mfma_f32_16x16x32_bf16 v[144:147], v[108:111], v[96:99], v[144:147]
    ds_read_b128 v[68:71], v6 offset:3072
    v_mfma_f32_16x16x32_bf16 v[148:151], v[108:111], v[100:103], v[148:151]
    ds_read_b64_tr_b16 v[76:77], v8 offset:0
    v_mfma_f32_16x16x32_bf16 v[152:155], v[112:115], v[88:91], v[152:155]
    ds_read_b64_tr_b16 v[78:79], v8 offset:4096
    v_mfma_f32_16x16x32_bf16 v[156:159], v[112:115], v[92:95], v[156:159]
    ds_read_b64_tr_b16 v[80:81], v9 offset:0
    v_mfma_f32_16x16x32_bf16 v[160:163], v[112:115], v[96:99], v[160:163]
    ds_read_b64_tr_b16 v[82:83], v9 offset:4096
    v_mfma_f32_16x16x32_bf16 v[164:167], v[112:115], v[100:103], v[164:167]
    ds_read_b64_tr_b16 v[84:85], v10 offset:0
    v_mfma_f32_16x16x32_bf16 v[168:171], v[116:119], v[88:91], v[168:171]
    ds_read_b64_tr_b16 v[86:87], v10 offset:4096
    v_mfma_f32_16x16x32_bf16 v[172:175], v[116:119], v[92:95], v[172:175]
    ds_read_b64_tr_b16 v[104:105], v7 offset:8192
    v_mfma_f32_16x16x32_bf16 v[176:179], v[116:119], v[96:99], v[176:179]
    ds_read_b64_tr_b16 v[106:107], v7 offset:12288
    v_mfma_f32_16x16x32_bf16 v[180:183], v[116:119], v[100:103], v[180:183]
    ds_read_b64_tr_b16 v[108:109], v8 offset:8192
    s_waitcnt lgkmcnt(7)
    v_mfma_f32_16x16x32_bf16 v[120:123], v[72:75], v[56:59], v[120:123]
    ds_read_b128 v[88:91], v6 offset:8192
    v_mfma_f32_16x16x32_bf16 v[124:127], v[72:75], v[60:63], v[124:127]
    ds_read_b128 v[92:95], v6 offset:9216
    v_mfma_f32_16x16x32_bf16 v[128:131], v[72:75], v[64:67], v[128:131]
    ds_read_b128 v[96:99], v6 offset:10240
    v_mfma_f32_16x16x32_bf16 v[132:135], v[72:75], v[68:71], v[132:135]
    ds_read_b128 v[100:103], v6 offset:11264
    v_mfma_f32_16x16x32_bf16 v[136:139], v[76:79], v[56:59], v[136:139]
    ds_read_b64_tr_b16 v[110:111], v8 offset:12288
    v_mfma_f32_16x16x32_bf16 v[140:143], v[76:79], v[60:63], v[140:143]
    ds_read_b64_tr_b16 v[112:113], v9 offset:8192
    v_mfma_f32_16x16x32_bf16 v[144:147], v[76:79], v[64:67], v[144:147]
    ds_read_b64_tr_b16 v[114:115], v9 offset:12288
    v_mfma_f32_16x16x32_bf16 v[148:151], v[76:79], v[68:71], v[148:151]
    ds_read_b64_tr_b16 v[116:117], v10 offset:8192
    s_waitcnt lgkmcnt(13)
    v_mfma_f32_16x16x32_bf16 v[152:155], v[80:83], v[56:59], v[152:155]
    ds_read_b64_tr_b16 v[118:119], v10 offset:12288
    v_mfma_f32_16x16x32_bf16 v[156:159], v[80:83], v[60:63], v[156:159]
    v_mfma_f32_16x16x32_bf16 v[160:163], v[80:83], v[64:67], v[160:163]
    v_mfma_f32_16x16x32_bf16 v[164:167], v[80:83], v[68:71], v[164:167]
    s_waitcnt lgkmcnt(12)
    v_mfma_f32_16x16x32_bf16 v[168:171], v[84:87], v[56:59], v[168:171]
    v_mfma_f32_16x16x32_bf16 v[172:175], v[84:87], v[60:63], v[172:175]
    v_mfma_f32_16x16x32_bf16 v[176:179], v[84:87], v[64:67], v[176:179]
    v_mfma_f32_16x16x32_bf16 v[180:183], v[84:87], v[68:71], v[180:183]
    s_waitcnt lgkmcnt(0)
    v_mfma_f32_16x16x32_bf16 v[120:123], v[104:107], v[88:91], v[120:123]
    s_barrier
    v_mfma_f32_16x16x32_bf16 v[124:127], v[104:107], v[92:95], v[124:127]
    ds_read_b128 v[56:59], v6 offset:32768
    v_mfma_f32_16x16x32_bf16 v[128:131], v[104:107], v[96:99], v[128:131]
    ds_read_b64_tr_b16 v[72:73], v7 offset:32768
    v_mfma_f32_16x16x32_bf16 v[132:135], v[104:107], v[100:103], v[132:135]
    ds_read_b64_tr_b16 v[74:75], v7 offset:36864
    v_mfma_f32_16x16x32_bf16 v[136:139], v[108:111], v[88:91], v[136:139]
    ds_read_b128 v[60:63], v6 offset:33792
    v_mfma_f32_16x16x32_bf16 v[140:143], v[108:111], v[92:95], v[140:143]
    ds_read_b128 v[64:67], v6 offset:34816
    v_mfma_f32_16x16x32_bf16 v[144:147], v[108:111], v[96:99], v[144:147]
    ds_read_b128 v[68:71], v6 offset:35840
    v_mfma_f32_16x16x32_bf16 v[148:151], v[108:111], v[100:103], v[148:151]
    ds_read_b64_tr_b16 v[76:77], v8 offset:32768
    v_mfma_f32_16x16x32_bf16 v[152:155], v[112:115], v[88:91], v[152:155]
    ds_read_b64_tr_b16 v[78:79], v8 offset:36864
    v_mfma_f32_16x16x32_bf16 v[156:159], v[112:115], v[92:95], v[156:159]
    ds_read_b64_tr_b16 v[80:81], v9 offset:32768
    v_mfma_f32_16x16x32_bf16 v[160:163], v[112:115], v[96:99], v[160:163]
    ds_read_b64_tr_b16 v[82:83], v9 offset:36864
    v_mfma_f32_16x16x32_bf16 v[164:167], v[112:115], v[100:103], v[164:167]
    ds_read_b64_tr_b16 v[84:85], v10 offset:32768
    v_mfma_f32_16x16x32_bf16 v[168:171], v[116:119], v[88:91], v[168:171]
    ds_read_b64_tr_b16 v[86:87], v10 offset:36864
    v_mfma_f32_16x16x32_bf16 v[172:175], v[116:119], v[92:95], v[172:175]
    ds_read_b64_tr_b16 v[104:105], v7 offset:40960
    v_mfma_f32_16x16x32_bf16 v[176:179], v[116:119], v[96:99], v[176:179]
    ds_read_b64_tr_b16 v[106:107], v7 offset:45056
    v_mfma_f32_16x16x32_bf16 v[180:183], v[116:119], v[100:103], v[180:183]
    ds_read_b64_tr_b16 v[108:109], v8 offset:40960
    s_sub_u32 s61, s61, 1
    s_cmp_lg_u32 s61, 0
    s_cbranch_scc1 LP_72
    s_waitcnt lgkmcnt(7)
    v_mfma_f32_16x16x32_bf16 v[120:123], v[72:75], v[56:59], v[120:123]
    ds_read_b128 v[88:91], v6 offset:40960
    v_mfma_f32_16x16x32_bf16 v[124:127], v[72:75], v[60:63], v[124:127]
    ds_read_b128 v[92:95], v6 offset:41984
    v_mfma_f32_16x16x32_bf16 v[128:131], v[72:75], v[64:67], v[128:131]
    ds_read_b128 v[96:99], v6 offset:43008
    v_mfma_f32_16x16x32_bf16 v[132:135], v[72:75], v[68:71], v[132:135]
    ds_read_b128 v[100:103], v6 offset:44032
    v_mfma_f32_16x16x32_bf16 v[136:139], v[76:79], v[56:59], v[136:139]
    ds_read_b64_tr_b16 v[110:111], v8 offset:45056
    v_mfma_f32_16x16x32_bf16 v[140:143], v[76:79], v[60:63], v[140:143]
    ds_read_b64_tr_b16 v[112:113], v9 offset:40960
    v_mfma_f32_16x16x32_bf16 v[144:147], v[76:79], v[64:67], v[144:147]
    ds_read_b64_tr_b16 v[114:115], v9 offset:45056
    v_mfma_f32_16x16x32_bf16 v[148:151], v[76:79], v[68:71], v[148:151]
    ds_read_b64_tr_b16 v[116:117], v10 offset:40960
    s_waitcnt lgkmcnt(13)
    v_mfma_f32_16x16x32_bf16 v[152:155], v[80:83], v[56:59], v[152:155]
    ds_read_b64_tr_b16 v[118:119], v10 offset:45056
    v_mfma_f32_16x16x32_bf16 v[156:159], v[80:83], v[60:63], v[156:159]
    v_mfma_f32_16x16x32_bf16 v[160:163], v[80:83], v[64:67], v[160:163]
    v_mfma_f32_16x16x32_bf16 v[164:167], v[80:83], v[68:71], v[164:167]
    s_waitcnt lgkmcnt(12)
    v_mfma_f32_16x16x32_bf16 v[168:171], v[84:87], v[56:59], v[168:171]
    v_mfma_f32_16x16x32_bf16 v[172:175], v[84:87], v[60:63], v[172:175]
    v_mfma_f32_16x16x32_bf16 v[176:179], v[84:87], v[64:67], v[176:179]
    v_mfma_f32_16x16x32_bf16 v[180:183], v[84:87], v[68:71], v[180:183]
    s_waitcnt lgkmcnt(0)
    v_mfma_f32_16x16x32_bf16 v[120:123], v[104:107], v[88:91], v[120:123]
    s_barrier
    v_mfma_f32_16x16x32_bf16 v[124:127], v[104:107], v[92:95], v[124:127]
    ds_read_b128 v[56:59], v11 offset:0
    v_mfma_f32_16x16x32_bf16 v[128:131], v[104:107], v[96:99], v[128:131]
    ds_read_b64_tr_b16 v[72:73], v12 offset:0
    v_mfma_f32_16x16x32_bf16 v[132:135], v[104:107], v[100:103], v[132:135]
    ds_read_b64_tr_b16 v[74:75], v12 offset:4096
    v_mfma_f32_16x16x32_bf16 v[136:139], v[108:111], v[88:91], v[136:139]
    ds_read_b128 v[60:63], v11 offset:1024
    v_mfma_f32_16x16x32_bf16 v[140:143], v[108:111], v[92:95], v[140:143]
    ds_read_b128 v[64:67], v11 offset:2048
    v_mfma_f32_16x16x32_bf16 v[144:147], v[108:111], v[96:99], v[144:147]
    ds_read_b128 v[68:71], v11 offset:3072
    v_mfma_f32_16x16x32_bf16 v[148:151], v[108:111], v[100:103], v[148:151]
    ds_read_b64_tr_b16 v[76:77], v13 offset:0
    v_mfma_f32_16x16x32_bf16 v[152:155], v[112:115], v[88:91], v[152:155]
    ds_read_b64_tr_b16 v[78:79], v13 offset:4096
    v_mfma_f32_16x16x32_bf16 v[156:159], v[112:115], v[92:95], v[156:159]
    ds_read_b64_tr_b16 v[80:81], v14 offset:0
    v_mfma_f32_16x16x32_bf16 v[160:163], v[112:115], v[96:99], v[160:163]
    ds_read_b64_tr_b16 v[82:83], v14 offset:4096
    v_mfma_f32_16x16x32_bf16 v[164:167], v[112:115], v[100:103], v[164:167]
    ds_read_b64_tr_b16 v[84:85], v15 offset:0
    v_mfma_f32_16x16x32_bf16 v[168:171], v[116:119], v[88:91], v[168:171]
    ds_read_b64_tr_b16 v[86:87], v15 offset:4096
    v_mfma_f32_16x16x32_bf16 v[172:175], v[116:119], v[92:95], v[172:175]
    ds_read_b64_tr_b16 v[104:105], v12 offset:8192
    v_mfma_f32_16x16x32_bf16 v[176:179], v[116:119], v[96:99], v[176:179]
    ds_read_b64_tr_b16 v[106:107], v12 offset:12288
    v_mfma_f32_16x16x32_bf16 v[180:183], v[116:119], v[100:103], v[180:183]
    ds_read_b64_tr_b16 v[108:109], v13 offset:8192
    s_waitcnt lgkmcnt(7)
    v_mfma_f32_16x16x32_bf16 v[120:123], v[72:75], v[56:59], v[120:123]
    ds_read_b128 v[88:91], v11 offset:8192
    v_mfma_f32_16x16x32_bf16 v[124:127], v[72:75], v[60:63], v[124:127]
    ds_read_b128 v[92:95], v11 offset:9216
    v_mfma_f32_16x16x32_bf16 v[128:131], v[72:75], v[64:67], v[128:131]
    ds_read_b128 v[96:99], v11 offset:10240
    v_mfma_f32_16x16x32_bf16 v[132:135], v[72:75], v[68:71], v[132:135]
    ds_read_b128 v[100:103], v11 offset:11264
    v_mfma_f32_16x16x32_bf16 v[136:139], v[76:79], v[56:59], v[136:139]
    ds_read_b64_tr_b16 v[110:111], v13 offset:12288
    v_mfma_f32_16x16x32_bf16 v[140:143], v[76:79], v[60:63], v[140:143]
    ds_read_b64_tr_b16 v[112:113], v14 offset:8192
    v_mfma_f32_16x16x32_bf16 v[144:147], v[76:79], v[64:67], v[144:147]
    ds_read_b64_tr_b16 v[114:115], v14 offset:12288
    v_mfma_f32_16x16x32_bf16 v[148:151], v[76:79], v[68:71], v[148:151]
    ds_read_b64_tr_b16 v[116:117], v15 offset:8192
    s_waitcnt lgkmcnt(13)
    v_mfma_f32_16x16x32_bf16 v[152:155], v[80:83], v[56:59], v[152:155]
    ds_read_b64_tr_b16 v[118:119], v15 offset:12288
    v_mfma_f32_16x16x32_bf16 v[156:159], v[80:83], v[60:63], v[156:159]
    v_mfma_f32_16x16x32_bf16 v[160:163], v[80:83], v[64:67], v[160:163]
    v_mfma_f32_16x16x32_bf16 v[164:167], v[80:83], v[68:71], v[164:167]
    s_waitcnt lgkmcnt(12)
    v_mfma_f32_16x16x32_bf16 v[168:171], v[84:87], v[56:59], v[168:171]
    v_mfma_f32_16x16x32_bf16 v[172:175], v[84:87], v[60:63], v[172:175]
    v_mfma_f32_16x16x32_bf16 v[176:179], v[84:87], v[64:67], v[176:179]
    v_mfma_f32_16x16x32_bf16 v[180:183], v[84:87], v[68:71], v[180:183]
    s_waitcnt lgkmcnt(0)
    v_mfma_f32_16x16x32_bf16 v[120:123], v[104:107], v[88:91], v[120:123]
    s_barrier
    v_mfma_f32_16x16x32_bf16 v[124:127], v[104:107], v[92:95], v[124:127]
    ds_read_b128 v[56:59], v11 offset:32768
    v_mfma_f32_16x16x32_bf16 v[128:131], v[104:107], v[96:99], v[128:131]
    ds_read_b64_tr_b16 v[72:73], v12 offset:32768
    v_mfma_f32_16x16x32_bf16 v[132:135], v[104:107], v[100:103], v[132:135]
    ds_read_b64_tr_b16 v[74:75], v12 offset:36864
    v_mfma_f32_16x16x32_bf16 v[136:139], v[108:111], v[88:91], v[136:139]
    ds_read_b128 v[60:63], v11 offset:33792
    v_mfma_f32_16x16x32_bf16 v[140:143], v[108:111], v[92:95], v[140:143]
    ds_read_b128 v[64:67], v11 offset:34816
    v_mfma_f32_16x16x32_bf16 v[144:147], v[108:111], v[96:99], v[144:147]
    ds_read_b128 v[68:71], v11 offset:35840
    v_mfma_f32_16x16x32_bf16 v[148:151], v[108:111], v[100:103], v[148:151]
    ds_read_b64_tr_b16 v[76:77], v13 offset:32768
    v_mfma_f32_16x16x32_bf16 v[152:155], v[112:115], v[88:91], v[152:155]
    ds_read_b64_tr_b16 v[78:79], v13 offset:36864
    v_mfma_f32_16x16x32_bf16 v[156:159], v[112:115], v[92:95], v[156:159]
    ds_read_b64_tr_b16 v[80:81], v14 offset:32768
    v_mfma_f32_16x16x32_bf16 v[160:163], v[112:115], v[96:99], v[160:163]
    ds_read_b64_tr_b16 v[82:83], v14 offset:36864
    v_mfma_f32_16x16x32_bf16 v[164:167], v[112:115], v[100:103], v[164:167]
    ds_read_b64_tr_b16 v[84:85], v15 offset:32768
    v_mfma_f32_16x16x32_bf16 v[168:171], v[116:119], v[88:91], v[168:171]
    ds_read_b64_tr_b16 v[86:87], v15 offset:36864
    v_mfma_f32_16x16x32_bf16 v[172:175], v[116:119], v[92:95], v[172:175]
    ds_read_b64_tr_b16 v[104:105], v12 offset:40960
    v_mfma_f32_16x16x32_bf16 v[176:179], v[116:119], v[96:99], v[176:179]
    ds_read_b64_tr_b16 v[106:107], v12 offset:45056
    v_mfma_f32_16x16x32_bf16 v[180:183], v[116:119], v[100:103], v[180:183]
    ds_read_b64_tr_b16 v[108:109], v13 offset:40960
    s_nop 7
    v_mul_f32 v120, v120, v22
    v_mul_f32 v121, v121, v22
    v_mul_f32 v122, v122, v22
    v_mul_f32 v123, v123, v22
    v_mul_f32 v124, v124, v23
    v_mul_f32 v125, v125, v23
    v_mul_f32 v126, v126, v23
    v_mul_f32 v127, v127, v23
    v_mul_f32 v128, v128, v24
    v_mul_f32 v129, v129, v24
    v_mul_f32 v130, v130, v24
    v_mul_f32 v131, v131, v24
    v_mul_f32 v132, v132, v25
    v_mul_f32 v133, v133, v25
    v_mul_f32 v134, v134, v25
    v_mul_f32 v135, v135, v25
    v_mul_f32 v136, v136, v22
    v_mul_f32 v137, v137, v22
    v_mul_f32 v138, v138, v22
    v_mul_f32 v139, v139, v22
    v_mul_f32 v140, v140, v23
    v_mul_f32 v141, v141, v23
    v_mul_f32 v142, v142, v23
    v_mul_f32 v143, v143, v23
    v_mul_f32 v144, v144, v24
    v_mul_f32 v145, v145, v24
    v_mul_f32 v146, v146, v24
    v_mul_f32 v147, v147, v24
    v_mul_f32 v148, v148, v25
    v_mul_f32 v149, v149, v25
    v_mul_f32 v150, v150, v25
    v_mul_f32 v151, v151, v25
    v_mul_f32 v152, v152, v22
    v_mul_f32 v153, v153, v22
    v_mul_f32 v154, v154, v22
    v_mul_f32 v155, v155, v22
    v_mul_f32 v156, v156, v23
    v_mul_f32 v157, v157, v23
    v_mul_f32 v158, v158, v23
    v_mul_f32 v159, v159, v23
    v_mul_f32 v160, v160, v24
    v_mul_f32 v161, v161, v24
    v_mul_f32 v162, v162, v24
    v_mul_f32 v163, v163, v24
    v_mul_f32 v164, v164, v25
    v_mul_f32 v165, v165, v25
    v_mul_f32 v166, v166, v25
    v_mul_f32 v167, v167, v25
    v_mul_f32 v168, v168, v22
    v_mul_f32 v169, v169, v22
    v_mul_f32 v170, v170, v22
    v_mul_f32 v171, v171, v22
    v_mul_f32 v172, v172, v23
    v_mul_f32 v173, v173, v23
    v_mul_f32 v174, v174, v23
    v_mul_f32 v175, v175, v23
    v_mul_f32 v176, v176, v24
    v_mul_f32 v177, v177, v24
    v_mul_f32 v178, v178, v24
    v_mul_f32 v179, v179, v24
    v_mul_f32 v180, v180, v25
    v_mul_f32 v181, v181, v25
    v_mul_f32 v182, v182, v25
    v_mul_f32 v183, v183, v25
    s_nop 1
    s_mov_b32 s61, 3
LP_73:
    s_waitcnt lgkmcnt(7)
    v_mfma_f32_16x16x32_bf16 v[120:123], v[72:75], v[56:59], v[120:123]
    ds_read_b128 v[88:91], v11 offset:40960
    v_mfma_f32_16x16x32_bf16 v[124:127], v[72:75], v[60:63], v[124:127]
    ds_read_b128 v[92:95], v11 offset:41984
    v_mfma_f32_16x16x32_bf16 v[128:131], v[72:75], v[64:67], v[128:131]
    ds_read_b128 v[96:99], v11 offset:43008
    v_mfma_f32_16x16x32_bf16 v[132:135], v[72:75], v[68:71], v[132:135]
    ds_read_b128 v[100:103], v11 offset:44032
    v_mfma_f32_16x16x32_bf16 v[136:139], v[76:79], v[56:59], v[136:139]
    ds_read_b64_tr_b16 v[110:111], v13 offset:45056
    v_mfma_f32_16x16x32_bf16 v[140:143], v[76:79], v[60:63], v[140:143]
    ds_read_b64_tr_b16 v[112:113], v14 offset:40960
    v_mfma_f32_16x16x32_bf16 v[144:147], v[76:79], v[64:67], v[144:147]
    ds_read_b64_tr_b16 v[114:115], v14 offset:45056
    v_mfma_f32_16x16x32_bf16 v[148:151], v[76:79], v[68:71], v[148:151]
    ds_read_b64_tr_b16 v[116:117], v15 offset:40960
    s_waitcnt lgkmcnt(13)
    v_mfma_f32_16x16x32_bf16 v[152:155], v[80:83], v[56:59], v[152:155]
    ds_read_b64_tr_b16 v[118:119], v15 offset:45056
    v_mfma_f32_16x16x32_bf16 v[156:159], v[80:83], v[60:63], v[156:159]
    v_mfma_f32_16x16x32_bf16 v[160:163], v[80:83], v[64:67], v[160:163]
    v_mfma_f32_16x16x32_bf16 v[164:167], v[80:83], v[68:71], v[164:167]
    s_waitcnt lgkmcnt(12)
    v_mfma_f32_16x16x32_bf16 v[168:171], v[84:87], v[56:59], v[168:171]
    v_mfma_f32_16x16x32_bf16 v[172:175], v[84:87], v[60:63], v[172:175]
    v_mfma_f32_16x16x32_bf16 v[176:179], v[84:87], v[64:67], v[176:179]
    v_mfma_f32_16x16x32_bf16 v[180:183], v[84:87], v[68:71], v[180:183]
    s_waitcnt lgkmcnt(0)
    v_mfma_f32_16x16x32_bf16 v[120:123], v[104:107], v[88:91], v[120:123]
    s_barrier
    v_mfma_f32_16x16x32_bf16 v[124:127], v[104:107], v[92:95], v[124:127]
    ds_read_b128 v[56:59], v248 offset:0
    v_mfma_f32_16x16x32_bf16 v[128:131], v[104:107], v[96:99], v[128:131]
    ds_read_b64_tr_b16 v[72:73], v249 offset:0
    v_mfma_f32_16x16x32_bf16 v[132:135], v[104:107], v[100:103], v[132:135]
    ds_read_b64_tr_b16 v[74:75], v249 offset:4096
    v_mfma_f32_16x16x32_bf16 v[136:139], v[108:111], v[88:91], v[136:139]
    ds_read_b128 v[60:63], v248 offset:1024
    v_mfma_f32_16x16x32_bf16 v[140:143], v[108:111], v[92:95], v[140:143]
    ds_read_b128 v[64:67], v248 offset:2048
    v_mfma_f32_16x16x32_bf16 v[144:147], v[108:111], v[96:99], v[144:147]
    ds_read_b128 v[68:71], v248 offset:3072
    v_mfma_f32_16x16x32_bf16 v[148:151], v[108:111], v[100:103], v[148:151]
    ds_read_b64_tr_b16 v[76:77], v250 offset:0
    v_mfma_f32_16x16x32_bf16 v[152:155], v[112:115], v[88:91], v[152:155]
    ds_read_b64_tr_b16 v[78:79], v250 offset:4096
    v_mfma_f32_16x16x32_bf16 v[156:159], v[112:115], v[92:95], v[156:159]
    ds_read_b64_tr_b16 v[80:81], v251 offset:0
    v_mfma_f32_16x16x32_bf16 v[160:163], v[112:115], v[96:99], v[160:163]
    ds_read_b64_tr_b16 v[82:83], v251 offset:4096
    v_mfma_f32_16x16x32_bf16 v[164:167], v[112:115], v[100:103], v[164:167]
    ds_read_b64_tr_b16 v[84:85], v252 offset:0
    v_mfma_f32_16x16x32_bf16 v[168:171], v[116:119], v[88:91], v[168:171]
    ds_read_b64_tr_b16 v[86:87], v252 offset:4096
    v_mfma_f32_16x16x32_bf16 v[172:175], v[116:119], v[92:95], v[172:175]
    ds_read_b64_tr_b16 v[104:105], v249 offset:8192
    v_mfma_f32_16x16x32_bf16 v[176:179], v[116:119], v[96:99], v[176:179]
    ds_read_b64_tr_b16 v[106:107], v249 offset:12288
    v_mfma_f32_16x16x32_bf16 v[180:183], v[116:119], v[100:103], v[180:183]
    ds_read_b64_tr_b16 v[108:109], v250 offset:8192
    s_waitcnt lgkmcnt(7)
    v_mfma_f32_16x16x32_bf16 v[120:123], v[72:75], v[56:59], v[120:123]
    ds_read_b128 v[88:91], v248 offset:8192
    v_mfma_f32_16x16x32_bf16 v[124:127], v[72:75], v[60:63], v[124:127]
    ds_read_b128 v[92:95], v248 offset:9216
    v_mfma_f32_16x16x32_bf16 v[128:131], v[72:75], v[64:67], v[128:131]
    ds_read_b128 v[96:99], v248 offset:10240
    v_mfma_f32_16x16x32_bf16 v[132:135], v[72:75], v[68:71], v[132:135]
    ds_read_b128 v[100:103], v248 offset:11264
    v_mfma_f32_16x16x32_bf16 v[136:139], v[76:79], v[56:59], v[136:139]
    ds_read_b64_tr_b16 v[110:111], v250 offset:12288
    v_mfma_f32_16x16x32_bf16 v[140:143], v[76:79], v[60:63], v[140:143]
    ds_read_b64_tr_b16 v[112:113], v251 offset:8192
    v_mfma_f32_16x16x32_bf16 v[144:147], v[76:79], v[64:67], v[144:147]
    ds_read_b64_tr_b16 v[114:115], v251 offset:12288
    v_mfma_f32_16x16x32_bf16 v[148:151], v[76:79], v[68:71], v[148:151]
    ds_read_b64_tr_b16 v[116:117], v252 offset:8192
    s_waitcnt lgkmcnt(13)
    v_mfma_f32_16x16x32_bf16 v[152:155], v[80:83], v[56:59], v[152:155]
    ds_read_b64_tr_b16 v[118:119], v252 offset:12288
    v_mfma_f32_16x16x32_bf16 v[156:159], v[80:83], v[60:63], v[156:159]
    v_mfma_f32_16x16x32_bf16 v[160:163], v[80:83], v[64:67], v[160:163]
    v_mfma_f32_16x16x32_bf16 v[164:167], v[80:83], v[68:71], v[164:167]
    s_waitcnt lgkmcnt(12)
    v_mfma_f32_16x16x32_bf16 v[168:171], v[84:87], v[56:59], v[168:171]
    v_mfma_f32_16x16x32_bf16 v[172:175], v[84:87], v[60:63], v[172:175]
    v_mfma_f32_16x16x32_bf16 v[176:179], v[84:87], v[64:67], v[176:179]
    v_mfma_f32_16x16x32_bf16 v[180:183], v[84:87], v[68:71], v[180:183]
    s_waitcnt lgkmcnt(0)
    v_mfma_f32_16x16x32_bf16 v[120:123], v[104:107], v[88:91], v[120:123]
    s_barrier
    v_mfma_f32_16x16x32_bf16 v[124:127], v[104:107], v[92:95], v[124:127]
    ds_read_b128 v[56:59], v6 offset:0
    v_mfma_f32_16x16x32_bf16 v[128:131], v[104:107], v[96:99], v[128:131]
    ds_read_b64_tr_b16 v[72:73], v7 offset:0
    v_mfma_f32_16x16x32_bf16 v[132:135], v[104:107], v[100:103], v[132:135]
    ds_read_b64_tr_b16 v[74:75], v7 offset:4096
    v_mfma_f32_16x16x32_bf16 v[136:139], v[108:111], v[88:91], v[136:139]
    ds_read_b128 v[60:63], v6 offset:1024
    v_mfma_f32_16x16x32_bf16 v[140:143], v[108:111], v[92:95], v[140:143]
    ds_read_b128 v[64:67], v6 offset:2048
    v_mfma_f32_16x16x32_bf16 v[144:147], v[108:111], v[96:99], v[144:147]
    ds_read_b128 v[68:71], v6 offset:3072
    v_mfma_f32_16x16x32_bf16 v[148:151], v[108:111], v[100:103], v[148:151]
    ds_read_b64_tr_b16 v[76:77], v8 offset:0
    v_mfma_f32_16x16x32_bf16 v[152:155], v[112:115], v[88:91], v[152:155]
    ds_read_b64_tr_b16 v[78:79], v8 offset:4096
    v_mfma_f32_16x16x32_bf16 v[156:159], v[112:115], v[92:95], v[156:159]
    ds_read_b64_tr_b16 v[80:81], v9 offset:0
    v_mfma_f32_16x16x32_bf16 v[160:163], v[112:115], v[96:99], v[160:163]
    ds_read_b64_tr_b16 v[82:83], v9 offset:4096
    v_mfma_f32_16x16x32_bf16 v[164:167], v[112:115], v[100:103], v[164:167]
    ds_read_b64_tr_b16 v[84:85], v10 offset:0
    v_mfma_f32_16x16x32_bf16 v[168:171], v[116:119], v[88:91], v[168:171]
    ds_read_b64_tr_b16 v[86:87], v10 offset:4096
    v_mfma_f32_16x16x32_bf16 v[172:175], v[116:119], v[92:95], v[172:175]
    ds_read_b64_tr_b16 v[104:105], v7 offset:8192
    v_mfma_f32_16x16x32_bf16 v[176:179], v[116:119], v[96:99], v[176:179]
    ds_read_b64_tr_b16 v[106:107], v7 offset:12288
    v_mfma_f32_16x16x32_bf16 v[180:183], v[116:119], v[100:103], v[180:183]
    ds_read_b64_tr_b16 v[108:109], v8 offset:8192
    s_waitcnt lgkmcnt(7)
    v_mfma_f32_16x16x32_bf16 v[120:123], v[72:75], v[56:59], v[120:123]
    ds_read_b128 v[88:91], v6 offset:8192
    v_mfma_f32_16x16x32_bf16 v[124:127], v[72:75], v[60:63], v[124:127]
    ds_read_b128 v[92:95], v6 offset:9216
    v_mfma_f32_16x16x32_bf16 v[128:131], v[72:75], v[64:67], v[128:131]
    ds_read_b128 v[96:99], v6 offset:10240
    v_mfma_f32_16x16x32_bf16 v[132:135], v[72:75], v[68:71], v[132:135]
    ds_read_b128 v[100:103], v6 offset:11264
    v_mfma_f32_16x16x32_bf16 v[136:139], v[76:79], v[56:59], v[136:139]
    ds_read_b64_tr_b16 v[110:111], v8 offset:12288
    v_mfma_f32_16x16x32_bf16 v[140:143], v[76:79], v[60:63], v[140:143]
    ds_read_b64_tr_b16 v[112:113], v9 offset:8192
    v_mfma_f32_16x16x32_bf16 v[144:147], v[76:79], v[64:67], v[144:147]
    ds_read_b64_tr_b16 v[114:115], v9 offset:12288
    v_mfma_f32_16x16x32_bf16 v[148:151], v[76:79], v[68:71], v[148:151]
    ds_read_b64_tr_b16 v[116:117], v10 offset:8192
    s_waitcnt lgkmcnt(13)
    v_mfma_f32_16x16x32_bf16 v[152:155], v[80:83], v[56:59], v[152:155]
    ds_read_b64_tr_b16 v[118:119], v10 offset:12288
    v_mfma_f32_16x16x32_bf16 v[156:159], v[80:83], v[60:63], v[156:159]
    v_mfma_f32_16x16x32_bf16 v[160:163], v[80:83], v[64:67], v[160:163]
    v_mfma_f32_16x16x32_bf16 v[164:167], v[80:83], v[68:71], v[164:167]
    s_waitcnt lgkmcnt(12)
    v_mfma_f32_16x16x32_bf16 v[168:171], v[84:87], v[56:59], v[168:171]
    v_mfma_f32_16x16x32_bf16 v[172:175], v[84:87], v[60:63], v[172:175]
    v_mfma_f32_16x16x32_bf16 v[176:179], v[84:87], v[64:67], v[176:179]
    v_mfma_f32_16x16x32_bf16 v[180:183], v[84:87], v[68:71], v[180:183]
    s_waitcnt lgkmcnt(0)
    v_mfma_f32_16x16x32_bf16 v[120:123], v[104:107], v[88:91], v[120:123]
    s_barrier
    v_mfma_f32_16x16x32_bf16 v[124:127], v[104:107], v[92:95], v[124:127]
    ds_read_b128 v[56:59], v6 offset:32768
    v_mfma_f32_16x16x32_bf16 v[128:131], v[104:107], v[96:99], v[128:131]
    ds_read_b64_tr_b16 v[72:73], v7 offset:32768
    v_mfma_f32_16x16x32_bf16 v[132:135], v[104:107], v[100:103], v[132:135]
    ds_read_b64_tr_b16 v[74:75], v7 offset:36864
    v_mfma_f32_16x16x32_bf16 v[136:139], v[108:111], v[88:91], v[136:139]
    ds_read_b128 v[60:63], v6 offset:33792
    v_mfma_f32_16x16x32_bf16 v[140:143], v[108:111], v[92:95], v[140:143]
    ds_read_b128 v[64:67], v6 offset:34816
    v_mfma_f32_16x16x32_bf16 v[144:147], v[108:111], v[96:99], v[144:147]
    ds_read_b128 v[68:71], v6 offset:35840
    v_mfma_f32_16x16x32_bf16 v[148:151], v[108:111], v[100:103], v[148:151]
    ds_read_b64_tr_b16 v[76:77], v8 offset:32768
    v_mfma_f32_16x16x32_bf16 v[152:155], v[112:115], v[88:91], v[152:155]
    ds_read_b64_tr_b16 v[78:79], v8 offset:36864
    v_mfma_f32_16x16x32_bf16 v[156:159], v[112:115], v[92:95], v[156:159]
    ds_read_b64_tr_b16 v[80:81], v9 offset:32768
    v_mfma_f32_16x16x32_bf16 v[160:163], v[112:115], v[96:99], v[160:163]
    ds_read_b64_tr_b16 v[82:83], v9 offset:36864
    v_mfma_f32_16x16x32_bf16 v[164:167], v[112:115], v[100:103], v[164:167]
    ds_read_b64_tr_b16 v[84:85], v10 offset:32768
    v_mfma_f32_16x16x32_bf16 v[168:171], v[116:119], v[88:91], v[168:171]
    ds_read_b64_tr_b16 v[86:87], v10 offset:36864
    v_mfma_f32_16x16x32_bf16 v[172:175], v[116:119], v[92:95], v[172:175]
    ds_read_b64_tr_b16 v[104:105], v7 offset:40960
    v_mfma_f32_16x16x32_bf16 v[176:179], v[116:119], v[96:99], v[176:179]
    ds_read_b64_tr_b16 v[106:107], v7 offset:45056
    v_mfma_f32_16x16x32_bf16 v[180:183], v[116:119], v[100:103], v[180:183]
    ds_read_b64_tr_b16 v[108:109], v8 offset:40960
    s_waitcnt lgkmcnt(7)
    v_mfma_f32_16x16x32_bf16 v[120:123], v[72:75], v[56:59], v[120:123]
    ds_read_b128 v[88:91], v6 offset:40960
    v_mfma_f32_16x16x32_bf16 v[124:127], v[72:75], v[60:63], v[124:127]
    ds_read_b128 v[92:95], v6 offset:41984
    v_mfma_f32_16x16x32_bf16 v[128:131], v[72:75], v[64:67], v[128:131]
    ds_read_b128 v[96:99], v6 offset:43008
    v_mfma_f32_16x16x32_bf16 v[132:135], v[72:75], v[68:71], v[132:135]
    ds_read_b128 v[100:103], v6 offset:44032
    v_mfma_f32_16x16x32_bf16 v[136:139], v[76:79], v[56:59], v[136:139]
    ds_read_b64_tr_b16 v[110:111], v8 offset:45056
    v_mfma_f32_16x16x32_bf16 v[140:143], v[76:79], v[60:63], v[140:143]
    ds_read_b64_tr_b16 v[112:113], v9 offset:40960
    v_mfma_f32_16x16x32_bf16 v[144:147], v[76:79], v[64:67], v[144:147]
    ds_read_b64_tr_b16 v[114:115], v9 offset:45056
    v_mfma_f32_16x16x32_bf16 v[148:151], v[76:79], v[68:71], v[148:151]
    ds_read_b64_tr_b16 v[116:117], v10 offset:40960
    s_waitcnt lgkmcnt(13)
    v_mfma_f32_16x16x32_bf16 v[152:155], v[80:83], v[56:59], v[152:155]
    ds_read_b64_tr_b16 v[118:119], v10 offset:45056
    v_mfma_f32_16x16x32_bf16 v[156:159], v[80:83], v[60:63], v[156:159]
    v_mfma_f32_16x16x32_bf16 v[160:163], v[80:83], v[64:67], v[160:163]
    v_mfma_f32_16x16x32_bf16 v[164:167], v[80:83], v[68:71], v[164:167]
    s_waitcnt lgkmcnt(12)
    v_mfma_f32_16x16x32_bf16 v[168:171], v[84:87], v[56:59], v[168:171]
    v_mfma_f32_16x16x32_bf16 v[172:175], v[84:87], v[60:63], v[172:175]
    v_mfma_f32_16x16x32_bf16 v[176:179], v[84:87], v[64:67], v[176:179]
    v_mfma_f32_16x16x32_bf16 v[180:183], v[84:87], v[68:71], v[180:183]
    s_waitcnt lgkmcnt(0)
    v_mfma_f32_16x16x32_bf16 v[120:123], v[104:107], v[88:91], v[120:123]
    s_barrier
    v_mfma_f32_16x16x32_bf16 v[124:127], v[104:107], v[92:95], v[124:127]
    ds_read_b128 v[56:59], v11 offset:0
    v_mfma_f32_16x16x32_bf16 v[128:131], v[104:107], v[96:99], v[128:131]
    ds_read_b64_tr_b16 v[72:73], v12 offset:0
    v_mfma_f32_16x16x32_bf16 v[132:135], v[104:107], v[100:103], v[132:135]
    ds_read_b64_tr_b16 v[74:75], v12 offset:4096
    v_mfma_f32_16x16x32_bf16 v[136:139], v[108:111], v[88:91], v[136:139]
    ds_read_b128 v[60:63], v11 offset:1024
    v_mfma_f32_16x16x32_bf16 v[140:143], v[108:111], v[92:95], v[140:143]
    ds_read_b128 v[64:67], v11 offset:2048
    v_mfma_f32_16x16x32_bf16 v[144:147], v[108:111], v[96:99], v[144:147]
    ds_read_b128 v[68:71], v11 offset:3072
    v_mfma_f32_16x16x32_bf16 v[148:151], v[108:111], v[100:103], v[148:151]
    ds_read_b64_tr_b16 v[76:77], v13 offset:0
    v_mfma_f32_16x16x32_bf16 v[152:155], v[112:115], v[88:91], v[152:155]
    ds_read_b64_tr_b16 v[78:79], v13 offset:4096
    v_mfma_f32_16x16x32_bf16 v[156:159], v[112:115], v[92:95], v[156:159]
    ds_read_b64_tr_b16 v[80:81], v14 offset:0
    v_mfma_f32_16x16x32_bf16 v[160:163], v[112:115], v[96:99], v[160:163]
    ds_read_b64_tr_b16 v[82:83], v14 offset:4096
    v_mfma_f32_16x16x32_bf16 v[164:167], v[112:115], v[100:103], v[164:167]
    ds_read_b64_tr_b16 v[84:85], v15 offset:0
    v_mfma_f32_16x16x32_bf16 v[168:171], v[116:119], v[88:91], v[168:171]
    ds_read_b64_tr_b16 v[86:87], v15 offset:4096
    v_mfma_f32_16x16x32_bf16 v[172:175], v[116:119], v[92:95], v[172:175]
    ds_read_b64_tr_b16 v[104:105], v12 offset:8192
    v_mfma_f32_16x16x32_bf16 v[176:179], v[116:119], v[96:99], v[176:179]
    ds_read_b64_tr_b16 v[106:107], v12 offset:12288
    v_mfma_f32_16x16x32_bf16 v[180:183], v[116:119], v[100:103], v[180:183]
    ds_read_b64_tr_b16 v[108:109], v13 offset:8192
    s_waitcnt lgkmcnt(7)
    v_mfma_f32_16x16x32_bf16 v[120:123], v[72:75], v[56:59], v[120:123]
    ds_read_b128 v[88:91], v11 offset:8192
    v_mfma_f32_16x16x32_bf16 v[124:127], v[72:75], v[60:63], v[124:127]
    ds_read_b128 v[92:95], v11 offset:9216
    v_mfma_f32_16x16x32_bf16 v[128:131], v[72:75], v[64:67], v[128:131]
    ds_read_b128 v[96:99], v11 offset:10240
    v_mfma_f32_16x16x32_bf16 v[132:135], v[72:75], v[68:71], v[132:135]
    ds_read_b128 v[100:103], v11 offset:11264
    v_mfma_f32_16x16x32_bf16 v[136:139], v[76:79], v[56:59], v[136:139]
    ds_read_b64_tr_b16 v[110:111], v13 offset:12288
    v_mfma_f32_16x16x32_bf16 v[140:143], v[76:79], v[60:63], v[140:143]
    ds_read_b64_tr_b16 v[112:113], v14 offset:8192
    v_mfma_f32_16x16x32_bf16 v[144:147], v[76:79], v[64:67], v[144:147]
    ds_read_b64_tr_b16 v[114:115], v14 offset:12288
    v_mfma_f32_16x16x32_bf16 v[148:151], v[76:79], v[68:71], v[148:151]
    ds_read_b64_tr_b16 v[116:117], v15 offset:8192
    s_waitcnt lgkmcnt(13)
    v_mfma_f32_16x16x32_bf16 v[152:155], v[80:83], v[56:59], v[152:155]
    ds_read_b64_tr_b16 v[118:119], v15 offset:12288
    v_mfma_f32_16x16x32_bf16 v[156:159], v[80:83], v[60:63], v[156:159]
    v_mfma_f32_16x16x32_bf16 v[160:163], v[80:83], v[64:67], v[160:163]
    v_mfma_f32_16x16x32_bf16 v[164:167], v[80:83], v[68:71], v[164:167]
    s_waitcnt lgkmcnt(12)
    v_mfma_f32_16x16x32_bf16 v[168:171], v[84:87], v[56:59], v[168:171]
    v_mfma_f32_16x16x32_bf16 v[172:175], v[84:87], v[60:63], v[172:175]
    v_mfma_f32_16x16x32_bf16 v[176:179], v[84:87], v[64:67], v[176:179]
    v_mfma_f32_16x16x32_bf16 v[180:183], v[84:87], v[68:71], v[180:183]
    s_waitcnt lgkmcnt(0)
    v_mfma_f32_16x16x32_bf16 v[120:123], v[104:107], v[88:91], v[120:123]
    s_barrier
    v_mfma_f32_16x16x32_bf16 v[124:127], v[104:107], v[92:95], v[124:127]
    ds_read_b128 v[56:59], v11 offset:32768
    v_mfma_f32_16x16x32_bf16 v[128:131], v[104:107], v[96:99], v[128:131]
    ds_read_b64_tr_b16 v[72:73], v12 offset:32768
    v_mfma_f32_16x16x32_bf16 v[132:135], v[104:107], v[100:103], v[132:135]
    ds_read_b64_tr_b16 v[74:75], v12 offset:36864
    v_mfma_f32_16x16x32_bf16 v[136:139], v[108:111], v[88:91], v[136:139]
    ds_read_b128 v[60:63], v11 offset:33792
    v_mfma_f32_16x16x32_bf16 v[140:143], v[108:111], v[92:95], v[140:143]
    ds_read_b128 v[64:67], v11 offset:34816
    v_mfma_f32_16x16x32_bf16 v[144:147], v[108:111], v[96:99], v[144:147]
    ds_read_b128 v[68:71], v11 offset:35840
    v_mfma_f32_16x16x32_bf16 v[148:151], v[108:111], v[100:103], v[148:151]
    ds_read_b64_tr_b16 v[76:77], v13 offset:32768
    v_mfma_f32_16x16x32_bf16 v[152:155], v[112:115], v[88:91], v[152:155]
    ds_read_b64_tr_b16 v[78:79], v13 offset:36864
    v_mfma_f32_16x16x32_bf16 v[156:159], v[112:115], v[92:95], v[156:159]
    ds_read_b64_tr_b16 v[80:81], v14 offset:32768
    v_mfma_f32_16x16x32_bf16 v[160:163], v[112:115], v[96:99], v[160:163]
    ds_read_b64_tr_b16 v[82:83], v14 offset:36864
    v_mfma_f32_16x16x32_bf16 v[164:167], v[112:115], v[100:103], v[164:167]
    ds_read_b64_tr_b16 v[84:85], v15 offset:32768
    v_mfma_f32_16x16x32_bf16 v[168:171], v[116:119], v[88:91], v[168:171]
    ds_read_b64_tr_b16 v[86:87], v15 offset:36864
    v_mfma_f32_16x16x32_bf16 v[172:175], v[116:119], v[92:95], v[172:175]
    ds_read_b64_tr_b16 v[104:105], v12 offset:40960
    v_mfma_f32_16x16x32_bf16 v[176:179], v[116:119], v[96:99], v[176:179]
    ds_read_b64_tr_b16 v[106:107], v12 offset:45056
    v_mfma_f32_16x16x32_bf16 v[180:183], v[116:119], v[100:103], v[180:183]
    ds_read_b64_tr_b16 v[108:109], v13 offset:40960
    s_sub_u32 s61, s61, 1
    s_cmp_lg_u32 s61, 0
    s_cbranch_scc1 LP_73
    s_waitcnt lgkmcnt(7)
    v_mfma_f32_16x16x32_bf16 v[120:123], v[72:75], v[56:59], v[120:123]
    ds_read_b128 v[88:91], v11 offset:40960
    v_mfma_f32_16x16x32_bf16 v[124:127], v[72:75], v[60:63], v[124:127]
    ds_read_b128 v[92:95], v11 offset:41984
    v_mfma_f32_16x16x32_bf16 v[128:131], v[72:75], v[64:67], v[128:131]
    ds_read_b128 v[96:99], v11 offset:43008
    v_mfma_f32_16x16x32_bf16 v[132:135], v[72:75], v[68:71], v[132:135]
    ds_read_b128 v[100:103], v11 offset:44032
    v_mfma_f32_16x16x32_bf16 v[136:139], v[76:79], v[56:59], v[136:139]
    ds_read_b64_tr_b16 v[110:111], v13 offset:45056
    v_mfma_f32_16x16x32_bf16 v[140:143], v[76:79], v[60:63], v[140:143]
    ds_read_b64_tr_b16 v[112:113], v14 offset:40960
    v_mfma_f32_16x16x32_bf16 v[144:147], v[76:79], v[64:67], v[144:147]
    ds_read_b64_tr_b16 v[114:115], v14 offset:45056
    v_mfma_f32_16x16x32_bf16 v[148:151], v[76:79], v[68:71], v[148:151]
    ds_read_b64_tr_b16 v[116:117], v15 offset:40960
    s_waitcnt lgkmcnt(13)
    v_mfma_f32_16x16x32_bf16 v[152:155], v[80:83], v[56:59], v[152:155]
    ds_read_b64_tr_b16 v[118:119], v15 offset:45056
    v_mfma_f32_16x16x32_bf16 v[156:159], v[80:83], v[60:63], v[156:159]
    v_mfma_f32_16x16x32_bf16 v[160:163], v[80:83], v[64:67], v[160:163]
    v_mfma_f32_16x16x32_bf16 v[164:167], v[80:83], v[68:71], v[164:167]
    s_waitcnt lgkmcnt(12)
    v_mfma_f32_16x16x32_bf16 v[168:171], v[84:87], v[56:59], v[168:171]
    v_mfma_f32_16x16x32_bf16 v[172:175], v[84:87], v[60:63], v[172:175]
    v_mfma_f32_16x16x32_bf16 v[176:179], v[84:87], v[64:67], v[176:179]
    v_mfma_f32_16x16x32_bf16 v[180:183], v[84:87], v[68:71], v[180:183]
    s_waitcnt lgkmcnt(0)
    v_mfma_f32_16x16x32_bf16 v[120:123], v[104:107], v[88:91], v[120:123]
    v_mfma_f32_16x16x32_bf16 v[124:127], v[104:107], v[92:95], v[124:127]
    v_mfma_f32_16x16x32_bf16 v[128:131], v[104:107], v[96:99], v[128:131]
    v_mfma_f32_16x16x32_bf16 v[132:135], v[104:107], v[100:103], v[132:135]
    v_mfma_f32_16x16x32_bf16 v[136:139], v[108:111], v[88:91], v[136:139]
    v_mfma_f32_16x16x32_bf16 v[140:143], v[108:111], v[92:95], v[140:143]
    v_mfma_f32_16x16x32_bf16 v[144:147], v[108:111], v[96:99], v[144:147]
    v_mfma_f32_16x16x32_bf16 v[148:151], v[108:111], v[100:103], v[148:151]
    v_mfma_f32_16x16x32_bf16 v[152:155], v[112:115], v[88:91], v[152:155]
    v_mfma_f32_16x16x32_bf16 v[156:159], v[112:115], v[92:95], v[156:159]
    v_mfma_f32_16x16x32_bf16 v[160:163], v[112:115], v[96:99], v[160:163]
    v_mfma_f32_16x16x32_bf16 v[164:167], v[112:115], v[100:103], v[164:167]
    v_mfma_f32_16x16x32_bf16 v[168:171], v[116:119], v[88:91], v[168:171]
    v_mfma_f32_16x16x32_bf16 v[172:175], v[116:119], v[92:95], v[172:175]
    v_mfma_f32_16x16x32_bf16 v[176:179], v[116:119], v[96:99], v[176:179]
    v_mfma_f32_16x16x32_bf16 v[180:183], v[116:119], v[100:103], v[180:183]
    s_nop 7
    v_lshlrev_b32 v26, 4, v1
    s_lshl_b32 s64, s53, 3
    s_add_u32 s64, s64, s58
    s_lshl_b32 s64, s64, 2
    s_add_u32 s64, s64, s52
    s_lshl_b32 s64, s64, 13
    s_add_u32 s64, s64, 0x1300000
    s_add_u32 s65, s64, 4096
    v_cvt_pk_bf16_f32 v184, v120, v121
    v_cvt_pk_bf16_f32 v185, v122, v123
    v_cvt_pk_bf16_f32 v186, v136, v137
    v_cvt_pk_bf16_f32 v187, v138, v139
    buffer_store_dwordx4 v[184:187], v26, s[28:31], s64 offen offset:0 sc1
    v_cvt_pk_bf16_f32 v188, v124, v125
    v_cvt_pk_bf16_f32 v189, v126, v127
    v_cvt_pk_bf16_f32 v190, v140, v141
    v_cvt_pk_bf16_f32 v191, v142, v143
    buffer_store_dwordx4 v[188:191], v26, s[28:31], s64 offen offset:1024 sc1
    v_cvt_pk_bf16_f32 v192, v128, v129
    v_cvt_pk_bf16_f32 v193, v130, v131
    v_cvt_pk_bf16_f32 v194, v144, v145
    v_cvt_pk_bf16_f32 v195, v146, v147
    buffer_store_dwordx4 v[192:195], v26, s[28:31], s64 offen offset:2048 sc1
    v_cvt_pk_bf16_f32 v196, v132, v133
    v_cvt_pk_bf16_f32 v197, v134, v135
    v_cvt_pk_bf16_f32 v198, v148, v149
    v_cvt_pk_bf16_f32 v199, v150, v151
    buffer_store_dwordx4 v[196:199], v26, s[28:31], s64 offen offset:3072 sc1
    v_cvt_pk_bf16_f32 v200, v152, v153
    v_cvt_pk_bf16_f32 v201, v154, v155
    v_cvt_pk_bf16_f32 v202, v168, v169
    v_cvt_pk_bf16_f32 v203, v170, v171
    buffer_store_dwordx4 v[200:203], v26, s[28:31], s65 offen offset:0 sc1
    v_cvt_pk_bf16_f32 v204, v156, v157
    v_cvt_pk_bf16_f32 v205, v158, v159
    v_cvt_pk_bf16_f32 v206, v172, v173
    v_cvt_pk_bf16_f32 v207, v174, v175
    buffer_store_dwordx4 v[204:207], v26, s[28:31], s65 offen offset:1024 sc1
    v_cvt_pk_bf16_f32 v208, v160, v161
    v_cvt_pk_bf16_f32 v209, v162, v163
    v_cvt_pk_bf16_f32 v210, v176, v177
    v_cvt_pk_bf16_f32 v211, v178, v179
    buffer_store_dwordx4 v[208:211], v26, s[28:31], s65 offen offset:2048 sc1
    v_cvt_pk_bf16_f32 v212, v164, v165
    v_cvt_pk_bf16_f32 v213, v166, v167
    v_cvt_pk_bf16_f32 v214, v180, v181
    v_cvt_pk_bf16_f32 v215, v182, v183
    buffer_store_dwordx4 v[212:215], v26, s[28:31], s65 offen offset:3072 sc1
    s_branch KE_71
KB_70:
    v_lshlrev_b32 v28, 16, v48
    v_and_b32 v29, 0xffff0000, v48
    v_lshlrev_b32 v30, 16, v49
    v_and_b32 v31, 0xffff0000, v49
    v_lshlrev_b32 v32, 16, v50
    v_and_b32 v33, 0xffff0000, v50
    v_lshlrev_b32 v34, 16, v51
    v_and_b32 v35, 0xffff0000, v51
    v_lshlrev_b32 v36, 16, v52
    v_and_b32 v37, 0xffff0000, v52
    v_lshlrev_b32 v38, 16, v53
    v_and_b32 v39, 0xffff0000, v53
    v_lshlrev_b32 v40, 16, v54
    v_and_b32 v41, 0xffff0000, v54
    v_lshlrev_b32 v42, 16, v55
    v_and_b32 v43, 0xffff0000, v55
    v_add_u32 v11, 65536, v6
    v_add_u32 v12, 65536, v7
    v_add_u32 v13, 65536, v8
    v_add_u32 v14, 65536, v9
    v_add_u32 v15, 65536, v10
    v_add_u32 v248, 131072, v6
    v_add_u32 v249, 131072, v7
    v_add_u32 v250, 131072, v8
    v_add_u32 v251, 131072, v9
    v_add_u32 v252, 131072, v10
    ds_read_b128 v[56:59], v11 offset:32768
    ds_read_b64_tr_b16 v[72:73], v12 offset:32768
    ds_read_b64_tr_b16 v[74:75], v12 offset:36864
    ds_read_b128 v[60:63], v11 offset:33792
    ds_read_b128 v[64:67], v11 offset:34816
    ds_read_b128 v[68:71], v11 offset:35840
    ds_read_b64_tr_b16 v[76:77], v13 offset:32768
    ds_read_b64_tr_b16 v[78:79], v13 offset:36864
    ds_read_b64_tr_b16 v[80:81], v14 offset:32768
    ds_read_b64_tr_b16 v[82:83], v14 offset:36864
    ds_read_b64_tr_b16 v[84:85], v15 offset:32768
    ds_read_b64_tr_b16 v[86:87], v15 offset:36864
    s_waitcnt lgkmcnt(0)
    v_mfma_f32_16x16x32_bf16 v[120:123], v[72:75], v[56:59], v[28:31]
    ds_read_b64_tr_b16 v[104:105], v12 offset:40960
    ds_read_b64_tr_b16 v[106:107], v12 offset:45056
    v_mfma_f32_16x16x32_bf16 v[124:127], v[72:75], v[60:63], v[28:31]
    ds_read_b128 v[88:91], v11 offset:40960
    v_mfma_f32_16x16x32_bf16 v[128:131], v[72:75], v[64:67], v[28:31]
    ds_read_b128 v[92:95], v11 offset:41984
    v_mfma_f32_16x16x32_bf16 v[132:135], v[72:75], v[68:71], v[28:31]
    ds_read_b128 v[96:99], v11 offset:43008
    ds_read_b128 v[100:103], v11 offset:44032
    v_mfma_f32_16x16x32_bf16 v[136:139], v[76:79], v[56:59], v[32:35]
    ds_read_b64_tr_b16 v[108:109], v13 offset:40960
    v_mfma_f32_16x16x32_bf16 v[140:143], v[76:79], v[60:63], v[32:35]
    ds_read_b64_tr_b16 v[110:111], v13 offset:45056
    v_mfma_f32_16x16x32_bf16 v[144:147], v[76:79], v[64:67], v[32:35]
    ds_read_b64_tr_b16 v[112:113], v14 offset:40960
    ds_read_b64_tr_b16 v[114:115], v14 offset:45056
    v_mfma_f32_16x16x32_bf16 v[148:151], v[76:79], v[68:71], v[32:35]
    ds_read_b64_tr_b16 v[116:117], v15 offset:40960
    v_mfma_f32_16x16x32_bf16 v[152:155], v[80:83], v[56:59], v[36:39]
    ds_read_b64_tr_b16 v[118:119], v15 offset:45056
    v_mfma_f32_16x16x32_bf16 v[156:159], v[80:83], v[60:63], v[36:39]
    v_mfma_f32_16x16x32_bf16 v[160:163], v[80:83], v[64:67], v[36:39]
    v_mfma_f32_16x16x32_bf16 v[164:167], v[80:83], v[68:71], v[36:39]
    v_mfma_f32_16x16x32_bf16 v[168:171], v[84:87], v[56:59], v[40:43]
    v_mfma_f32_16x16x32_bf16 v[172:175], v[84:87], v[60:63], v[40:43]
    v_mfma_f32_16x16x32_bf16 v[176:179], v[84:87], v[64:67], v[40:43]
    v_mfma_f32_16x16x32_bf16 v[180:183], v[84:87], v[68:71], v[40:43]
    s_waitcnt lgkmcnt(0)
    v_mfma_f32_16x16x32_bf16 v[120:123], v[104:107], v[88:91], v[120:123]
    s_barrier
    v_mfma_f32_16x16x32_bf16 v[124:127], v[104:107], v[92:95], v[124:127]
    ds_read_b128 v[56:59], v248 offset:0
    v_mfma_f32_16x16x32_bf16 v[128:131], v[104:107], v[96:99], v[128:131]
    ds_read_b64_tr_b16 v[72:73], v249 offset:0
    v_mfma_f32_16x16x32_bf16 v[132:135], v[104:107], v[100:103], v[132:135]
    ds_read_b64_tr_b16 v[74:75], v249 offset:4096
    v_mfma_f32_16x16x32_bf16 v[136:139], v[108:111], v[88:91], v[136:139]
    ds_read_b128 v[60:63], v248 offset:1024
    v_mfma_f32_16x16x32_bf16 v[140:143], v[108:111], v[92:95], v[140:143]
    ds_read_b128 v[64:67], v248 offset:2048
    v_mfma_f32_16x16x32_bf16 v[144:147], v[108:111], v[96:99], v[144:147]
    ds_read_b128 v[68:71], v248 offset:3072
    v_mfma_f32_16x16x32_bf16 v[148:151], v[108:111], v[100:103], v[148:151]
    ds_read_b64_tr_b16 v[76:77], v250 offset:0
    v_mfma_f32_16x16x32_bf16 v[152:155], v[112:115], v[88:91], v[152:155]
    ds_read_b64_tr_b16 v[78:79], v250 offset:4096
    v_mfma_f32_16x16x32_bf16 v[156:159], v[112:115], v[92:95], v[156:159]
    ds_read_b64_tr_b16 v[80:81], v251 offset:0
    v_mfma_f32_16x16x32_bf16 v[160:163], v[112:115], v[96:99], v[160:163]
    ds_read_b64_tr_b16 v[82:83], v251 offset:4096
    v_mfma_f32_16x16x32_bf16 v[164:167], v[112:115], v[100:103], v[164:167]
    ds_read_b64_tr_b16 v[84:85], v252 offset:0
    v_mfma_f32_16x16x32_bf16 v[168:171], v[116:119], v[88:91], v[168:171]
    ds_read_b64_tr_b16 v[86:87], v252 offset:4096
    v_mfma_f32_16x16x32_bf16 v[172:175], v[116:119], v[92:95], v[172:175]
    ds_read_b64_tr_b16 v[104:105], v249 offset:8192
    v_mfma_f32_16x16x32_bf16 v[176:179], v[116:119], v[96:99], v[176:179]
    ds_read_b64_tr_b16 v[106:107], v249 offset:12288
    v_mfma_f32_16x16x32_bf16 v[180:183], v[116:119], v[100:103], v[180:183]
    ds_read_b64_tr_b16 v[108:109], v250 offset:8192
    s_waitcnt lgkmcnt(7)
    v_mfma_f32_16x16x32_bf16 v[120:123], v[72:75], v[56:59], v[120:123]
    ds_read_b128 v[88:91], v248 offset:8192
    v_mfma_f32_16x16x32_bf16 v[124:127], v[72:75], v[60:63], v[124:127]
    ds_read_b128 v[92:95], v248 offset:9216
    v_mfma_f32_16x16x32_bf16 v[128:131], v[72:75], v[64:67], v[128:131]
    ds_read_b128 v[96:99], v248 offset:10240
    v_mfma_f32_16x16x32_bf16 v[132:135], v[72:75], v[68:71], v[132:135]
    ds_read_b128 v[100:103], v248 offset:11264
    v_mfma_f32_16x16x32_bf16 v[136:139], v[76:79], v[56:59], v[136:139]
    ds_read_b64_tr_b16 v[110:111], v250 offset:12288
    v_mfma_f32_16x16x32_bf16 v[140:143], v[76:79], v[60:63], v[140:143]
    ds_read_b64_tr_b16 v[112:113], v251 offset:8192
    v_mfma_f32_16x16x32_bf16 v[144:147], v[76:79], v[64:67], v[144:147]
    ds_read_b64_tr_b16 v[114:115], v251 offset:12288
    v_mfma_f32_16x16x32_bf16 v[148:151], v[76:79], v[68:71], v[148:151]
    ds_read_b64_tr_b16 v[116:117], v252 offset:8192
    s_waitcnt lgkmcnt(13)
    v_mfma_f32_16x16x32_bf16 v[152:155], v[80:83], v[56:59], v[152:155]
    ds_read_b64_tr_b16 v[118:119], v252 offset:12288
    v_mfma_f32_16x16x32_bf16 v[156:159], v[80:83], v[60:63], v[156:159]
    v_mfma_f32_16x16x32_bf16 v[160:163], v[80:83], v[64:67], v[160:163]
    v_mfma_f32_16x16x32_bf16 v[164:167], v[80:83], v[68:71], v[164:167]
    s_waitcnt lgkmcnt(12)
    v_mfma_f32_16x16x32_bf16 v[168:171], v[84:87], v[56:59], v[168:171]
    v_mfma_f32_16x16x32_bf16 v[172:175], v[84:87], v[60:63], v[172:175]
    v_mfma_f32_16x16x32_bf16 v[176:179], v[84:87], v[64:67], v[176:179]
    v_mfma_f32_16x16x32_bf16 v[180:183], v[84:87], v[68:71], v[180:183]
    s_waitcnt lgkmcnt(0)
    v_mfma_f32_16x16x32_bf16 v[120:123], v[104:107], v[88:91], v[120:123]
    s_barrier
    v_mfma_f32_16x16x32_bf16 v[124:127], v[104:107], v[92:95], v[124:127]
    ds_read_b128 v[56:59], v6 offset:0
    v_mfma_f32_16x16x32_bf16 v[128:131], v[104:107], v[96:99], v[128:131]
    ds_read_b64_tr_b16 v[72:73], v7 offset:0
    v_mfma_f32_16x16x32_bf16 v[132:135], v[104:107], v[100:103], v[132:135]
    ds_read_b64_tr_b16 v[74:75], v7 offset:4096
    v_mfma_f32_16x16x32_bf16 v[136:139], v[108:111], v[88:91], v[136:139]
    ds_read_b128 v[60:63], v6 offset:1024
    v_mfma_f32_16x16x32_bf16 v[140:143], v[108:111], v[92:95], v[140:143]
    ds_read_b128 v[64:67], v6 offset:2048
    v_mfma_f32_16x16x32_bf16 v[144:147], v[108:111], v[96:99], v[144:147]
    ds_read_b128 v[68:71], v6 offset:3072
    v_mfma_f32_16x16x32_bf16 v[148:151], v[108:111], v[100:103], v[148:151]
    ds_read_b64_tr_b16 v[76:77], v8 offset:0
    v_mfma_f32_16x16x32_bf16 v[152:155], v[112:115], v[88:91], v[152:155]
    ds_read_b64_tr_b16 v[78:79], v8 offset:4096
    v_mfma_f32_16x16x32_bf16 v[156:159], v[112:115], v[92:95], v[156:159]
    ds_read_b64_tr_b16 v[80:81], v9 offset:0
    v_mfma_f32_16x16x32_bf16 v[160:163], v[112:115], v[96:99], v[160:163]
    ds_read_b64_tr_b16 v[82:83], v9 offset:4096
    v_mfma_f32_16x16x32_bf16 v[164:167], v[112:115], v[100:103], v[164:167]
    ds_read_b64_tr_b16 v[84:85], v10 offset:0
    v_mfma_f32_16x16x32_bf16 v[168:171], v[116:119], v[88:91], v[168:171]
    ds_read_b64_tr_b16 v[86:87], v10 offset:4096
    v_mfma_f32_16x16x32_bf16 v[172:175], v[116:119], v[92:95], v[172:175]
    ds_read_b64_tr_b16 v[104:105], v7 offset:8192
    v_mfma_f32_16x16x32_bf16 v[176:179], v[116:119], v[96:99], v[176:179]
    ds_read_b64_tr_b16 v[106:107], v7 offset:12288
    v_mfma_f32_16x16x32_bf16 v[180:183], v[116:119], v[100:103], v[180:183]
    ds_read_b64_tr_b16 v[108:109], v8 offset:8192
    s_waitcnt lgkmcnt(7)
    v_mfma_f32_16x16x32_bf16 v[120:123], v[72:75], v[56:59], v[120:123]
    ds_read_b128 v[88:91], v6 offset:8192
    v_mfma_f32_16x16x32_bf16 v[124:127], v[72:75], v[60:63], v[124:127]
    ds_read_b128 v[92:95], v6 offset:9216
    v_mfma_f32_16x16x32_bf16 v[128:131], v[72:75], v[64:67], v[128:131]
    ds_read_b128 v[96:99], v6 offset:10240
    v_mfma_f32_16x16x32_bf16 v[132:135], v[72:75], v[68:71], v[132:135]
    ds_read_b128 v[100:103], v6 offset:11264
    v_mfma_f32_16x16x32_bf16 v[136:139], v[76:79], v[56:59], v[136:139]
    ds_read_b64_tr_b16 v[110:111], v8 offset:12288
    v_mfma_f32_16x16x32_bf16 v[140:143], v[76:79], v[60:63], v[140:143]
    ds_read_b64_tr_b16 v[112:113], v9 offset:8192
    v_mfma_f32_16x16x32_bf16 v[144:147], v[76:79], v[64:67], v[144:147]
    ds_read_b64_tr_b16 v[114:115], v9 offset:12288
    v_mfma_f32_16x16x32_bf16 v[148:151], v[76:79], v[68:71], v[148:151]
    ds_read_b64_tr_b16 v[116:117], v10 offset:8192
    s_waitcnt lgkmcnt(13)
    v_mfma_f32_16x16x32_bf16 v[152:155], v[80:83], v[56:59], v[152:155]
    ds_read_b64_tr_b16 v[118:119], v10 offset:12288
    v_mfma_f32_16x16x32_bf16 v[156:159], v[80:83], v[60:63], v[156:159]
    v_mfma_f32_16x16x32_bf16 v[160:163], v[80:83], v[64:67], v[160:163]
    v_mfma_f32_16x16x32_bf16 v[164:167], v[80:83], v[68:71], v[164:167]
    s_waitcnt lgkmcnt(12)
    v_mfma_f32_16x16x32_bf16 v[168:171], v[84:87], v[56:59], v[168:171]
    v_mfma_f32_16x16x32_bf16 v[172:175], v[84:87], v[60:63], v[172:175]
    v_mfma_f32_16x16x32_bf16 v[176:179], v[84:87], v[64:67], v[176:179]
    v_mfma_f32_16x16x32_bf16 v[180:183], v[84:87], v[68:71], v[180:183]
    s_waitcnt lgkmcnt(0)
    v_mfma_f32_16x16x32_bf16 v[120:123], v[104:107], v[88:91], v[120:123]
    s_barrier
    v_mfma_f32_16x16x32_bf16 v[124:127], v[104:107], v[92:95], v[124:127]
    ds_read_b128 v[56:59], v6 offset:32768
    v_mfma_f32_16x16x32_bf16 v[128:131], v[104:107], v[96:99], v[128:131]
    ds_read_b64_tr_b16 v[72:73], v7 offset:32768
    v_mfma_f32_16x16x32_bf16 v[132:135], v[104:107], v[100:103], v[132:135]
    ds_read_b64_tr_b16 v[74:75], v7 offset:36864
    v_mfma_f32_16x16x32_bf16 v[136:139], v[108:111], v[88:91], v[136:139]
    ds_read_b128 v[60:63], v6 offset:33792
    v_mfma_f32_16x16x32_bf16 v[140:143], v[108:111], v[92:95], v[140:143]
    ds_read_b128 v[64:67], v6 offset:34816
    v_mfma_f32_16x16x32_bf16 v[144:147], v[108:111], v[96:99], v[144:147]
    ds_read_b128 v[68:71], v6 offset:35840
    v_mfma_f32_16x16x32_bf16 v[148:151], v[108:111], v[100:103], v[148:151]
    ds_read_b64_tr_b16 v[76:77], v8 offset:32768
    v_mfma_f32_16x16x32_bf16 v[152:155], v[112:115], v[88:91], v[152:155]
    ds_read_b64_tr_b16 v[78:79], v8 offset:36864
    v_mfma_f32_16x16x32_bf16 v[156:159], v[112:115], v[92:95], v[156:159]
    ds_read_b64_tr_b16 v[80:81], v9 offset:32768
    v_mfma_f32_16x16x32_bf16 v[160:163], v[112:115], v[96:99], v[160:163]
    ds_read_b64_tr_b16 v[82:83], v9 offset:36864
    v_mfma_f32_16x16x32_bf16 v[164:167], v[112:115], v[100:103], v[164:167]
    ds_read_b64_tr_b16 v[84:85], v10 offset:32768
    v_mfma_f32_16x16x32_bf16 v[168:171], v[116:119], v[88:91], v[168:171]
    ds_read_b64_tr_b16 v[86:87], v10 offset:36864
    v_mfma_f32_16x16x32_bf16 v[172:175], v[116:119], v[92:95], v[172:175]
    ds_read_b64_tr_b16 v[104:105], v7 offset:40960
    v_mfma_f32_16x16x32_bf16 v[176:179], v[116:119], v[96:99], v[176:179]
    ds_read_b64_tr_b16 v[106:107], v7 offset:45056
    v_mfma_f32_16x16x32_bf16 v[180:183], v[116:119], v[100:103], v[180:183]
    ds_read_b64_tr_b16 v[108:109], v8 offset:40960
    s_mov_b32 s61, 6
LP_74:
    s_waitcnt lgkmcnt(7)
    v_mfma_f32_16x16x32_bf16 v[120:123], v[72:75], v[56:59], v[120:123]
    ds_read_b128 v[88:91], v6 offset:40960
    v_mfma_f32_16x16x32_bf16 v[124:127], v[72:75], v[60:63], v[124:127]
    ds_read_b128 v[92:95], v6 offset:41984
    v_mfma_f32_16x16x32_bf16 v[128:131], v[72:75], v[64:67], v[128:131]
    ds_read_b128 v[96:99], v6 offset:43008
    v_mfma_f32_16x16x32_bf16 v[132:135], v[72:75], v[68:71], v[132:135]
    ds_read_b128 v[100:103], v6 offset:44032
    v_mfma_f32_16x16x32_bf16 v[136:139], v[76:79], v[56:59], v[136:139]
    ds_read_b64_tr_b16 v[110:111], v8 offset:45056
    v_mfma_f32_16x16x32_bf16 v[140:143], v[76:79], v[60:63], v[140:143]
    ds_read_b64_tr_b16 v[112:113], v9 offset:40960
    v_mfma_f32_16x16x32_bf16 v[144:147], v[76:79], v[64:67], v[144:147]
    ds_read_b64_tr_b16 v[114:115], v9 offset:45056
    v_mfma_f32_16x16x32_bf16 v[148:151], v[76:79], v[68:71], v[148:151]
    ds_read_b64_tr_b16 v[116:117], v10 offset:40960
    s_waitcnt lgkmcnt(13)
    v_mfma_f32_16x16x32_bf16 v[152:155], v[80:83], v[56:59], v[152:155]
    ds_read_b64_tr_b16 v[118:119], v10 offset:45056
    v_mfma_f32_16x16x32_bf16 v[156:159], v[80:83], v[60:63], v[156:159]
    v_mfma_f32_16x16x32_bf16 v[160:163], v[80:83], v[64:67], v[160:163]
    v_mfma_f32_16x16x32_bf16 v[164:167], v[80:83], v[68:71], v[164:167]
    s_waitcnt lgkmcnt(12)
    v_mfma_f32_16x16x32_bf16 v[168:171], v[84:87], v[56:59], v[168:171]
    v_mfma_f32_16x16x32_bf16 v[172:175], v[84:87], v[60:63], v[172:175]
    v_mfma_f32_16x16x32_bf16 v[176:179], v[84:87], v[64:67], v[176:179]
    v_mfma_f32_16x16x32_bf16 v[180:183], v[84:87], v[68:71], v[180:183]
    s_waitcnt lgkmcnt(0)
    v_mfma_f32_16x16x32_bf16 v[120:123], v[104:107], v[88:91], v[120:123]
    s_waitcnt vmcnt(0)
    s_barrier
    v_mfma_f32_16x16x32_bf16 v[124:127], v[104:107], v[92:95], v[124:127]
    ds_read_b128 v[56:59], v11 offset:0
    v_mfma_f32_16x16x32_bf16 v[128:131], v[104:107], v[96:99], v[128:131]
    ds_read_b64_tr_b16 v[72:73], v12 offset:0
    v_mfma_f32_16x16x32_bf16 v[132:135], v[104:107], v[100:103], v[132:135]
    ds_read_b64_tr_b16 v[74:75], v12 offset:4096
    v_mfma_f32_16x16x32_bf16 v[136:139], v[108:111], v[88:91], v[136:139]
    ds_read_b128 v[60:63], v11 offset:1024
    v_mfma_f32_16x16x32_bf16 v[140:143], v[108:111], v[92:95], v[140:143]
    ds_read_b128 v[64:67], v11 offset:2048
    v_mfma_f32_16x16x32_bf16 v[144:147], v[108:111], v[96:99], v[144:147]
    ds_read_b128 v[68:71], v11 offset:3072
    v_mfma_f32_16x16x32_bf16 v[148:151], v[108:111], v[100:103], v[148:151]
    ds_read_b64_tr_b16 v[76:77], v13 offset:0
    v_mfma_f32_16x16x32_bf16 v[152:155], v[112:115], v[88:91], v[152:155]
    ds_read_b64_tr_b16 v[78:79], v13 offset:4096
    v_mfma_f32_16x16x32_bf16 v[156:159], v[112:115], v[92:95], v[156:159]
    ds_read_b64_tr_b16 v[80:81], v14 offset:0
    v_mfma_f32_16x16x32_bf16 v[160:163], v[112:115], v[96:99], v[160:163]
    ds_read_b64_tr_b16 v[82:83], v14 offset:4096
    v_mfma_f32_16x16x32_bf16 v[164:167], v[112:115], v[100:103], v[164:167]
    ds_read_b64_tr_b16 v[84:85], v15 offset:0
    v_mfma_f32_16x16x32_bf16 v[168:171], v[116:119], v[88:91], v[168:171]
    ds_read_b64_tr_b16 v[86:87], v15 offset:4096
    v_mfma_f32_16x16x32_bf16 v[172:175], v[116:119], v[92:95], v[172:175]
    ds_read_b64_tr_b16 v[104:105], v12 offset:8192
    v_mfma_f32_16x16x32_bf16 v[176:179], v[116:119], v[96:99], v[176:179]
    ds_read_b64_tr_b16 v[106:107], v12 offset:12288
    v_mfma_f32_16x16x32_bf16 v[180:183], v[116:119], v[100:103], v[180:183]
    ds_read_b64_tr_b16 v[108:109], v13 offset:8192
    s_waitcnt lgkmcnt(7)
    v_mfma_f32_16x16x32_bf16 v[120:123], v[72:75], v[56:59], v[120:123]
    ds_read_b128 v[88:91], v11 offset:8192
    v_mfma_f32_16x16x32_bf16 v[124:127], v[72:75], v[60:63], v[124:127]
    ds_read_b128 v[92:95], v11 offset:9216
    v_mfma_f32_16x16x32_bf16 v[128:131], v[72:75], v[64:67], v[128:131]
    ds_read_b128 v[96:99], v11 offset:10240
    v_mfma_f32_16x16x32_bf16 v[132:135], v[72:75], v[68:71], v[132:135]
    ds_read_b128 v[100:103], v11 offset:11264
    v_mfma_f32_16x16x32_bf16 v[136:139], v[76:79], v[56:59], v[136:139]
    ds_read_b64_tr_b16 v[110:111], v13 offset:12288
    v_mfma_f32_16x16x32_bf16 v[140:143], v[76:79], v[60:63], v[140:143]
    ds_read_b64_tr_b16 v[112:113], v14 offset:8192
    v_mfma_f32_16x16x32_bf16 v[144:147], v[76:79], v[64:67], v[144:147]
    ds_read_b64_tr_b16 v[114:115], v14 offset:12288
    v_mfma_f32_16x16x32_bf16 v[148:151], v[76:79], v[68:71], v[148:151]
    ds_read_b64_tr_b16 v[116:117], v15 offset:8192
    s_waitcnt lgkmcnt(13)
    v_mfma_f32_16x16x32_bf16 v[152:155], v[80:83], v[56:59], v[152:155]
    ds_read_b64_tr_b16 v[118:119], v15 offset:12288
    v_mfma_f32_16x16x32_bf16 v[156:159], v[80:83], v[60:63], v[156:159]
    v_mfma_f32_16x16x32_bf16 v[160:163], v[80:83], v[64:67], v[160:163]
    v_mfma_f32_16x16x32_bf16 v[164:167], v[80:83], v[68:71], v[164:167]
    s_waitcnt lgkmcnt(12)
    v_mfma_f32_16x16x32_bf16 v[168:171], v[84:87], v[56:59], v[168:171]
    v_mfma_f32_16x16x32_bf16 v[172:175], v[84:87], v[60:63], v[172:175]
    v_mfma_f32_16x16x32_bf16 v[176:179], v[84:87], v[64:67], v[176:179]
    v_mfma_f32_16x16x32_bf16 v[180:183], v[84:87], v[68:71], v[180:183]
    s_waitcnt lgkmcnt(0)
    v_mfma_f32_16x16x32_bf16 v[120:123], v[104:107], v[88:91], v[120:123]
    s_barrier
    v_mfma_f32_16x16x32_bf16 v[124:127], v[104:107], v[92:95], v[124:127]
    ds_read_b128 v[56:59], v11 offset:32768
    v_mfma_f32_16x16x32_bf16 v[128:131], v[104:107], v[96:99], v[128:131]
    ds_read_b64_tr_b16 v[72:73], v12 offset:32768
    v_mfma_f32_16x16x32_bf16 v[132:135], v[104:107], v[100:103], v[132:135]
    ds_read_b64_tr_b16 v[74:75], v12 offset:36864
    v_mfma_f32_16x16x32_bf16 v[136:139], v[108:111], v[88:91], v[136:139]
    ds_read_b128 v[60:63], v11 offset:33792
    v_mfma_f32_16x16x32_bf16 v[140:143], v[108:111], v[92:95], v[140:143]
    ds_read_b128 v[64:67], v11 offset:34816
    v_mfma_f32_16x16x32_bf16 v[144:147], v[108:111], v[96:99], v[144:147]
    ds_read_b128 v[68:71], v11 offset:35840
    v_mfma_f32_16x16x32_bf16 v[148:151], v[108:111], v[100:103], v[148:151]
    ds_read_b64_tr_b16 v[76:77], v13 offset:32768
    v_mfma_f32_16x16x32_bf16 v[152:155], v[112:115], v[88:91], v[152:155]
    ds_read_b64_tr_b16 v[78:79], v13 offset:36864
    v_mfma_f32_16x16x32_bf16 v[156:159], v[112:115], v[92:95], v[156:159]
    ds_read_b64_tr_b16 v[80:81], v14 offset:32768
    v_mfma_f32_16x16x32_bf16 v[160:163], v[112:115], v[96:99], v[160:163]
    ds_read_b64_tr_b16 v[82:83], v14 offset:36864
    v_mfma_f32_16x16x32_bf16 v[164:167], v[112:115], v[100:103], v[164:167]
    ds_read_b64_tr_b16 v[84:85], v15 offset:32768
    v_mfma_f32_16x16x32_bf16 v[168:171], v[116:119], v[88:91], v[168:171]
    ds_read_b64_tr_b16 v[86:87], v15 offset:36864
    v_mfma_f32_16x16x32_bf16 v[172:175], v[116:119], v[92:95], v[172:175]
    ds_read_b64_tr_b16 v[104:105], v12 offset:40960
    v_mfma_f32_16x16x32_bf16 v[176:179], v[116:119], v[96:99], v[176:179]
    ds_read_b64_tr_b16 v[106:107], v12 offset:45056
    v_mfma_f32_16x16x32_bf16 v[180:183], v[116:119], v[100:103], v[180:183]
    ds_read_b64_tr_b16 v[108:109], v13 offset:40960
    s_waitcnt lgkmcnt(7)
    v_mfma_f32_16x16x32_bf16 v[120:123], v[72:75], v[56:59], v[120:123]
    ds_read_b128 v[88:91], v11 offset:40960
    v_mfma_f32_16x16x32_bf16 v[124:127], v[72:75], v[60:63], v[124:127]
    ds_read_b128 v[92:95], v11 offset:41984
    v_mfma_f32_16x16x32_bf16 v[128:131], v[72:75], v[64:67], v[128:131]
    ds_read_b128 v[96:99], v11 offset:43008
    v_mfma_f32_16x16x32_bf16 v[132:135], v[72:75], v[68:71], v[132:135]
    ds_read_b128 v[100:103], v11 offset:44032
    v_mfma_f32_16x16x32_bf16 v[136:139], v[76:79], v[56:59], v[136:139]
    ds_read_b64_tr_b16 v[110:111], v13 offset:45056
    v_mfma_f32_16x16x32_bf16 v[140:143], v[76:79], v[60:63], v[140:143]
    ds_read_b64_tr_b16 v[112:113], v14 offset:40960
    v_mfma_f32_16x16x32_bf16 v[144:147], v[76:79], v[64:67], v[144:147]
    ds_read_b64_tr_b16 v[114:115], v14 offset:45056
    v_mfma_f32_16x16x32_bf16 v[148:151], v[76:79], v[68:71], v[148:151]
    ds_read_b64_tr_b16 v[116:117], v15 offset:40960
    s_waitcnt lgkmcnt(13)
    v_mfma_f32_16x16x32_bf16 v[152:155], v[80:83], v[56:59], v[152:155]
    ds_read_b64_tr_b16 v[118:119], v15 offset:45056
    v_mfma_f32_16x16x32_bf16 v[156:159], v[80:83], v[60:63], v[156:159]
    v_mfma_f32_16x16x32_bf16 v[160:163], v[80:83], v[64:67], v[160:163]
    v_mfma_f32_16x16x32_bf16 v[164:167], v[80:83], v[68:71], v[164:167]
    s_waitcnt lgkmcnt(12)
    v_mfma_f32_16x16x32_bf16 v[168:171], v[84:87], v[56:59], v[168:171]
    v_mfma_f32_16x16x32_bf16 v[172:175], v[84:87], v[60:63], v[172:175]
    v_mfma_f32_16x16x32_bf16 v[176:179], v[84:87], v[64:67], v[176:179]
    v_mfma_f32_16x16x32_bf16 v[180:183], v[84:87], v[68:71], v[180:183]
    s_waitcnt lgkmcnt(0)
    v_mfma_f32_16x16x32_bf16 v[120:123], v[104:107], v[88:91], v[120:123]
    s_barrier
    v_mfma_f32_16x16x32_bf16 v[124:127], v[104:107], v[92:95], v[124:127]
    ds_read_b128 v[56:59], v248 offset:0
    v_mfma_f32_16x16x32_bf16 v[128:131], v[104:107], v[96:99], v[128:131]
    ds_read_b64_tr_b16 v[72:73], v249 offset:0
    v_mfma_f32_16x16x32_bf16 v[132:135], v[104:107], v[100:103], v[132:135]
    ds_read_b64_tr_b16 v[74:75], v249 offset:4096
    v_mfma_f32_16x16x32_bf16 v[136:139], v[108:111], v[88:91], v[136:139]
    ds_read_b128 v[60:63], v248 offset:1024
    v_mfma_f32_16x16x32_bf16 v[140:143], v[108:111], v[92:95], v[140:143]
    ds_read_b128 v[64:67], v248 offset:2048
    v_mfma_f32_16x16x32_bf16 v[144:147], v[108:111], v[96:99], v[144:147]
    ds_read_b128 v[68:71], v248 offset:3072
    v_mfma_f32_16x16x32_bf16 v[148:151], v[108:111], v[100:103], v[148:151]
    ds_read_b64_tr_b16 v[76:77], v250 offset:0
    v_mfma_f32_16x16x32_bf16 v[152:155], v[112:115], v[88:91], v[152:155]
    ds_read_b64_tr_b16 v[78:79], v250 offset:4096
    v_mfma_f32_16x16x32_bf16 v[156:159], v[112:115], v[92:95], v[156:159]
    ds_read_b64_tr_b16 v[80:81], v251 offset:0
    v_mfma_f32_16x16x32_bf16 v[160:163], v[112:115], v[96:99], v[160:163]
    ds_read_b64_tr_b16 v[82:83], v251 offset:4096
    v_mfma_f32_16x16x32_bf16 v[164:167], v[112:115], v[100:103], v[164:167]
    ds_read_b64_tr_b16 v[84:85], v252 offset:0
    v_mfma_f32_16x16x32_bf16 v[168:171], v[116:119], v[88:91], v[168:171]
    ds_read_b64_tr_b16 v[86:87], v252 offset:4096
    v_mfma_f32_16x16x32_bf16 v[172:175], v[116:119], v[92:95], v[172:175]
    ds_read_b64_tr_b16 v[104:105], v249 offset:8192
    v_mfma_f32_16x16x32_bf16 v[176:179], v[116:119], v[96:99], v[176:179]
    ds_read_b64_tr_b16 v[106:107], v249 offset:12288
    v_mfma_f32_16x16x32_bf16 v[180:183], v[116:119], v[100:103], v[180:183]
    ds_read_b64_tr_b16 v[108:109], v250 offset:8192
    s_waitcnt lgkmcnt(7)
    v_mfma_f32_16x16x32_bf16 v[120:123], v[72:75], v[56:59], v[120:123]
    ds_read_b128 v[88:91], v248 offset:8192
    v_mfma_f32_16x16x32_bf16 v[124:127], v[72:75], v[60:63], v[124:127]
    ds_read_b128 v[92:95], v248 offset:9216
    v_mfma_f32_16x16x32_bf16 v[128:131], v[72:75], v[64:67], v[128:131]
    ds_read_b128 v[96:99], v248 offset:10240
    v_mfma_f32_16x16x32_bf16 v[132:135], v[72:75], v[68:71], v[132:135]
    ds_read_b128 v[100:103], v248 offset:11264
    v_mfma_f32_16x16x32_bf16 v[136:139], v[76:79], v[56:59], v[136:139]
    ds_read_b64_tr_b16 v[110:111], v250 offset:12288
    v_mfma_f32_16x16x32_bf16 v[140:143], v[76:79], v[60:63], v[140:143]
    ds_read_b64_tr_b16 v[112:113], v251 offset:8192
    v_mfma_f32_16x16x32_bf16 v[144:147], v[76:79], v[64:67], v[144:147]
    ds_read_b64_tr_b16 v[114:115], v251 offset:12288
    v_mfma_f32_16x16x32_bf16 v[148:151], v[76:79], v[68:71], v[148:151]
    ds_read_b64_tr_b16 v[116:117], v252 offset:8192
    s_waitcnt lgkmcnt(13)
    v_mfma_f32_16x16x32_bf16 v[152:155], v[80:83], v[56:59], v[152:155]
    ds_read_b64_tr_b16 v[118:119], v252 offset:12288
    v_mfma_f32_16x16x32_bf16 v[156:159], v[80:83], v[60:63], v[156:159]
    v_mfma_f32_16x16x32_bf16 v[160:163], v[80:83], v[64:67], v[160:163]
    v_mfma_f32_16x16x32_bf16 v[164:167], v[80:83], v[68:71], v[164:167]
    s_waitcnt lgkmcnt(12)
    v_mfma_f32_16x16x32_bf16 v[168:171], v[84:87], v[56:59], v[168:171]
    v_mfma_f32_16x16x32_bf16 v[172:175], v[84:87], v[60:63], v[172:175]
    v_mfma_f32_16x16x32_bf16 v[176:179], v[84:87], v[64:67], v[176:179]
    v_mfma_f32_16x16x32_bf16 v[180:183], v[84:87], v[68:71], v[180:183]
    s_waitcnt lgkmcnt(0)
    v_mfma_f32_16x16x32_bf16 v[120:123], v[104:107], v[88:91], v[120:123]
    s_barrier
    v_mfma_f32_16x16x32_bf16 v[124:127], v[104:107], v[92:95], v[124:127]
    ds_read_b128 v[56:59], v6 offset:0
    v_mfma_f32_16x16x32_bf16 v[128:131], v[104:107], v[96:99], v[128:131]
    ds_read_b64_tr_b16 v[72:73], v7 offset:0
    v_mfma_f32_16x16x32_bf16 v[132:135], v[104:107], v[100:103], v[132:135]
    ds_read_b64_tr_b16 v[74:75], v7 offset:4096
    v_mfma_f32_16x16x32_bf16 v[136:139], v[108:111], v[88:91], v[136:139]
    ds_read_b128 v[60:63], v6 offset:1024
    v_mfma_f32_16x16x32_bf16 v[140:143], v[108:111], v[92:95], v[140:143]
    ds_read_b128 v[64:67], v6 offset:2048
    v_mfma_f32_16x16x32_bf16 v[144:147], v[108:111], v[96:99], v[144:147]
    ds_read_b128 v[68:71], v6 offset:3072
    v_mfma_f32_16x16x32_bf16 v[148:151], v[108:111], v[100:103], v[148:151]
    ds_read_b64_tr_b16 v[76:77], v8 offset:0
    v_mfma_f32_16x16x32_bf16 v[152:155], v[112:115], v[88:91], v[152:155]
    ds_read_b64_tr_b16 v[78:79], v8 offset:4096
    v_mfma_f32_16x16x32_bf16 v[156:159], v[112:115], v[92:95], v[156:159]
    ds_read_b64_tr_b16 v[80:81], v9 offset:0
    v_mfma_f32_16x16x32_bf16 v[160:163], v[112:115], v[96:99], v[160:163]
    ds_read_b64_tr_b16 v[82:83], v9 offset:4096
    v_mfma_f32_16x16x32_bf16 v[164:167], v[112:115], v[100:103], v[164:167]
    ds_read_b64_tr_b16 v[84:85], v10 offset:0
    v_mfma_f32_16x16x32_bf16 v[168:171], v[116:119], v[88:91], v[168:171]
    ds_read_b64_tr_b16 v[86:87], v10 offset:4096
    v_mfma_f32_16x16x32_bf16 v[172:175], v[116:119], v[92:95], v[172:175]
    ds_read_b64_tr_b16 v[104:105], v7 offset:8192
    v_mfma_f32_16x16x32_bf16 v[176:179], v[116:119], v[96:99], v[176:179]
    ds_read_b64_tr_b16 v[106:107], v7 offset:12288
    v_mfma_f32_16x16x32_bf16 v[180:183], v[116:119], v[100:103], v[180:183]
    ds_read_b64_tr_b16 v[108:109], v8 offset:8192
    s_waitcnt lgkmcnt(7)
    v_mfma_f32_16x16x32_bf16 v[120:123], v[72:75], v[56:59], v[120:123]
    ds_read_b128 v[88:91], v6 offset:8192
    v_mfma_f32_16x16x32_bf16 v[124:127], v[72:75], v[60:63], v[124:127]
    ds_read_b128 v[92:95], v6 offset:9216
    v_mfma_f32_16x16x32_bf16 v[128:131], v[72:75], v[64:67], v[128:131]
    ds_read_b128 v[96:99], v6 offset:10240
    v_mfma_f32_16x16x32_bf16 v[132:135], v[72:75], v[68:71], v[132:135]
    ds_read_b128 v[100:103], v6 offset:11264
    v_mfma_f32_16x16x32_bf16 v[136:139], v[76:79], v[56:59], v[136:139]
    ds_read_b64_tr_b16 v[110:111], v8 offset:12288
    v_mfma_f32_16x16x32_bf16 v[140:143], v[76:79], v[60:63], v[140:143]
    ds_read_b64_tr_b16 v[112:113], v9 offset:8192
    v_mfma_f32_16x16x32_bf16 v[144:147], v[76:79], v[64:67], v[144:147]
    ds_read_b64_tr_b16 v[114:115], v9 offset:12288
    v_mfma_f32_16x16x32_bf16 v[148:151], v[76:79], v[68:71], v[148:151]
    ds_read_b64_tr_b16 v[116:117], v10 offset:8192
    s_waitcnt lgkmcnt(13)
    v_mfma_f32_16x16x32_bf16 v[152:155], v[80:83], v[56:59], v[152:155]
    ds_read_b64_tr_b16 v[118:119], v10 offset:12288
    v_mfma_f32_16x16x32_bf16 v[156:159], v[80:83], v[60:63], v[156:159]
    v_mfma_f32_16x16x32_bf16 v[160:163], v[80:83], v[64:67], v[160:163]
    v_mfma_f32_16x16x32_bf16 v[164:167], v[80:83], v[68:71], v[164:167]
    s_waitcnt lgkmcnt(12)
    v_mfma_f32_16x16x32_bf16 v[168:171], v[84:87], v[56:59], v[168:171]
    v_mfma_f32_16x16x32_bf16 v[172:175], v[84:87], v[60:63], v[172:175]
    v_mfma_f32_16x16x32_bf16 v[176:179], v[84:87], v[64:67], v[176:179]
    v_mfma_f32_16x16x32_bf16 v[180:183], v[84:87], v[68:71], v[180:183]
    s_waitcnt lgkmcnt(0)
    v_mfma_f32_16x16x32_bf16 v[120:123], v[104:107], v[88:91], v[120:123]
    s_barrier
    v_mfma_f32_16x16x32_bf16 v[124:127], v[104:107], v[92:95], v[124:127]
    ds_read_b128 v[56:59], v6 offset:32768
    v_mfma_f32_16x16x32_bf16 v[128:131], v[104:107], v[96:99], v[128:131]
    ds_read_b64_tr_b16 v[72:73], v7 offset:32768
    v_mfma_f32_16x16x32_bf16 v[132:135], v[104:107], v[100:103], v[132:135]
    ds_read_b64_tr_b16 v[74:75], v7 offset:36864
    v_mfma_f32_16x16x32_bf16 v[136:139], v[108:111], v[88:91], v[136:139]
    ds_read_b128 v[60:63], v6 offset:33792
    v_mfma_f32_16x16x32_bf16 v[140:143], v[108:111], v[92:95], v[140:143]
    ds_read_b128 v[64:67], v6 offset:34816
    v_mfma_f32_16x16x32_bf16 v[144:147], v[108:111], v[96:99], v[144:147]
    ds_read_b128 v[68:71], v6 offset:35840
    v_mfma_f32_16x16x32_bf16 v[148:151], v[108:111], v[100:103], v[148:151]
    ds_read_b64_tr_b16 v[76:77], v8 offset:32768
    v_mfma_f32_16x16x32_bf16 v[152:155], v[112:115], v[88:91], v[152:155]
    ds_read_b64_tr_b16 v[78:79], v8 offset:36864
    v_mfma_f32_16x16x32_bf16 v[156:159], v[112:115], v[92:95], v[156:159]
    ds_read_b64_tr_b16 v[80:81], v9 offset:32768
    v_mfma_f32_16x16x32_bf16 v[160:163], v[112:115], v[96:99], v[160:163]
    ds_read_b64_tr_b16 v[82:83], v9 offset:36864
    v_mfma_f32_16x16x32_bf16 v[164:167], v[112:115], v[100:103], v[164:167]
    ds_read_b64_tr_b16 v[84:85], v10 offset:32768
    v_mfma_f32_16x16x32_bf16 v[168:171], v[116:119], v[88:91], v[168:171]
    ds_read_b64_tr_b16 v[86:87], v10 offset:36864
    v_mfma_f32_16x16x32_bf16 v[172:175], v[116:119], v[92:95], v[172:175]
    ds_read_b64_tr_b16 v[104:105], v7 offset:40960
    v_mfma_f32_16x16x32_bf16 v[176:179], v[116:119], v[96:99], v[176:179]
    ds_read_b64_tr_b16 v[106:107], v7 offset:45056
    v_mfma_f32_16x16x32_bf16 v[180:183], v[116:119], v[100:103], v[180:183]
    ds_read_b64_tr_b16 v[108:109], v8 offset:40960
    s_sub_u32 s61, s61, 1
    s_cmp_lg_u32 s61, 0
    s_cbranch_scc1 LP_74
    s_waitcnt lgkmcnt(7)
    v_mfma_f32_16x16x32_bf16 v[120:123], v[72:75], v[56:59], v[120:123]
    ds_read_b128 v[88:91], v6 offset:40960
    v_mfma_f32_16x16x32_bf16 v[124:127], v[72:75], v[60:63], v[124:127]
    ds_read_b128 v[92:95], v6 offset:41984
    v_mfma_f32_16x16x32_bf16 v[128:131], v[72:75], v[64:67], v[128:131]
    ds_read_b128 v[96:99], v6 offset:43008
    v_mfma_f32_16x16x32_bf16 v[132:135], v[72:75], v[68:71], v[132:135]
    ds_read_b128 v[100:103], v6 offset:44032
    v_mfma_f32_16x16x32_bf16 v[136:139], v[76:79], v[56:59], v[136:139]
    ds_read_b64_tr_b16 v[110:111], v8 offset:45056
    v_mfma_f32_16x16x32_bf16 v[140:143], v[76:79], v[60:63], v[140:143]
    ds_read_b64_tr_b16 v[112:113], v9 offset:40960
    v_mfma_f32_16x16x32_bf16 v[144:147], v[76:79], v[64:67], v[144:147]
    ds_read_b64_tr_b16 v[114:115], v9 offset:45056
    v_mfma_f32_16x16x32_bf16 v[148:151], v[76:79], v[68:71], v[148:151]
    ds_read_b64_tr_b16 v[116:117], v10 offset:40960
    s_waitcnt lgkmcnt(13)
    v_mfma_f32_16x16x32_bf16 v[152:155], v[80:83], v[56:59], v[152:155]
    ds_read_b64_tr_b16 v[118:119], v10 offset:45056
    v_mfma_f32_16x16x32_bf16 v[156:159], v[80:83], v[60:63], v[156:159]
    v_mfma_f32_16x16x32_bf16 v[160:163], v[80:83], v[64:67], v[160:163]
    v_mfma_f32_16x16x32_bf16 v[164:167], v[80:83], v[68:71], v[164:167]
    s_waitcnt lgkmcnt(12)
    v_mfma_f32_16x16x32_bf16 v[168:171], v[84:87], v[56:59], v[168:171]
    v_mfma_f32_16x16x32_bf16 v[172:175], v[84:87], v[60:63], v[172:175]
    v_mfma_f32_16x16x32_bf16 v[176:179], v[84:87], v[64:67], v[176:179]
    v_mfma_f32_16x16x32_bf16 v[180:183], v[84:87], v[68:71], v[180:183]
    s_waitcnt lgkmcnt(0)
    v_mfma_f32_16x16x32_bf16 v[120:123], v[104:107], v[88:91], v[120:123]
    s_barrier
    v_mfma_f32_16x16x32_bf16 v[124:127], v[104:107], v[92:95], v[124:127]
    ds_read_b128 v[56:59], v11 offset:0
    v_mfma_f32_16x16x32_bf16 v[128:131], v[104:107], v[96:99], v[128:131]
    ds_read_b64_tr_b16 v[72:73], v12 offset:0
    v_mfma_f32_16x16x32_bf16 v[132:135], v[104:107], v[100:103], v[132:135]
    ds_read_b64_tr_b16 v[74:75], v12 offset:4096
    v_mfma_f32_16x16x32_bf16 v[136:139], v[108:111], v[88:91], v[136:139]
    ds_read_b128 v[60:63], v11 offset:1024
    v_mfma_f32_16x16x32_bf16 v[140:143], v[108:111], v[92:95], v[140:143]
    ds_read_b128 v[64:67], v11 offset:2048
    v_mfma_f32_16x16x32_bf16 v[144:147], v[108:111], v[96:99], v[144:147]
    ds_read_b128 v[68:71], v11 offset:3072
    v_mfma_f32_16x16x32_bf16 v[148:151], v[108:111], v[100:103], v[148:151]
    ds_read_b64_tr_b16 v[76:77], v13 offset:0
    v_mfma_f32_16x16x32_bf16 v[152:155], v[112:115], v[88:91], v[152:155]
    ds_read_b64_tr_b16 v[78:79], v13 offset:4096
    v_mfma_f32_16x16x32_bf16 v[156:159], v[112:115], v[92:95], v[156:159]
    ds_read_b64_tr_b16 v[80:81], v14 offset:0
    v_mfma_f32_16x16x32_bf16 v[160:163], v[112:115], v[96:99], v[160:163]
    ds_read_b64_tr_b16 v[82:83], v14 offset:4096
    v_mfma_f32_16x16x32_bf16 v[164:167], v[112:115], v[100:103], v[164:167]
    ds_read_b64_tr_b16 v[84:85], v15 offset:0
    v_mfma_f32_16x16x32_bf16 v[168:171], v[116:119], v[88:91], v[168:171]
    ds_read_b64_tr_b16 v[86:87], v15 offset:4096
    v_mfma_f32_16x16x32_bf16 v[172:175], v[116:119], v[92:95], v[172:175]
    ds_read_b64_tr_b16 v[104:105], v12 offset:8192
    v_mfma_f32_16x16x32_bf16 v[176:179], v[116:119], v[96:99], v[176:179]
    ds_read_b64_tr_b16 v[106:107], v12 offset:12288
    v_mfma_f32_16x16x32_bf16 v[180:183], v[116:119], v[100:103], v[180:183]
    ds_read_b64_tr_b16 v[108:109], v13 offset:8192
    v_lshlrev_b32 v26, 4, v1
    s_lshl_b32 s64, s53, 3
    s_add_u32 s64, s64, s58
    s_lshl_b32 s64, s64, 2
    s_add_u32 s64, s64, s52
    s_lshl_b32 s64, s64, 13
    s_add_u32 s64, s64, 0x1300000
    s_add_u32 s65, s64, 4096
    s_waitcnt lgkmcnt(7)
    v_mfma_f32_16x16x32_bf16 v[120:123], v[72:75], v[56:59], v[120:123]
    ds_read_b128 v[88:91], v11 offset:8192
    buffer_load_dwordx4 v[184:187], v26, s[28:31], s64 offen offset:0 sc1
    v_mfma_f32_16x16x32_bf16 v[124:127], v[72:75], v[60:63], v[124:127]
    ds_read_b128 v[92:95], v11 offset:9216
    v_mfma_f32_16x16x32_bf16 v[128:131], v[72:75], v[64:67], v[128:131]
    ds_read_b128 v[96:99], v11 offset:10240
    buffer_load_dwordx4 v[188:191], v26, s[28:31], s64 offen offset:1024 sc1
    v_mfma_f32_16x16x32_bf16 v[132:135], v[72:75], v[68:71], v[132:135]
    ds_read_b128 v[100:103], v11 offset:11264
    v_mfma_f32_16x16x32_bf16 v[136:139], v[76:79], v[56:59], v[136:139]
    ds_read_b64_tr_b16 v[110:111], v13 offset:12288
    buffer_load_dwordx4 v[192:195], v26, s[28:31], s64 offen offset:2048 sc1
    v_mfma_f32_16x16x32_bf16 v[140:143], v[76:79], v[60:63], v[140:143]
    ds_read_b64_tr_b16 v[112:113], v14 offset:8192
    v_mfma_f32_16x16x32_bf16 v[144:147], v[76:79], v[64:67], v[144:147]
    ds_read_b64_tr_b16 v[114:115], v14 offset:12288
    buffer_load_dwordx4 v[196:199], v26, s[28:31], s64 offen offset:3072 sc1
    v_mfma_f32_16x16x32_bf16 v[148:151], v[76:79], v[68:71], v[148:151]
    ds_read_b64_tr_b16 v[116:117], v15 offset:8192
    s_waitcnt lgkmcnt(13)
    v_mfma_f32_16x16x32_bf16 v[152:155], v[80:83], v[56:59], v[152:155]
    ds_read_b64_tr_b16 v[118:119], v15 offset:12288
    buffer_load_dwordx4 v[200:203], v26, s[28:31], s65 offen offset:0 sc1
    v_mfma_f32_16x16x32_bf16 v[156:159], v[80:83], v[60:63], v[156:159]
    v_mfma_f32_16x16x32_bf16 v[160:163], v[80:83], v[64:67], v[160:163]
    buffer_load_dwordx4 v[204:207], v26, s[28:31], s65 offen offset:1024 sc1
    v_mfma_f32_16x16x32_bf16 v[164:167], v[80:83], v[68:71], v[164:167]
    s_waitcnt lgkmcnt(12)
    v_mfma_f32_16x16x32_bf16 v[168:171], v[84:87], v[56:59], v[168:171]
    buffer_load_dwordx4 v[208:211], v26, s[28:31], s65 offen offset:2048 sc1
    v_mfma_f32_16x16x32_bf16 v[172:175], v[84:87], v[60:63], v[172:175]
    v_mfma_f32_16x16x32_bf16 v[176:179], v[84:87], v[64:67], v[176:179]
    buffer_load_dwordx4 v[212:215], v26, s[28:31], s65 offen offset:3072 sc1
    v_mfma_f32_16x16x32_bf16 v[180:183], v[84:87], v[68:71], v[180:183]
    s_waitcnt lgkmcnt(0)
    v_mfma_f32_16x16x32_bf16 v[120:123], v[104:107], v[88:91], v[120:123]
    s_barrier
    v_mfma_f32_16x16x32_bf16 v[124:127], v[104:107], v[92:95], v[124:127]
    ds_read_b128 v[56:59], v11 offset:32768
    v_mfma_f32_16x16x32_bf16 v[128:131], v[104:107], v[96:99], v[128:131]
    ds_read_b64_tr_b16 v[72:73], v12 offset:32768
    v_mfma_f32_16x16x32_bf16 v[132:135], v[104:107], v[100:103], v[132:135]
    ds_read_b64_tr_b16 v[74:75], v12 offset:36864
    v_mfma_f32_16x16x32_bf16 v[136:139], v[108:111], v[88:91], v[136:139]
    ds_read_b128 v[60:63], v11 offset:33792
    v_mfma_f32_16x16x32_bf16 v[140:143], v[108:111], v[92:95], v[140:143]
    ds_read_b128 v[64:67], v11 offset:34816
    v_mfma_f32_16x16x32_bf16 v[144:147], v[108:111], v[96:99], v[144:147]
    ds_read_b128 v[68:71], v11 offset:35840
    v_mfma_f32_16x16x32_bf16 v[148:151], v[108:111], v[100:103], v[148:151]
    ds_read_b64_tr_b16 v[76:77], v13 offset:32768
    v_mfma_f32_16x16x32_bf16 v[152:155], v[112:115], v[88:91], v[152:155]
    ds_read_b64_tr_b16 v[78:79], v13 offset:36864
    v_mfma_f32_16x16x32_bf16 v[156:159], v[112:115], v[92:95], v[156:159]
    ds_read_b64_tr_b16 v[80:81], v14 offset:32768
    v_mfma_f32_16x16x32_bf16 v[160:163], v[112:115], v[96:99], v[160:163]
    ds_read_b64_tr_b16 v[82:83], v14 offset:36864
    v_mfma_f32_16x16x32_bf16 v[164:167], v[112:115], v[100:103], v[164:167]
    ds_read_b64_tr_b16 v[84:85], v15 offset:32768
    v_mfma_f32_16x16x32_bf16 v[168:171], v[116:119], v[88:91], v[168:171]
    ds_read_b64_tr_b16 v[86:87], v15 offset:36864
    v_mfma_f32_16x16x32_bf16 v[172:175], v[116:119], v[92:95], v[172:175]
    ds_read_b64_tr_b16 v[104:105], v12 offset:40960
    v_mfma_f32_16x16x32_bf16 v[176:179], v[116:119], v[96:99], v[176:179]
    ds_read_b64_tr_b16 v[106:107], v12 offset:45056
    v_mfma_f32_16x16x32_bf16 v[180:183], v[116:119], v[100:103], v[180:183]
    ds_read_b64_tr_b16 v[108:109], v13 offset:40960
    s_waitcnt lgkmcnt(7)
    v_mfma_f32_16x16x32_bf16 v[120:123], v[72:75], v[56:59], v[120:123]
    ds_read_b128 v[88:91], v11 offset:40960
    v_mfma_f32_16x16x32_bf16 v[124:127], v[72:75], v[60:63], v[124:127]
    ds_read_b128 v[92:95], v11 offset:41984
    v_mfma_f32_16x16x32_bf16 v[128:131], v[72:75], v[64:67], v[128:131]
    ds_read_b128 v[96:99], v11 offset:43008
    v_mfma_f32_16x16x32_bf16 v[132:135], v[72:75], v[68:71], v[132:135]
    ds_read_b128 v[100:103], v11 offset:44032
    v_mfma_f32_16x16x32_bf16 v[136:139], v[76:79], v[56:59], v[136:139]
    ds_read_b64_tr_b16 v[110:111], v13 offset:45056
    v_mfma_f32_16x16x32_bf16 v[140:143], v[76:79], v[60:63], v[140:143]
    ds_read_b64_tr_b16 v[112:113], v14 offset:40960
    v_mfma_f32_16x16x32_bf16 v[144:147], v[76:79], v[64:67], v[144:147]
    ds_read_b64_tr_b16 v[114:115], v14 offset:45056
    v_mfma_f32_16x16x32_bf16 v[148:151], v[76:79], v[68:71], v[148:151]
    ds_read_b64_tr_b16 v[116:117], v15 offset:40960
    s_waitcnt lgkmcnt(13)
    v_mfma_f32_16x16x32_bf16 v[152:155], v[80:83], v[56:59], v[152:155]
    ds_read_b64_tr_b16 v[118:119], v15 offset:45056
    v_mfma_f32_16x16x32_bf16 v[156:159], v[80:83], v[60:63], v[156:159]
    v_mfma_f32_16x16x32_bf16 v[160:163], v[80:83], v[64:67], v[160:163]
    v_mfma_f32_16x16x32_bf16 v[164:167], v[80:83], v[68:71], v[164:167]
    s_waitcnt lgkmcnt(12)
    v_mfma_f32_16x16x32_bf16 v[168:171], v[84:87], v[56:59], v[168:171]
    v_mfma_f32_16x16x32_bf16 v[172:175], v[84:87], v[60:63], v[172:175]
    v_mfma_f32_16x16x32_bf16 v[176:179], v[84:87], v[64:67], v[176:179]
    v_mfma_f32_16x16x32_bf16 v[180:183], v[84:87], v[68:71], v[180:183]
    s_waitcnt lgkmcnt(0)
    v_mfma_f32_16x16x32_bf16 v[120:123], v[104:107], v[88:91], v[120:123]
    v_mfma_f32_16x16x32_bf16 v[124:127], v[104:107], v[92:95], v[124:127]
    v_mfma_f32_16x16x32_bf16 v[128:131], v[104:107], v[96:99], v[128:131]
    v_mfma_f32_16x16x32_bf16 v[132:135], v[104:107], v[100:103], v[132:135]
    v_mfma_f32_16x16x32_bf16 v[136:139], v[108:111], v[88:91], v[136:139]
    v_mfma_f32_16x16x32_bf16 v[140:143], v[108:111], v[92:95], v[140:143]
    v_mfma_f32_16x16x32_bf16 v[144:147], v[108:111], v[96:99], v[144:147]
    v_mfma_f32_16x16x32_bf16 v[148:151], v[108:111], v[100:103], v[148:151]
    v_mfma_f32_16x16x32_bf16 v[152:155], v[112:115], v[88:91], v[152:155]
    v_mfma_f32_16x16x32_bf16 v[156:159], v[112:115], v[92:95], v[156:159]
    v_mfma_f32_16x16x32_bf16 v[160:163], v[112:115], v[96:99], v[160:163]
    v_mfma_f32_16x16x32_bf16 v[164:167], v[112:115], v[100:103], v[164:167]
    v_mfma_f32_16x16x32_bf16 v[168:171], v[116:119], v[88:91], v[168:171]
    v_mfma_f32_16x16x32_bf16 v[172:175], v[116:119], v[92:95], v[172:175]
    v_mfma_f32_16x16x32_bf16 v[176:179], v[116:119], v[96:99], v[176:179]
    v_mfma_f32_16x16x32_bf16 v[180:183], v[116:119], v[100:103], v[180:183]
    s_nop 7
    v_and_b32 v2, 15, v1
    v_lshrrev_b32 v3, 4, v1
    s_lshl_b32 s62, s53, 7
    s_lshl_b32 s63, s55, 6
    s_add_u32 s62, s62, s63
    v_add_u32 v2, s62, v2
    v_lshlrev_b32 v2, 11, v2
    v_lshlrev_b32 v3, 4, v3
    v_add_u32 v2, v2, v3
    s_lshl_b32 s62, s58, 8
    s_lshl_b32 s63, s56, 7
    s_add_u32 s62, s62, s63
    v_add_u32 v2, s62, v2
    s_mov_b32 s63, 0x20000
PX_75:
    s_waitcnt vmcnt(0)
    v_max3_u32 v3, v184, v185, v186
    v_max3_u32 v3, v3, v187, v188
    v_max3_u32 v3, v3, v189, v190
    v_max3_u32 v3, v3, v191, v192
    v_max3_u32 v3, v3, v193, v194
    v_max3_u32 v3, v3, v195, v196
    v_max3_u32 v3, v3, v197, v198
    v_max3_u32 v3, v3, v199, v200
    v_max3_u32 v3, v3, v201, v202
    v_max3_u32 v3, v3, v203, v204
    v_max3_u32 v3, v3, v205, v206
    v_max3_u32 v3, v3, v207, v208
    v_max3_u32 v3, v3, v209, v210
    v_max3_u32 v3, v3, v211, v212
    v_max3_u32 v3, v3, v213, v214
    v_max_u32 v3, v3, v215
    v_cmp_eq_u32 vcc, -1, v3
    s_sub_u32 s63, s63, 1
    s_nop 2
    s_cbranch_vccz PY_76
    s_cmp_eq_u32 s63, 0
    s_cbranch_scc1 PY_76
    buffer_load_dwordx4 v[184:187], v26, s[28:31], s64 offen offset:0 sc1
    buffer_load_dwordx4 v[188:191], v26, s[28:31], s64 offen offset:1024 sc1
    buffer_load_dwordx4 v[192:195], v26, s[28:31], s64 offen offset:2048 sc1
    buffer_load_dwordx4 v[196:199], v26, s[28:31], s64 offen offset:3072 sc1
    buffer_load_dwordx4 v[200:203], v26, s[28:31], s65 offen offset:0 sc1
    buffer_load_dwordx4 v[204:207], v26, s[28:31], s65 offen offset:1024 sc1
    buffer_load_dwordx4 v[208:211], v26, s[28:31], s65 offen offset:2048 sc1
    buffer_load_dwordx4 v[212:215], v26, s[28:31], s65 offen offset:3072 sc1
    s_branch PX_75
PY_76:
    v_lshlrev_b32 v216, 16, v184
    v_and_b32 v217, 0xffff0000, v184
    v_lshlrev_b32 v218, 16, v185
    v_and_b32 v219, 0xffff0000, v185
    v_fma_f32 v120, v120, v22, v216
    v_fma_f32 v121, v121, v22, v217
    v_fma_f32 v122, v122, v22, v218
    v_fma_f32 v123, v123, v22, v219
    v_cvt_pk_bf16_f32 v56, v120, v121
    v_cvt_pk_bf16_f32 v57, v122, v123
    v_lshlrev_b32 v220, 16, v186
    v_and_b32 v221, 0xffff0000, v186
    v_lshlrev_b32 v222, 16, v187
    v_and_b32 v223, 0xffff0000, v187
    v_fma_f32 v136, v136, v22, v220
    v_fma_f32 v137, v137, v22, v221
    v_fma_f32 v138, v138, v22, v222
    v_fma_f32 v139, v139, v22, v223
    v_cvt_pk_bf16_f32 v58, v136, v137
    v_cvt_pk_bf16_f32 v59, v138, v139
    v_lshlrev_b32 v224, 16, v200
    v_and_b32 v225, 0xffff0000, v200
    v_lshlrev_b32 v226, 16, v201
    v_and_b32 v227, 0xffff0000, v201
    v_fma_f32 v152, v152, v22, v224
    v_fma_f32 v153, v153, v22, v225
    v_fma_f32 v154, v154, v22, v226
    v_fma_f32 v155, v155, v22, v227
    v_cvt_pk_bf16_f32 v60, v152, v153
    v_cvt_pk_bf16_f32 v61, v154, v155
    v_lshlrev_b32 v228, 16, v202
    v_and_b32 v229, 0xffff0000, v202
    v_lshlrev_b32 v230, 16, v203
    v_and_b32 v231, 0xffff0000, v203
    v_fma_f32 v168, v168, v22, v228
    v_fma_f32 v169, v169, v22, v229
    v_fma_f32 v170, v170, v22, v230
    v_fma_f32 v171, v171, v22, v231
    v_cvt_pk_bf16_f32 v62, v168, v169
    v_cvt_pk_bf16_f32 v63, v170, v171
    s_nop 0
    v_permlane32_swap_b32 v56, v58
    v_permlane32_swap_b32 v57, v59
    v_permlane32_swap_b32 v60, v62
    v_permlane32_swap_b32 v61, v63
    v_permlane16_swap_b32 v56, v58
    v_permlane16_swap_b32 v57, v59
    v_permlane16_swap_b32 v60, v62
    v_permlane16_swap_b32 v61, v63
    buffer_store_dwordx4 v[56:59], v2, s[32:35], 0 offen offset:0 nt
    buffer_store_dwordx4 v[60:63], v2, s[32:35], 0 offen offset:64 nt
    v_add_u32 v2, 0x8000, v2
    v_lshlrev_b32 v216, 16, v188
    v_and_b32 v217, 0xffff0000, v188
    v_lshlrev_b32 v218, 16, v189
    v_and_b32 v219, 0xffff0000, v189
    v_fma_f32 v124, v124, v23, v216
    v_fma_f32 v125, v125, v23, v217
    v_fma_f32 v126, v126, v23, v218
    v_fma_f32 v127, v127, v23, v219
    v_cvt_pk_bf16_f32 v64, v124, v125
    v_cvt_pk_bf16_f32 v65, v126, v127
    v_lshlrev_b32 v220, 16, v190
    v_and_b32 v221, 0xffff0000, v190
    v_lshlrev_b32 v222, 16, v191
    v_and_b32 v223, 0xffff0000, v191
    v_fma_f32 v140, v140, v23, v220
    v_fma_f32 v141, v141, v23, v221
    v_fma_f32 v142, v142, v23, v222
    v_fma_f32 v143, v143, v23, v223
    v_cvt_pk_bf16_f32 v66, v140, v141
    v_cvt_pk_bf16_f32 v67, v142, v143
    v_lshlrev_b32 v224, 16, v204
    v_and_b32 v225, 0xffff0000, v204
    v_lshlrev_b32 v226, 16, v205
    v_and_b32 v227, 0xffff0000, v205
    v_fma_f32 v156, v156, v23, v224
    v_fma_f32 v157, v157, v23, v225
    v_fma_f32 v158, v158, v23, v226
    v_fma_f32 v159, v159, v23, v227
    v_cvt_pk_bf16_f32 v68, v156, v157
    v_cvt_pk_bf16_f32 v69, v158, v159
    v_lshlrev_b32 v228, 16, v206
    v_and_b32 v229, 0xffff0000, v206
    v_lshlrev_b32 v230, 16, v207
    v_and_b32 v231, 0xffff0000, v207
    v_fma_f32 v172, v172, v23, v228
    v_fma_f32 v173, v173, v23, v229
    v_fma_f32 v174, v174, v23, v230
    v_fma_f32 v175, v175, v23, v231
    v_cvt_pk_bf16_f32 v70, v172, v173
    v_cvt_pk_bf16_f32 v71, v174, v175
    s_nop 0
    v_permlane32_swap_b32 v64, v66
    v_permlane32_swap_b32 v65, v67
    v_permlane32_swap_b32 v68, v70
    v_permlane32_swap_b32 v69, v71
    v_permlane16_swap_b32 v64, v66
    v_permlane16_swap_b32 v65, v67
    v_permlane16_swap_b32 v68, v70
    v_permlane16_swap_b32 v69, v71
    buffer_store_dwordx4 v[64:67], v2, s[32:35], 0 offen offset:0 nt
    buffer_store_dwordx4 v[68:71], v2, s[32:35], 0 offen offset:64 nt
    v_add_u32 v2, 0x8000, v2
    v_lshlrev_b32 v216, 16, v192
    v_and_b32 v217, 0xffff0000, v192
    v_lshlrev_b32 v218, 16, v193
    v_and_b32 v219, 0xffff0000, v193
    v_fma_f32 v128, v128, v24, v216
    v_fma_f32 v129, v129, v24, v217
    v_fma_f32 v130, v130, v24, v218
    v_fma_f32 v131, v131, v24, v219
    v_cvt_pk_bf16_f32 v72, v128, v129
    v_cvt_pk_bf16_f32 v73, v130, v131
    v_lshlrev_b32 v220, 16, v194
    v_and_b32 v221, 0xffff0000, v194
    v_lshlrev_b32 v222, 16, v195
    v_and_b32 v223, 0xffff0000, v195
    v_fma_f32 v144, v144, v24, v220
    v_fma_f32 v145, v145, v24, v221
    v_fma_f32 v146, v146, v24, v222
    v_fma_f32 v147, v147, v24, v223
    v_cvt_pk_bf16_f32 v74, v144, v145
    v_cvt_pk_bf16_f32 v75, v146, v147
    v_lshlrev_b32 v224, 16, v208
    v_and_b32 v225, 0xffff0000, v208
    v_lshlrev_b32 v226, 16, v209
    v_and_b32 v227, 0xffff0000, v209
    v_fma_f32 v160, v160, v24, v224
    v_fma_f32 v161, v161, v24, v225
    v_fma_f32 v162, v162, v24, v226
    v_fma_f32 v163, v163, v24, v227
    v_cvt_pk_bf16_f32 v76, v160, v161
    v_cvt_pk_bf16_f32 v77, v162, v163
    v_lshlrev_b32 v228, 16, v210
    v_and_b32 v229, 0xffff0000, v210
    v_lshlrev_b32 v230, 16, v211
    v_and_b32 v231, 0xffff0000, v211
    v_fma_f32 v176, v176, v24, v228
    v_fma_f32 v177, v177, v24, v229
    v_fma_f32 v178, v178, v24, v230
    v_fma_f32 v179, v179, v24, v231
    v_cvt_pk_bf16_f32 v78, v176, v177
    v_cvt_pk_bf16_f32 v79, v178, v179
    s_nop 0
    v_permlane32_swap_b32 v72, v74
    v_permlane32_swap_b32 v73, v75
    v_permlane32_swap_b32 v76, v78
    v_permlane32_swap_b32 v77, v79
    v_permlane16_swap_b32 v72, v74
    v_permlane16_swap_b32 v73, v75
    v_permlane16_swap_b32 v76, v78
    v_permlane16_swap_b32 v77, v79
    buffer_store_dwordx4 v[72:75], v2, s[32:35], 0 offen offset:0 nt
    buffer_store_dwordx4 v[76:79], v2, s[32:35], 0 offen offset:64 nt
    v_add_u32 v2, 0x8000, v2
    v_lshlrev_b32 v216, 16, v196
    v_and_b32 v217, 0xffff0000, v196
    v_lshlrev_b32 v218, 16, v197
    v_and_b32 v219, 0xffff0000, v197
    v_fma_f32 v132, v132, v25, v216
    v_fma_f32 v133, v133, v25, v217
    v_fma_f32 v134, v134, v25, v218
    v_fma_f32 v135, v135, v25, v219
    v_cvt_pk_bf16_f32 v80, v132, v133
    v_cvt_pk_bf16_f32 v81, v134, v135
    v_lshlrev_b32 v220, 16, v198
    v_and_b32 v221, 0xffff0000, v198
    v_lshlrev_b32 v222, 16, v199
    v_and_b32 v223, 0xffff0000, v199
    v_fma_f32 v148, v148, v25, v220
    v_fma_f32 v149, v149, v25, v221
    v_fma_f32 v150, v150, v25, v222
    v_fma_f32 v151, v151, v25, v223
    v_cvt_pk_bf16_f32 v82, v148, v149
    v_cvt_pk_bf16_f32 v83, v150, v151
    v_lshlrev_b32 v224, 16, v212
    v_and_b32 v225, 0xffff0000, v212
    v_lshlrev_b32 v226, 16, v213
    v_and_b32 v227, 0xffff0000, v213
    v_fma_f32 v164, v164, v25, v224
    v_fma_f32 v165, v165, v25, v225
    v_fma_f32 v166, v166, v25, v226
    v_fma_f32 v167, v167, v25, v227
    v_cvt_pk_bf16_f32 v84, v164, v165
    v_cvt_pk_bf16_f32 v85, v166, v167
    v_lshlrev_b32 v228, 16, v214
    v_and_b32 v229, 0xffff0000, v214
    v_lshlrev_b32 v230, 16, v215
    v_and_b32 v231, 0xffff0000, v215
    v_fma_f32 v180, v180, v25, v228
    v_fma_f32 v181, v181, v25, v229
    v_fma_f32 v182, v182, v25, v230
    v_fma_f32 v183, v183, v25, v231
    v_cvt_pk_bf16_f32 v86, v180, v181
    v_cvt_pk_bf16_f32 v87, v182, v183
    s_nop 0
    v_permlane32_swap_b32 v80, v82
    v_permlane32_swap_b32 v81, v83
    v_permlane32_swap_b32 v84, v86
    v_permlane32_swap_b32 v85, v87
    v_permlane16_swap_b32 v80, v82
    v_permlane16_swap_b32 v81, v83
    v_permlane16_swap_b32 v84, v86
    v_permlane16_swap_b32 v85, v87
    buffer_store_dwordx4 v[80:83], v2, s[32:35], 0 offen offset:0 nt
    buffer_store_dwordx4 v[84:87], v2, s[32:35], 0 offen offset:64 nt
KE_71:
    s_endpgm
L_END:
    s_endpgm
L_KEND:
.section .rodata,"a"
.p2align 6
.amdhsa_kernel gated_mix__sliding_local_dilated__dense_activation_squared_relu__prompt_kernel
  .amdhsa_next_free_vgpr 256
  .amdhsa_next_free_sgpr 96
  .amdhsa_accum_offset 256
  .amdhsa_group_segment_fixed_size 0
  .amdhsa_kernarg_size 96
  .amdhsa_user_sgpr_count 2
  .amdhsa_user_sgpr_kernarg_segment_ptr 1
  .amdhsa_system_sgpr_workgroup_id_x 1
.end_amdhsa_kernel
```
